```python
import torch

def _softmax(x, axis=-1):
    return torch.softmax(x, dim=axis)
def _gelu(x):
    return torch.nn.functional.gelu(x, approximate="tanh")
def _silu(x):
    return torch.nn.functional.silu(x)
def _sigmoid(x):
    return torch.sigmoid(x)
def _layernorm(x, axis=-1, eps=1e-5):
    m = x.mean(dim=axis, keepdim=True)
    v = x.var(dim=axis, keepdim=True, unbiased=False)
    return (x - m) / torch.sqrt(v + eps)
def _scatter_add(tgt, idx, src, axis=0):
    return tgt.clone().index_add_(axis, idx, src)
def _segment_sum(src, seg, n):
    out = torch.zeros((n,) + src.shape[1:], dtype=src.dtype)
    return out.index_add_(0, seg, src)
def _pad(x, pw):
    flat = tuple(v for pair in reversed(pw) for v in pair)
    return torch.nn.functional.pad(x, flat)

kernel_name = 'parallel_sum__sliding_local_dilated__glu_gated_swiglu__prompt'

def setup_inputs():

    _w = (lambda a: (lambda t: t.to(torch.bfloat16) if t.is_floating_point() else t)(torch.as_tensor(a)))
    def _A_setup():
        B, S, D = 1, 2048, 512
        return {
            "x": _w((lambda *s: torch.randn(*s, dtype=torch.bfloat16) * 0.05)(B, S, D)),
            "wqkv": _w((lambda *s: torch.randn(*s, dtype=torch.bfloat16) * 0.05)(D, 3 * D)),
            "wo": _w((lambda *s: torch.randn(*s, dtype=torch.bfloat16) * 0.05)(D, D)),
        }
    _A_in = _A_setup()

    def _B_setup():
        B, S, D, F = 1, 2048, 512, 1376
        return {
            "x": _w((lambda *s: torch.randn(*s, dtype=torch.bfloat16) * 0.05)(B, S, D)),
            "w1": _w((lambda *s: torch.randn(*s, dtype=torch.bfloat16) * 0.8)(D, F) * (2.0 / D) ** 0.5),
            "w3": _w((lambda *s: torch.randn(*s, dtype=torch.bfloat16) * 0.8)(D, F) * (2.0 / D) ** 0.5),
            "w2": _w((lambda *s: torch.randn(*s, dtype=torch.bfloat16) * 0.8)(F, D) * (2.0 / F) ** 0.5),
        }
    _B_in = _B_setup()

    return {
        "A_x": _A_in["x"],
        "A_wqkv": _A_in["wqkv"],
        "A_wo": _A_in["wo"],
        "B_x": _B_in["x"],
        "B_w1": _B_in["w1"],
        "B_w3": _B_in["w3"],
        "B_w2": _B_in["w2"],
    }

def reference(A_x, A_wqkv, A_wo, B_x, B_w1, B_w3, B_w2):
    def _A_ref(x, wqkv, wo):
        B, S, D = x.shape
        H = 32; Dh = D // H
        W, dil = 8, 2
        qkv = (lambda x, *d: x.permute(*d))((x @ wqkv).reshape(B, S, 3, H, Dh), 2, 0, 3, 1, 4)
        q, k, v = qkv[0], qkv[1], qkv[2]
        scale = Dh ** -0.5
        pos = torch.arange(S)
        off = torch.arange(W) * dil
        idx = pos[:, None] - off[None, :]
        mask = idx >= 0
        idx_c = torch.where(mask, idx, 0).reshape(-1)
        kg = k[:, :, idx_c, :].reshape(B, H, S, W, Dh)
        vg = v[:, :, idx_c, :].reshape(B, H, S, W, Dh)
        logits = torch.einsum("bhsd,bhswd->bhsw", q, kg) * scale
        logits = torch.where(mask[None, None, :, :], logits, -1e9)
        attn = _softmax(logits, axis=-1)
        o = torch.einsum("bhsw,bhswd->bhsd", attn, vg)
        return (lambda x, *d: x.permute(*d))(o, 0, 2, 1, 3).reshape(B, S, D) @ wo

    def _B_ref(x, w1, w3, w2):
        gate = torch.einsum("bsd,df->bsf", x, w1)
        up = torch.einsum("bsd,df->bsf", x, w3)
        h = _silu(gate) * up
        out = torch.einsum("bsf,fd->bsd", h, w2)
        return out

    x = A_x
    xn = _layernorm(x, axis=-1)
    return x + _A_ref(xn, A_wqkv, A_wo) + _B_ref(xn, B_w1, B_w3, B_w2)
```

```asm
; @launch kernel=k1_kernel grid=(256,1,1) block=(512,1,1) lds=163840
; @launch kernel=k2_kernel grid=(256,1,1) block=(256,1,1) lds=131072
.amdgcn_target "amdgcn-amd-amdhsa--gfx950"
.text
.globl k1_kernel
.p2align 8
.type k1_kernel,@function
k1_kernel:
    s_cmp_ge_u32 s2, 256
    s_cbranch_scc1 K1_END
    s_load_dwordx4 s[4:7], s[0:1], 0
    s_load_dwordx4 s[28:31], s[0:1], 32
    s_load_dwordx4 s[76:79], s[0:1], 64
    s_load_dwordx2 s[72:73], s[0:1], 16
    s_load_dwordx4 s[96:99], s[0:1], 48
    s_getpc_b64 s[70:71]
K1_PC:
    s_lshr_b32 s46, s2, 3
    s_lshl_b32 s46, s46, 11
    v_lshl_add_u32 v5, v0, 7, s46
    v_min_u32 v5, K2_END-K1_PC, v5
    v_cmp_gt_u32 vcc, 16, v0
    s_and_saveexec_b64 s[62:63], vcc
    s_cbranch_execz K1_NCP
    global_load_dword v15, v5, s[70:71]
K1_NCP:
    s_mov_b64 exec, -1
    v_lshrrev_b32 v4, 6, v0
    v_and_b32 v1, 63, v0
    v_readfirstlane_b32 s34, v4
    v_and_b32 v2, 31, v1
    v_lshrrev_b32 v3, 5, v1
    s_lshr_b32 s46, s2, 3
    s_and_b32 s35, s2, 1
    s_lshl_b32 s35, s35, 2
    s_and_b32 s47, s46, 3
    s_add_u32 s35, s35, s47
    v_lshrrev_b32 v5, 3, v1
    v_lshrrev_b32 v6, 4, v1
    v_and_b32 v7, 7, v1
    s_lshl_b32 s46, s35, 8
    s_lshl_b32 s47, s34, 5
    s_add_u32 s46, s46, s47
    v_add_u32 v8, s46, v5
    v_lshlrev_b32 v8, 10, v8
    v_xor_b32 v9, v7, v6
    v_lshl_add_u32 v16, v9, 4, v8
    v_xor_b32 v9, v7, v6
    v_xor_b32 v9, 4, v9
    v_lshl_add_u32 v17, v9, 4, v8
    v_add_u32 v17, 7168, v17
    v_xor_b32 v9, v7, v6
    v_lshl_add_u32 v18, v9, 4, v8
    v_add_u32 v18, 14336, v18
    v_xor_b32 v9, v7, v6
    v_xor_b32 v9, 4, v9
    v_lshl_add_u32 v19, v9, 4, v8
    v_add_u32 v19, 21504, v19
    s_bfe_u32 s39, s2, 0x20005
    s_lshl_b32 s39, s39, 1
    s_lshr_b32 s49, s2, 7
    s_add_u32 s39, s39, s49
    s_add_u32 s49, s39, s35
    s_and_b32 s49, s49, 7
    s_lshl_b32 s40, s49, 7
    s_lshl_b32 s50, s34, 12
    s_mov_b32 m0, s50
    s_mov_b32 s10, 2097152
    s_mov_b32 s11, 0x20000
    s_waitcnt lgkmcnt(0)
    s_mov_b64 s[8:9], s[4:5]
    buffer_load_dwordx4 v16, s[8:11], s40 offen offset:0 lds
    buffer_load_dwordx4 v17, s[8:11], s40 offen offset:1024 lds
    buffer_load_dwordx4 v18, s[8:11], s40 offen offset:2048 lds
    buffer_load_dwordx4 v19, s[8:11], s40 offen offset:3072 lds
    s_lshr_b32 s46, s2, 3
    s_lshr_b32 s48, s2, 1
    s_and_b32 s48, s48, 3
    s_lshl_b32 s48, s48, 3
    s_add_u32 s48, s48, s39
    s_and_b32 s55, s48, 1
    s_lshr_b32 s36, s48, 1
    s_lshr_b32 s46, s34, 2
    s_xor_b32 s37, s34, s46
    s_and_b32 s37, s37, 1
    s_lshr_b32 s38, s34, 1
    s_and_b32 s56, s34, 3
    s_mov_b32 s54, 0x3f803f80
    s_lshr_b32 s57, s36, 1
    s_cmp_lt_u32 s36, 12
    s_cselect_b32 s57, s57, 0
    s_add_u32 s57, s57, 80
    s_cmp_eq_u32 s55, 0
    s_cselect_b32 s57, s36, s57
    s_lshl_b32 s58, s36, 2
    s_add_u32 s58, s58, 16
    s_lshl_b32 s46, s56, 4
    v_lshrrev_b32 v8, 1, v2
    v_add_u32 v8, s46, v8
    s_and_b32 s46, s34, 4
    v_xor_b32 v8, s46, v8
    v_mul_u32_u24 v8, 2752, v8
    v_and_b32 v9, 1, v1
    v_lshl_add_u32 v8, v9, 4, v8
    s_lshl_b32 s46, s57, 5
    v_add_u32 v229, s46, v8
    v_bfe_u32 v10, v1, 2, 2
    v_and_b32 v11, 3, v1
    v_and_b32 v12, 1, v6
    v_lshl_add_u32 v13, v3, 3, v10
    s_lshl_b32 s53, s34, 9
    s_add_u32 s53, s53, 49152
    s_mul_i32 s42, s49, 176128
    v_lshlrev_b32 v219, 4, v1
    s_lshl_b32 s60, s35, 8
    s_lshl_b32 s47, s48, 3
    s_add_u32 s60, s60, s47
    s_add_u32 s60, s60, s34
    s_lshl_b32 s61, s60, 10
    s_cmp_eq_u32 s55, 0
    s_cbranch_scc1 K1_ATT_SETUP
    s_mov_b32 s41, s42
    s_lshl_b32 s51, s34, 10
    s_add_u32 s52, s51, 40960
    s_add_u32 s51, s51, 32768
    s_lshl_b32 s46, s34, 3
    v_add_u32 v8, s46, v5
    v_mul_u32_u24 v8, 2752, v8
    v_and_b32 v9, 1, v1
    v_lshl_add_u32 v8, v9, 4, v8
    s_lshl_b32 s46, s58, 5
    v_add_u32 v8, s46, v8
    v_lshrrev_b32 v9, 1, v7
    v_lshlrev_b32 v14, 1, v12
    v_xor_b32 v9, v9, v14
    v_lshl_add_u32 v225, v9, 5, v8
    v_xor_b32 v9, 1, v9
    v_lshl_add_u32 v227, v9, 5, v8
    s_mov_b32 s22, 1409024
    s_mov_b32 s23, 0x20000
    s_mov_b32 s26, 7733248
    s_mov_b32 s27, 0x20000
    s_mov_b32 s15, 0x20000
    s_mov_b32 s19, 0x20000
    s_mov_b32 s14, 1409024
    s_mov_b32 s18, 1409024
    s_cmp_lt_u32 s34, 4
    s_mov_b64 s[12:13], s[28:29]
    s_mov_b64 s[16:17], s[30:31]
    s_cselect_b64 s[20:21], s[28:29], s[30:31]
    s_mov_b64 s[32:33], s[78:79]
    s_mov_b64 s[24:25], s[78:79]
    s_add_u32 m0, s51, 0
    s_nop 0
    buffer_load_dwordx4 v225, s[12:15], s41 offen lds
    s_add_u32 m0, s52, 0
    s_nop 0
    buffer_load_dwordx4 v227, s[16:19], s41 offen lds
    s_add_u32 m0, s53, 0
    s_mov_b32 exec_hi, 0
    buffer_load_dwordx4 v229, s[20:23], s42 offen lds
    s_mov_b32 exec_hi, -1
    s_add_u32 s49, s49, 1
    s_and_b32 s49, s49, 7
    s_lshl_b32 s40, s49, 7
    s_mul_i32 s42, s49, 176128
    s_mov_b32 s41, s42
    v_and_b32 v9, 2, v10
    v_xor_b32 v9, v9, v12
    s_lshl_b32 s46, s37, 1
    v_xor_b32 v9, s46, v9
    v_lshlrev_b32 v8, 7, v13
    v_lshl_add_u32 v8, v11, 3, v8
    v_lshl_add_u32 v8, v12, 13, v8
    v_add_u32 v8, 32768, v8
    v_lshl_add_u32 v36, v9, 5, v8
    v_xor_b32 v9, 1, v9
    v_lshl_add_u32 v38, v9, 5, v8
    v_lshlrev_b32 v8, 2, v12
    v_xor_b32 v8, v8, v13
    v_lshlrev_b32 v8, 5, v8
    v_lshl_add_u32 v8, v11, 3, v8
    v_lshl_add_u32 v8, v12, 11, v8
    v_add_u32 v40, 49152, v8
    v_lshlrev_b32 v8, 2, v12
    v_xor_b32 v8, v8, v13
    v_xor_b32 v8, 4, v8
    v_lshlrev_b32 v8, 5, v8
    v_lshl_add_u32 v8, v11, 3, v8
    v_lshl_add_u32 v8, v12, 11, v8
    v_add_u32 v41, 49152, v8
    v_bfe_u32 v8, v2, 1, 3
    v_xor_b32 v8, v8, v3
    v_lshlrev_b32 v8, 4, v8
    v_lshl_add_u32 v8, v2, 7, v8
    s_lshl_b32 s46, s38, 13
    s_lshl_b32 s47, s37, 12
    s_add_u32 s46, s46, s47
    s_xor_b32 s47, s46, 4096
    v_xor_b32 v9, 0, v8
    v_add_u32 v24, s46, v9
    v_add_u32 v28, s47, v9
    v_xor_b32 v9, 32, v8
    v_add_u32 v25, s46, v9
    v_add_u32 v29, s47, v9
    v_xor_b32 v9, 64, v8
    v_add_u32 v26, s46, v9
    v_add_u32 v30, s47, v9
    v_xor_b32 v9, 96, v8
    v_add_u32 v27, s46, v9
    v_add_u32 v31, s47, v9
    s_sub_u32 s46, s35, 1
    s_cmp_eq_u32 s35, 0
    s_cselect_b32 s46, 0, s46
    s_mov_b32 s46, s35
    v_mov_b32 v221, 0
    v_mov_b32 v8, 0x01010101
    v_cmp_eq_u32 vcc, s35, v5
    s_nop 1
    v_cndmask_b32 v221, v221, v8, vcc
    v_cmp_eq_u32 vcc, s46, v5
    s_nop 1
    v_cndmask_b32 v221, v221, v8, vcc
    s_and_b32 s46, s48, 3
    s_lshl_b32 s46, s46, 3
    s_lshl_b32 s46, 1, s46
    s_lshr_b32 s47, s48, 2
    v_or_b32 v8, s46, v221
    v_cmp_eq_u32 vcc, s47, v7
    s_nop 1
    v_cndmask_b32 v221, v221, v8, vcc
    s_lshr_b32 s43, s39, 1
    s_lshl_b32 s43, s43, 2
    s_bfe_u32 s46, s2, 0x20003
    s_add_u32 s43, s43, s46
    s_lshl_b32 s43, s43, 3
    s_add_u32 s43, s43, s34
    s_lshl_b32 s43, s43, 1
    s_sub_u32 s46, s43, 64
    s_min_u32 s46, s46, 170
    s_cmp_lt_u32 s43, 64
    s_cselect_b32 s46, s43, s46
    s_lshl_b32 s46, s46, 13
    v_lshl_add_u32 v199, v1, 7, s46
    v_add_u32 v196, 8192, v199
    s_mov_b32 s66, 1409024
    s_mov_b32 s67, 0x20000
    s_lshl_b32 s60, s60, 3
    s_add_u32 s60, s60, 9437184
    s_cmp_lt_u32 s43, 64
    s_cselect_b64 s[70:71], s[72:73], s[96:97]
    s_barrier
    buffer_load_dwordx4 v[232:235], v219, s[8:11], s61 offen
    s_add_u32 m0, s50, 53248
    s_nop 0
    buffer_load_dwordx4 v16, s[8:11], s40 offen offset:0 lds
    buffer_load_dwordx4 v17, s[8:11], s40 offen offset:1024 lds
    buffer_load_dwordx4 v18, s[8:11], s40 offen offset:2048 lds
    buffer_load_dwordx4 v19, s[8:11], s40 offen offset:3072 lds
    s_add_u32 m0, s51, 53248
    s_nop 0
    buffer_load_dwordx4 v225, s[12:15], s41 offen lds
    s_add_u32 m0, s52, 53248
    s_nop 0
    buffer_load_dwordx4 v227, s[16:19], s41 offen lds
    s_add_u32 m0, s53, 53248
    s_mov_b32 exec_hi, 0
    buffer_load_dwordx4 v229, s[20:23], s42 offen lds
    s_mov_b32 exec_hi, -1
    s_add_u32 s49, s49, 1
    s_and_b32 s49, s49, 7
    s_lshl_b32 s40, s49, 7
    s_mul_i32 s42, s49, 176128
    s_mov_b32 s41, s42
    s_waitcnt vmcnt(8)
    s_cmp_ge_u32 s36, 12
    s_cbranch_scc1 K1_F4
    s_and_b32 s46, s36, 1
    s_lshr_b32 s47, s34, 2
    s_cmp_eq_u32 s46, s47
    s_cbranch_scc1 K1_F5
    s_branch K1_F4
K1_F4_SLOW:
    s_mov_b32 s62, 0
K1_F4_SPIN:
    s_add_u32 s62, s62, 1
    s_cmp_ge_u32 s62, 4000
    s_cbranch_scc1 K1_F4_FB1
    s_sleep 4
    v_lshlrev_b32 v11, 2, v1
    global_load_dword v223, v11, s[76:77] sc1
    s_waitcnt vmcnt(0)
    v_and_b32 v11, v223, v221
    v_cmp_ne_u32 vcc, v11, v221
    s_nop 4
    s_cbranch_vccz K1_F4_RDY
    s_branch K1_F4_SPIN
K1_F4_FB1:
    v_mov_b32 v5, 1
    s_branch K1_F4_RDY
K1_F4_FB:
    s_lshl_b32 s63, s35, 8
    s_lshl_b32 s47, s38, 6
    s_add_u32 s63, s63, s47
    s_lshl_b32 s47, s37, 5
    s_add_u32 s63, s63, s47
    s_mov_b32 s62, 0
K1_F4_FS0:
    s_add_u32 s64, s63, s62
    s_lshl_b32 s64, s64, 10
    buffer_load_dwordx4 v[164:167], v219, s[8:11], s64 offen
    s_waitcnt vmcnt(0)
    v_mov_b32 v8, 0
    v_mov_b32 v9, 0
    v_dot2c_f32_bf16 v8, s54, v164
    v_dot2c_f32_bf16 v9, v164, v164
    v_dot2c_f32_bf16 v8, s54, v165
    v_dot2c_f32_bf16 v9, v165, v165
    v_dot2c_f32_bf16 v8, s54, v166
    v_dot2c_f32_bf16 v9, v166, v166
    v_dot2c_f32_bf16 v8, s54, v167
    v_dot2c_f32_bf16 v9, v167, v167
    s_nop 2
    v_add_f32_dpp v8, v8, v8 row_shr:1 row_mask:0xf bank_mask:0xf bound_ctrl:0
    v_add_f32_dpp v9, v9, v9 row_shr:1 row_mask:0xf bank_mask:0xf bound_ctrl:0
    s_nop 0
    v_add_f32_dpp v8, v8, v8 row_shr:2 row_mask:0xf bank_mask:0xf bound_ctrl:0
    v_add_f32_dpp v9, v9, v9 row_shr:2 row_mask:0xf bank_mask:0xf bound_ctrl:0
    s_nop 0
    v_add_f32_dpp v8, v8, v8 row_shr:4 row_mask:0xf bank_mask:0xf bound_ctrl:0
    v_add_f32_dpp v9, v9, v9 row_shr:4 row_mask:0xf bank_mask:0xf bound_ctrl:0
    s_nop 0
    v_add_f32_dpp v8, v8, v8 row_shr:8 row_mask:0xf bank_mask:0xf bound_ctrl:0
    v_add_f32_dpp v9, v9, v9 row_shr:8 row_mask:0xf bank_mask:0xf bound_ctrl:0
    s_nop 0
    v_add_f32_dpp v8, v8, v8 row_bcast:15 row_mask:0xa bank_mask:0xf
    v_add_f32_dpp v9, v9, v9 row_bcast:15 row_mask:0xa bank_mask:0xf
    s_nop 0
    v_add_f32_dpp v8, v8, v8 row_bcast:31 row_mask:0xc bank_mask:0xf
    v_add_f32_dpp v9, v9, v9 row_bcast:31 row_mask:0xc bank_mask:0xf
    s_nop 0
    v_readlane_b32 s46, v8, 63
    v_readlane_b32 s47, v9, 63
    s_nop 1
    v_mov_b32 v8, s46
    v_mov_b32 v9, s47
    v_cmp_eq_u32 vcc, s62, v2
    s_nop 1
    v_cndmask_b32 v248, v248, v8, vcc
    v_cndmask_b32 v249, v249, v9, vcc
    s_add_u32 s62, s62, 1
    s_cmp_lt_u32 s62, 32
    s_cbranch_scc1 K1_F4_FS0
    s_xor_b32 s63, s63, 32
    s_mov_b32 s62, 0
K1_F4_FS1:
    s_add_u32 s64, s63, s62
    s_lshl_b32 s64, s64, 10
    buffer_load_dwordx4 v[164:167], v219, s[8:11], s64 offen
    s_waitcnt vmcnt(0)
    v_mov_b32 v8, 0
    v_mov_b32 v9, 0
    v_dot2c_f32_bf16 v8, s54, v164
    v_dot2c_f32_bf16 v9, v164, v164
    v_dot2c_f32_bf16 v8, s54, v165
    v_dot2c_f32_bf16 v9, v165, v165
    v_dot2c_f32_bf16 v8, s54, v166
    v_dot2c_f32_bf16 v9, v166, v166
    v_dot2c_f32_bf16 v8, s54, v167
    v_dot2c_f32_bf16 v9, v167, v167
    s_nop 2
    v_add_f32_dpp v8, v8, v8 row_shr:1 row_mask:0xf bank_mask:0xf bound_ctrl:0
    v_add_f32_dpp v9, v9, v9 row_shr:1 row_mask:0xf bank_mask:0xf bound_ctrl:0
    s_nop 0
    v_add_f32_dpp v8, v8, v8 row_shr:2 row_mask:0xf bank_mask:0xf bound_ctrl:0
    v_add_f32_dpp v9, v9, v9 row_shr:2 row_mask:0xf bank_mask:0xf bound_ctrl:0
    s_nop 0
    v_add_f32_dpp v8, v8, v8 row_shr:4 row_mask:0xf bank_mask:0xf bound_ctrl:0
    v_add_f32_dpp v9, v9, v9 row_shr:4 row_mask:0xf bank_mask:0xf bound_ctrl:0
    s_nop 0
    v_add_f32_dpp v8, v8, v8 row_shr:8 row_mask:0xf bank_mask:0xf bound_ctrl:0
    v_add_f32_dpp v9, v9, v9 row_shr:8 row_mask:0xf bank_mask:0xf bound_ctrl:0
    s_nop 0
    v_add_f32_dpp v8, v8, v8 row_bcast:15 row_mask:0xa bank_mask:0xf
    v_add_f32_dpp v9, v9, v9 row_bcast:15 row_mask:0xa bank_mask:0xf
    s_nop 0
    v_add_f32_dpp v8, v8, v8 row_bcast:31 row_mask:0xc bank_mask:0xf
    v_add_f32_dpp v9, v9, v9 row_bcast:31 row_mask:0xc bank_mask:0xf
    s_nop 0
    v_readlane_b32 s46, v8, 63
    v_readlane_b32 s47, v9, 63
    s_nop 1
    v_mov_b32 v8, s46
    v_mov_b32 v9, s47
    v_cmp_eq_u32 vcc, s62, v2
    s_nop 1
    v_cndmask_b32 v250, v250, v8, vcc
    v_cndmask_b32 v251, v251, v9, vcc
    s_add_u32 s62, s62, 1
    s_cmp_lt_u32 s62, 32
    s_cbranch_scc1 K1_F4_FS1
    v_mov_b32 v232, 0
    v_mov_b32 v233, 0
    v_mov_b32 v234, 0
    v_mov_b32 v235, 0
    v_mov_b32 v236, 0
    v_mov_b32 v237, 0
    v_mov_b32 v238, 0
    v_mov_b32 v239, 0
    v_mov_b32 v240, 0
    v_mov_b32 v241, 0
    v_mov_b32 v242, 0
    v_mov_b32 v243, 0
    v_mov_b32 v244, 0
    v_mov_b32 v245, 0
    v_mov_b32 v246, 0
    v_mov_b32 v247, 0
    s_lshl_b32 s46, s37, 1
    s_add_u32 s46, s46, s58
    v_add_u32 v4, s46, v3
    v_and_b32 v5, 15, v2
    v_lshlrev_b32 v5, 1, v5
    v_lshl_add_u32 v4, v4, 5, v5
    v_mov_b32 v164, s28
    v_mov_b32 v165, s29
    v_mov_b32 v6, s30
    v_mov_b32 v7, s31
    v_cmp_lt_u32 vcc, 15, v2
    s_nop 1
    v_cndmask_b32 v164, v164, v6, vcc
    v_cndmask_b32 v165, v165, v7, vcc
    v_mov_b32 v166, 2752
    v_mov_b32 v167, 0
    v_mov_b32 v5, 0
    v_add_co_u32 v164, vcc, v164, v4
    s_nop 1
    v_addc_co_u32 v165, vcc, v165, v5, vcc
    s_mov_b32 s62, 0
K1_F4_FC0:
    global_load_ushort v6, v[164:165], off
    v_lshl_add_u64 v[164:165], v[166:167], 0, v[164:165]
    s_waitcnt vmcnt(0)
    v_lshlrev_b32 v6, 16, v6
    v_add_f32 v232, v232, v6
    s_add_u32 s62, s62, 1
    s_cmp_lt_u32 s62, 512
    s_cbranch_scc1 K1_F4_FC0
    s_branch K1_F4_HB
K1_F4:
    s_barrier
    ds_read_b128 v[44:47], v24 offset:0
    ds_read_b64_tr_b16 v[52:53], v36 offset:0
    ds_read_b64_tr_b16 v[54:55], v36 offset:512
    ds_read_b128 v[48:51], v28 offset:0
    ds_read_b64_tr_b16 v[56:57], v38 offset:0
    ds_read_b64_tr_b16 v[58:59], v38 offset:512
    s_add_u32 m0, s50, 106496
    s_nop 0
    buffer_load_dwordx4 v16, s[8:11], s40 offen offset:0 lds
    buffer_load_dwordx4 v17, s[8:11], s40 offen offset:1024 lds
    s_waitcnt lgkmcnt(0)
    v_mfma_f32_32x32x16_bf16 v[84:99], v[52:55], v[44:47], 0
    ds_read_b128 v[64:67], v25 offset:0
    ds_read_b64_tr_b16 v[72:73], v36 offset:2048
    ds_read_b64_tr_b16 v[74:75], v36 offset:2560
    ds_read_b128 v[68:71], v29 offset:0
    v_mfma_f32_32x32x16_bf16 v[100:115], v[52:55], v[48:51], 0
    ds_read_b64_tr_b16 v[76:77], v38 offset:2048
    ds_read_b64_tr_b16 v[78:79], v38 offset:2560
    v_mfma_f32_32x32x16_bf16 v[116:131], v[56:59], v[44:47], 0
    buffer_load_dwordx4 v18, s[8:11], s40 offen offset:2048 lds
    buffer_load_dwordx4 v19, s[8:11], s40 offen offset:3072 lds
    s_mul_i32 s46, s38, 2048
    v_add_u32 v4, s46, v36
    ds_read_b64_tr_b16 v[164:165], v4 offset:0
    ds_read_b64_tr_b16 v[166:167], v4 offset:512
    s_mul_i32 s46, s38, 2048
    v_add_u32 v4, s46, v38
    ds_read_b64_tr_b16 v[168:169], v4 offset:0
    ds_read_b64_tr_b16 v[170:171], v4 offset:512
    s_lshl_b32 s46, s38, 9
    v_add_u32 v4, s46, v40
    v_add_u32 v5, s46, v41
    v_mfma_f32_32x32x16_bf16 v[132:147], v[56:59], v[48:51], 0
    ds_read_b64_tr_b16 v[172:173], v4 offset:0
    ds_read_b64_tr_b16 v[174:175], v5 offset:0
    v_mov_b32 v6, 0
    v_mov_b32 v7, 0
    v_mov_b32 v8, 0
    s_mul_i32 s46, s38, 640
    s_lshl_b32 s47, s37, 8
    s_add_u32 s47, s47, s46
    v_lshl_add_u32 v10, v1, 2, s47
    v_lshl_add_u32 v11, v2, 2, s46
    v_add_u32 v10, 159744, v10
    v_add_u32 v11, 160256, v11
    s_waitcnt lgkmcnt(0)
    v_mfma_f32_32x32x16_bf16 v[84:99], v[72:75], v[64:67], v[84:99]
    ds_read_b128 v[44:47], v26 offset:0
    ds_read_b64_tr_b16 v[52:53], v36 offset:4096
    ds_read_b64_tr_b16 v[54:55], v36 offset:4608
    ds_read_b128 v[48:51], v30 offset:0
    v_mfma_f32_32x32x16_bf16 v[100:115], v[72:75], v[68:71], v[100:115]
    ds_read_b64_tr_b16 v[56:57], v38 offset:4096
    ds_read_b64_tr_b16 v[58:59], v38 offset:4608
    v_mfma_f32_32x32x16_bf16 v[116:131], v[76:79], v[64:67], v[116:131]
    s_add_u32 m0, s51, 106496
    s_nop 0
    buffer_load_dwordx4 v225, s[12:15], s41 offen lds
    s_add_u32 m0, s52, 106496
    s_nop 0
    buffer_load_dwordx4 v227, s[16:19], s41 offen lds
    v_dot2c_f32_bf16 v6, s54, v164
    v_dot2c_f32_bf16 v7, s54, v168
    v_dot2c_f32_bf16 v8, s54, v172
    v_mfma_f32_32x32x16_bf16 v[132:147], v[76:79], v[68:71], v[132:147]
    v_dot2c_f32_bf16 v6, s54, v165
    v_dot2c_f32_bf16 v7, s54, v169
    v_dot2c_f32_bf16 v8, s54, v173
    v_dot2c_f32_bf16 v6, s54, v166
    v_dot2c_f32_bf16 v7, s54, v170
    v_dot2c_f32_bf16 v8, s54, v174
    v_dot2c_f32_bf16 v6, s54, v167
    v_dot2c_f32_bf16 v7, s54, v171
    v_dot2c_f32_bf16 v8, s54, v175
    s_waitcnt lgkmcnt(0)
    v_mfma_f32_32x32x16_bf16 v[84:99], v[52:55], v[44:47], v[84:99]
    ds_read_b128 v[64:67], v27 offset:0
    ds_read_b64_tr_b16 v[72:73], v36 offset:6144
    ds_read_b64_tr_b16 v[74:75], v36 offset:6656
    ds_read_b128 v[68:71], v31 offset:0
    v_mfma_f32_32x32x16_bf16 v[100:115], v[52:55], v[48:51], v[100:115]
    ds_read_b64_tr_b16 v[76:77], v38 offset:6144
    ds_read_b64_tr_b16 v[78:79], v38 offset:6656
    v_mfma_f32_32x32x16_bf16 v[116:131], v[56:59], v[44:47], v[116:131]
    s_add_u32 m0, s53, 106496
    s_mov_b32 exec_hi, 0
    buffer_load_dwordx4 v229, s[20:23], s42 offen lds
    s_mov_b32 exec_hi, -1
    s_add_u32 s49, s49, 1
    s_and_b32 s49, s49, 7
    s_lshl_b32 s40, s49, 7
    s_mul_i32 s42, s49, 176128
    s_mov_b32 s41, s42
    v_mfma_f32_32x32x16_bf16 v[132:147], v[56:59], v[48:51], v[132:147]
    v_mov_b32 v9, v8
    s_nop 1
    v_permlane32_swap_b32 v6, v7
    v_permlane32_swap_b32 v8, v9
    s_nop 1
    v_add_f32 v6, v6, v7
    v_add_f32 v8, v8, v9
    ds_write_b32 v10, v6
    ds_write_b32 v11, v8
    s_waitcnt vmcnt(7) lgkmcnt(0)
    s_barrier
    v_mfma_f32_32x32x16_bf16 v[84:99], v[72:75], v[64:67], v[84:99]
    ds_read_b128 v[44:47], v24 offset:53248
    ds_read_b64_tr_b16 v[52:53], v36 offset:53248
    ds_read_b64_tr_b16 v[54:55], v36 offset:53760
    ds_read_b128 v[48:51], v28 offset:53248
    v_mfma_f32_32x32x16_bf16 v[100:115], v[72:75], v[68:71], v[100:115]
    ds_read_b64_tr_b16 v[56:57], v38 offset:53248
    ds_read_b64_tr_b16 v[58:59], v38 offset:53760
    v_mfma_f32_32x32x16_bf16 v[116:131], v[76:79], v[64:67], v[116:131]
    s_add_u32 m0, s50, 0
    s_nop 0
    buffer_load_dwordx4 v16, s[8:11], s40 offen offset:0 lds
    buffer_load_dwordx4 v17, s[8:11], s40 offen offset:1024 lds
    s_lshl_b32 s46, s34, 8
    v_lshl_add_u32 v4, v1, 2, s46
    v_min_u32 v5, 636, v4
    v_add_u32 v5, 159744, v5
    ds_read_b32 v6, v5 offset:0
    ds_read_b32 v7, v5 offset:640
    ds_read_b32 v8, v5 offset:1280
    ds_read_b32 v9, v5 offset:1920
    s_lshl_b32 s46, s48, 3
    s_add_u32 s46, s46, s35
    s_mul_i32 s46, s46, 640
    s_add_u32 s46, s46, 8388608
    v_mfma_f32_32x32x16_bf16 v[132:147], v[76:79], v[68:71], v[132:147]
    v_add_u32 v4, s46, v4
    v_mov_b32 v10, 0
    v_mov_b32 v11, 0
    v_dot2c_f32_bf16 v10, s54, v232
    v_dot2c_f32_bf16 v11, v232, v232
    v_dot2c_f32_bf16 v10, s54, v233
    v_dot2c_f32_bf16 v11, v233, v233
    v_dot2c_f32_bf16 v10, s54, v234
    v_dot2c_f32_bf16 v11, v234, v234
    v_dot2c_f32_bf16 v10, s54, v235
    v_dot2c_f32_bf16 v11, v235, v235
    s_nop 2
    v_add_f32_dpp v10, v10, v10 row_shr:1 row_mask:0xf bank_mask:0xf bound_ctrl:0
    v_add_f32_dpp v11, v11, v11 row_shr:1 row_mask:0xf bank_mask:0xf bound_ctrl:0
    s_nop 0
    s_waitcnt lgkmcnt(0)
    v_mfma_f32_32x32x16_bf16 v[84:99], v[52:55], v[44:47], v[84:99]
    ds_read_b128 v[64:67], v25 offset:53248
    ds_read_b64_tr_b16 v[72:73], v36 offset:55296
    ds_read_b64_tr_b16 v[74:75], v36 offset:55808
    ds_read_b128 v[68:71], v29 offset:53248
    v_mfma_f32_32x32x16_bf16 v[100:115], v[52:55], v[48:51], v[100:115]
    ds_read_b64_tr_b16 v[76:77], v38 offset:55296
    ds_read_b64_tr_b16 v[78:79], v38 offset:55808
    v_mfma_f32_32x32x16_bf16 v[116:131], v[56:59], v[44:47], v[116:131]
    v_add_f32 v6, v6, v7
    v_add_f32 v8, v8, v9
    v_add_f32 v6, v6, v8
    s_cmp_ge_u32 s34, 3
    s_cbranch_scc1 K1_F4_H1
    s_cmp_eq_u32 s34, 2
    s_cselect_b32 exec_hi, 0, -1
    global_store_dword v4, v6, s[32:33] sc1
    s_mov_b32 exec_hi, -1
K1_F4_H1:
    v_add_f32_dpp v10, v10, v10 row_shr:2 row_mask:0xf bank_mask:0xf bound_ctrl:0
    v_add_f32_dpp v11, v11, v11 row_shr:2 row_mask:0xf bank_mask:0xf bound_ctrl:0
    s_nop 0
    v_add_f32_dpp v10, v10, v10 row_shr:4 row_mask:0xf bank_mask:0xf bound_ctrl:0
    v_add_f32_dpp v11, v11, v11 row_shr:4 row_mask:0xf bank_mask:0xf bound_ctrl:0
    s_nop 0
    v_add_f32_dpp v10, v10, v10 row_shr:8 row_mask:0xf bank_mask:0xf bound_ctrl:0
    v_add_f32_dpp v11, v11, v11 row_shr:8 row_mask:0xf bank_mask:0xf bound_ctrl:0
    v_mfma_f32_32x32x16_bf16 v[132:147], v[56:59], v[48:51], v[132:147]
    s_nop 0
    v_add_f32_dpp v10, v10, v10 row_bcast:15 row_mask:0xa bank_mask:0xf
    v_add_f32_dpp v11, v11, v11 row_bcast:15 row_mask:0xa bank_mask:0xf
    s_nop 0
    v_add_f32_dpp v10, v10, v10 row_bcast:31 row_mask:0xc bank_mask:0xf
    v_add_f32_dpp v11, v11, v11 row_bcast:31 row_mask:0xc bank_mask:0xf
    s_nop 0
    v_readlane_b32 s44, v10, 63
    v_readlane_b32 s45, v11, 63
    s_nop 1
    v_mov_b32 v236, s44
    v_mov_b32 v237, s45
    v_mov_b32 v10, s60
    s_mov_b64 exec, 1
    global_store_dwordx2 v10, v[236:237], s[32:33] sc1
    s_mov_b64 exec, -1
    buffer_load_dwordx4 v18, s[8:11], s40 offen offset:2048 lds
    buffer_load_dwordx4 v19, s[8:11], s40 offen offset:3072 lds
    s_waitcnt lgkmcnt(0)
    v_mfma_f32_32x32x16_bf16 v[84:99], v[72:75], v[64:67], v[84:99]
    ds_read_b128 v[44:47], v26 offset:53248
    ds_read_b64_tr_b16 v[52:53], v36 offset:57344
    ds_read_b64_tr_b16 v[54:55], v36 offset:57856
    ds_read_b128 v[48:51], v30 offset:53248
    v_mfma_f32_32x32x16_bf16 v[100:115], v[72:75], v[68:71], v[100:115]
    ds_read_b64_tr_b16 v[56:57], v38 offset:57344
    ds_read_b64_tr_b16 v[58:59], v38 offset:57856
    v_mfma_f32_32x32x16_bf16 v[116:131], v[76:79], v[64:67], v[116:131]
    s_add_u32 m0, s51, 0
    s_nop 0
    buffer_load_dwordx4 v225, s[12:15], s41 offen lds
    v_mfma_f32_32x32x16_bf16 v[132:147], v[76:79], v[68:71], v[132:147]
    s_add_u32 m0, s52, 0
    s_nop 0
    buffer_load_dwordx4 v227, s[16:19], s41 offen lds
    s_waitcnt lgkmcnt(0)
    v_mfma_f32_32x32x16_bf16 v[84:99], v[52:55], v[44:47], v[84:99]
    ds_read_b128 v[64:67], v27 offset:53248
    ds_read_b64_tr_b16 v[72:73], v36 offset:59392
    ds_read_b64_tr_b16 v[74:75], v36 offset:59904
    ds_read_b128 v[68:71], v31 offset:53248
    v_mfma_f32_32x32x16_bf16 v[100:115], v[52:55], v[48:51], v[100:115]
    ds_read_b64_tr_b16 v[76:77], v38 offset:59392
    ds_read_b64_tr_b16 v[78:79], v38 offset:59904
    v_mfma_f32_32x32x16_bf16 v[116:131], v[56:59], v[44:47], v[116:131]
    s_add_u32 m0, s53, 0
    s_mov_b32 exec_hi, 0
    buffer_load_dwordx4 v229, s[20:23], s42 offen lds
    s_mov_b32 exec_hi, -1
    s_add_u32 s49, s49, 1
    s_and_b32 s49, s49, 7
    s_lshl_b32 s40, s49, 7
    s_mul_i32 s42, s49, 176128
    s_mov_b32 s41, s42
    v_add_u32 v24, 106496, v24
    v_add_u32 v25, 106496, v25
    v_mfma_f32_32x32x16_bf16 v[132:147], v[56:59], v[48:51], v[132:147]
    v_add_u32 v26, 106496, v26
    v_add_u32 v27, 106496, v27
    v_add_u32 v28, 106496, v28
    v_add_u32 v29, 106496, v29
    v_add_u32 v30, 106496, v30
    v_add_u32 v31, 106496, v31
    v_add_u32 v36, 106496, v36
    v_add_u32 v40, 106496, v40
    v_add_u32 v41, 106496, v41
    v_add_u32 v38, 106496, v38
    s_waitcnt vmcnt(5) lgkmcnt(0)
    s_barrier
    v_mfma_f32_32x32x16_bf16 v[84:99], v[72:75], v[64:67], v[84:99]
    ds_read_b128 v[44:47], v24 offset:0
    ds_read_b64_tr_b16 v[52:53], v36 offset:0
    ds_read_b64_tr_b16 v[54:55], v36 offset:512
    ds_read_b128 v[48:51], v28 offset:0
    v_mfma_f32_32x32x16_bf16 v[100:115], v[72:75], v[68:71], v[100:115]
    ds_read_b64_tr_b16 v[56:57], v38 offset:0
    ds_read_b64_tr_b16 v[58:59], v38 offset:512
    v_mfma_f32_32x32x16_bf16 v[116:131], v[76:79], v[64:67], v[116:131]
    s_add_u32 m0, s50, 53248
    s_nop 0
    buffer_load_dwordx4 v16, s[8:11], s40 offen offset:0 lds
    buffer_load_dwordx4 v17, s[8:11], s40 offen offset:1024 lds
    s_cmp_lg_u32 s34, 0
    s_cbranch_scc1 K1_F4_H2
    s_lshl_b32 s46, s35, 5
    s_add_u32 s46, s46, s48
    s_and_b32 s47, s46, 3
    s_lshl_b32 s47, s47, 3
    s_lshl_b32 s47, 1, s47
    s_and_b32 s46, s46, 252
    v_mov_b32 v4, s46
    v_mov_b32 v5, s47
    s_mov_b64 exec, 1
    global_atomic_add v4, v5, s[76:77] sc1
    s_mov_b64 exec, -1
K1_F4_H2:
    v_mfma_f32_32x32x16_bf16 v[132:147], v[76:79], v[68:71], v[132:147]
    s_waitcnt lgkmcnt(0)
    v_mfma_f32_32x32x16_bf16 v[84:99], v[52:55], v[44:47], v[84:99]
    ds_read_b128 v[64:67], v25 offset:0
    ds_read_b64_tr_b16 v[72:73], v36 offset:2048
    ds_read_b64_tr_b16 v[74:75], v36 offset:2560
    ds_read_b128 v[68:71], v29 offset:0
    v_mfma_f32_32x32x16_bf16 v[100:115], v[52:55], v[48:51], v[100:115]
    ds_read_b64_tr_b16 v[76:77], v38 offset:2048
    ds_read_b64_tr_b16 v[78:79], v38 offset:2560
    v_mfma_f32_32x32x16_bf16 v[116:131], v[56:59], v[44:47], v[116:131]
    buffer_load_dwordx4 v18, s[8:11], s40 offen offset:2048 lds
    v_mfma_f32_32x32x16_bf16 v[132:147], v[56:59], v[48:51], v[132:147]
    buffer_load_dwordx4 v19, s[8:11], s40 offen offset:3072 lds
    s_waitcnt lgkmcnt(0)
    v_mfma_f32_32x32x16_bf16 v[84:99], v[72:75], v[64:67], v[84:99]
    ds_read_b128 v[44:47], v26 offset:0
    ds_read_b64_tr_b16 v[52:53], v36 offset:4096
    ds_read_b64_tr_b16 v[54:55], v36 offset:4608
    ds_read_b128 v[48:51], v30 offset:0
    v_mfma_f32_32x32x16_bf16 v[100:115], v[72:75], v[68:71], v[100:115]
    ds_read_b64_tr_b16 v[56:57], v38 offset:4096
    ds_read_b64_tr_b16 v[58:59], v38 offset:4608
    v_mfma_f32_32x32x16_bf16 v[116:131], v[76:79], v[64:67], v[116:131]
    s_add_u32 m0, s51, 53248
    s_nop 0
    buffer_load_dwordx4 v225, s[12:15], s41 offen lds
    v_mfma_f32_32x32x16_bf16 v[132:147], v[76:79], v[68:71], v[132:147]
    s_add_u32 m0, s52, 53248
    s_nop 0
    buffer_load_dwordx4 v227, s[16:19], s41 offen lds
    s_waitcnt lgkmcnt(0)
    v_mfma_f32_32x32x16_bf16 v[84:99], v[52:55], v[44:47], v[84:99]
    ds_read_b128 v[64:67], v27 offset:0
    ds_read_b64_tr_b16 v[72:73], v36 offset:6144
    ds_read_b64_tr_b16 v[74:75], v36 offset:6656
    ds_read_b128 v[68:71], v31 offset:0
    v_mfma_f32_32x32x16_bf16 v[100:115], v[52:55], v[48:51], v[100:115]
    ds_read_b64_tr_b16 v[76:77], v38 offset:6144
    ds_read_b64_tr_b16 v[78:79], v38 offset:6656
    v_mfma_f32_32x32x16_bf16 v[116:131], v[56:59], v[44:47], v[116:131]
    s_add_u32 m0, s53, 53248
    s_mov_b32 exec_hi, 0
    buffer_load_dwordx4 v229, s[20:23], s42 offen lds
    s_mov_b32 exec_hi, -1
    s_add_u32 s49, s49, 1
    s_and_b32 s49, s49, 7
    s_lshl_b32 s40, s49, 7
    s_mul_i32 s42, s49, 176128
    s_mov_b32 s41, s42
    v_subrev_u32 v24, 106496, v24
    v_subrev_u32 v25, 106496, v25
    v_mfma_f32_32x32x16_bf16 v[132:147], v[56:59], v[48:51], v[132:147]
    v_subrev_u32 v26, 106496, v26
    v_subrev_u32 v27, 106496, v27
    v_subrev_u32 v28, 106496, v28
    v_subrev_u32 v29, 106496, v29
    v_subrev_u32 v30, 106496, v30
    v_subrev_u32 v31, 106496, v31
    v_subrev_u32 v36, 106496, v36
    v_subrev_u32 v40, 106496, v40
    v_subrev_u32 v41, 106496, v41
    v_subrev_u32 v38, 106496, v38
    s_waitcnt vmcnt(7) lgkmcnt(0)
    s_barrier
    v_mfma_f32_32x32x16_bf16 v[84:99], v[72:75], v[64:67], v[84:99]
    ds_read_b128 v[44:47], v24 offset:0
    ds_read_b64_tr_b16 v[52:53], v36 offset:0
    ds_read_b64_tr_b16 v[54:55], v36 offset:512
    ds_read_b128 v[48:51], v28 offset:0
    v_mfma_f32_32x32x16_bf16 v[100:115], v[72:75], v[68:71], v[100:115]
    ds_read_b64_tr_b16 v[56:57], v38 offset:0
    ds_read_b64_tr_b16 v[58:59], v38 offset:512
    v_mfma_f32_32x32x16_bf16 v[116:131], v[76:79], v[64:67], v[116:131]
    s_add_u32 m0, s50, 106496
    s_nop 0
    buffer_load_dwordx4 v16, s[8:11], s40 offen offset:0 lds
    v_mfma_f32_32x32x16_bf16 v[132:147], v[76:79], v[68:71], v[132:147]
    buffer_load_dwordx4 v17, s[8:11], s40 offen offset:1024 lds
    s_waitcnt lgkmcnt(0)
    v_mfma_f32_32x32x16_bf16 v[84:99], v[52:55], v[44:47], v[84:99]
    ds_read_b128 v[64:67], v25 offset:0
    ds_read_b64_tr_b16 v[72:73], v36 offset:2048
    ds_read_b64_tr_b16 v[74:75], v36 offset:2560
    ds_read_b128 v[68:71], v29 offset:0
    v_mfma_f32_32x32x16_bf16 v[100:115], v[52:55], v[48:51], v[100:115]
    ds_read_b64_tr_b16 v[76:77], v38 offset:2048
    ds_read_b64_tr_b16 v[78:79], v38 offset:2560
    v_mfma_f32_32x32x16_bf16 v[116:131], v[56:59], v[44:47], v[116:131]
    buffer_load_dwordx4 v18, s[8:11], s40 offen offset:2048 lds
    v_mfma_f32_32x32x16_bf16 v[132:147], v[56:59], v[48:51], v[132:147]
    buffer_load_dwordx4 v19, s[8:11], s40 offen offset:3072 lds
    s_waitcnt lgkmcnt(0)
    v_mfma_f32_32x32x16_bf16 v[84:99], v[72:75], v[64:67], v[84:99]
    ds_read_b128 v[44:47], v26 offset:0
    ds_read_b64_tr_b16 v[52:53], v36 offset:4096
    ds_read_b64_tr_b16 v[54:55], v36 offset:4608
    ds_read_b128 v[48:51], v30 offset:0
    v_mfma_f32_32x32x16_bf16 v[100:115], v[72:75], v[68:71], v[100:115]
    ds_read_b64_tr_b16 v[56:57], v38 offset:4096
    ds_read_b64_tr_b16 v[58:59], v38 offset:4608
    v_mfma_f32_32x32x16_bf16 v[116:131], v[76:79], v[64:67], v[116:131]
    s_add_u32 m0, s51, 106496
    s_nop 0
    buffer_load_dwordx4 v225, s[12:15], s41 offen lds
    v_mfma_f32_32x32x16_bf16 v[132:147], v[76:79], v[68:71], v[132:147]
    s_add_u32 m0, s52, 106496
    s_nop 0
    buffer_load_dwordx4 v227, s[16:19], s41 offen lds
    s_waitcnt lgkmcnt(0)
    v_mfma_f32_32x32x16_bf16 v[84:99], v[52:55], v[44:47], v[84:99]
    ds_read_b128 v[64:67], v27 offset:0
    ds_read_b64_tr_b16 v[72:73], v36 offset:6144
    ds_read_b64_tr_b16 v[74:75], v36 offset:6656
    ds_read_b128 v[68:71], v31 offset:0
    v_mfma_f32_32x32x16_bf16 v[100:115], v[52:55], v[48:51], v[100:115]
    ds_read_b64_tr_b16 v[76:77], v38 offset:6144
    ds_read_b64_tr_b16 v[78:79], v38 offset:6656
    v_mfma_f32_32x32x16_bf16 v[116:131], v[56:59], v[44:47], v[116:131]
    s_add_u32 m0, s53, 106496
    s_mov_b32 exec_hi, 0
    buffer_load_dwordx4 v229, s[20:23], s42 offen lds
    s_mov_b32 exec_hi, -1
    s_add_u32 s49, s49, 1
    s_and_b32 s49, s49, 7
    s_lshl_b32 s40, s49, 7
    s_mul_i32 s42, s49, 176128
    s_mov_b32 s41, s42
    v_mfma_f32_32x32x16_bf16 v[132:147], v[56:59], v[48:51], v[132:147]
    s_waitcnt vmcnt(7) lgkmcnt(0)
    s_barrier
    v_mfma_f32_32x32x16_bf16 v[84:99], v[72:75], v[64:67], v[84:99]
    ds_read_b128 v[44:47], v24 offset:53248
    ds_read_b64_tr_b16 v[52:53], v36 offset:53248
    ds_read_b64_tr_b16 v[54:55], v36 offset:53760
    ds_read_b128 v[48:51], v28 offset:53248
    v_mfma_f32_32x32x16_bf16 v[100:115], v[72:75], v[68:71], v[100:115]
    ds_read_b64_tr_b16 v[56:57], v38 offset:53248
    ds_read_b64_tr_b16 v[58:59], v38 offset:53760
    v_mfma_f32_32x32x16_bf16 v[116:131], v[76:79], v[64:67], v[116:131]
    s_add_u32 m0, s50, 0
    s_nop 0
    buffer_load_dwordx4 v16, s[8:11], s40 offen offset:0 lds
    v_mfma_f32_32x32x16_bf16 v[132:147], v[76:79], v[68:71], v[132:147]
    buffer_load_dwordx4 v17, s[8:11], s40 offen offset:1024 lds
    s_waitcnt lgkmcnt(0)
    v_mfma_f32_32x32x16_bf16 v[84:99], v[52:55], v[44:47], v[84:99]
    ds_read_b128 v[64:67], v25 offset:53248
    ds_read_b64_tr_b16 v[72:73], v36 offset:55296
    ds_read_b64_tr_b16 v[74:75], v36 offset:55808
    ds_read_b128 v[68:71], v29 offset:53248
    v_mfma_f32_32x32x16_bf16 v[100:115], v[52:55], v[48:51], v[100:115]
    ds_read_b64_tr_b16 v[76:77], v38 offset:55296
    ds_read_b64_tr_b16 v[78:79], v38 offset:55808
    v_mfma_f32_32x32x16_bf16 v[116:131], v[56:59], v[44:47], v[116:131]
    buffer_load_dwordx4 v18, s[8:11], s40 offen offset:2048 lds
    v_mfma_f32_32x32x16_bf16 v[132:147], v[56:59], v[48:51], v[132:147]
    buffer_load_dwordx4 v19, s[8:11], s40 offen offset:3072 lds
    s_waitcnt lgkmcnt(0)
    v_mfma_f32_32x32x16_bf16 v[84:99], v[72:75], v[64:67], v[84:99]
    ds_read_b128 v[44:47], v26 offset:53248
    ds_read_b64_tr_b16 v[52:53], v36 offset:57344
    ds_read_b64_tr_b16 v[54:55], v36 offset:57856
    ds_read_b128 v[48:51], v30 offset:53248
    v_mfma_f32_32x32x16_bf16 v[100:115], v[72:75], v[68:71], v[100:115]
    ds_read_b64_tr_b16 v[56:57], v38 offset:57344
    ds_read_b64_tr_b16 v[58:59], v38 offset:57856
    v_mfma_f32_32x32x16_bf16 v[116:131], v[76:79], v[64:67], v[116:131]
    s_add_u32 m0, s51, 0
    s_nop 0
    buffer_load_dwordx4 v225, s[12:15], s41 offen lds
    v_mfma_f32_32x32x16_bf16 v[132:147], v[76:79], v[68:71], v[132:147]
    s_add_u32 m0, s52, 0
    s_nop 0
    buffer_load_dwordx4 v227, s[16:19], s41 offen lds
    s_waitcnt lgkmcnt(0)
    v_mfma_f32_32x32x16_bf16 v[84:99], v[52:55], v[44:47], v[84:99]
    ds_read_b128 v[64:67], v27 offset:53248
    ds_read_b64_tr_b16 v[72:73], v36 offset:59392
    ds_read_b64_tr_b16 v[74:75], v36 offset:59904
    ds_read_b128 v[68:71], v31 offset:53248
    v_mfma_f32_32x32x16_bf16 v[100:115], v[52:55], v[48:51], v[100:115]
    ds_read_b64_tr_b16 v[76:77], v38 offset:59392
    ds_read_b64_tr_b16 v[78:79], v38 offset:59904
    v_mfma_f32_32x32x16_bf16 v[116:131], v[56:59], v[44:47], v[116:131]
    s_add_u32 m0, s53, 0
    s_mov_b32 exec_hi, 0
    buffer_load_dwordx4 v229, s[20:23], s42 offen lds
    s_mov_b32 exec_hi, -1
    s_add_u32 s49, s49, 1
    s_and_b32 s49, s49, 7
    s_lshl_b32 s40, s49, 7
    s_mul_i32 s42, s49, 176128
    s_mov_b32 s41, s42
    s_cmp_lg_u32 s34, 5
    s_cbranch_scc1 K1_F4_P1
    v_lshlrev_b32 v4, 2, v1
    global_load_dword v223, v4, s[76:77] sc1
K1_F4_P1:
    v_mfma_f32_32x32x16_bf16 v[132:147], v[56:59], v[48:51], v[132:147]
    v_add_u32 v24, 106496, v24
    v_add_u32 v25, 106496, v25
    v_add_u32 v26, 106496, v26
    v_add_u32 v27, 106496, v27
    v_add_u32 v28, 106496, v28
    v_add_u32 v29, 106496, v29
    v_add_u32 v30, 106496, v30
    v_add_u32 v31, 106496, v31
    v_add_u32 v36, 106496, v36
    v_add_u32 v40, 106496, v40
    v_add_u32 v41, 106496, v41
    v_add_u32 v38, 106496, v38
    s_waitcnt vmcnt(7) lgkmcnt(0)
    s_barrier
    v_mfma_f32_32x32x16_bf16 v[84:99], v[72:75], v[64:67], v[84:99]
    ds_read_b128 v[44:47], v24 offset:0
    ds_read_b64_tr_b16 v[52:53], v36 offset:0
    ds_read_b64_tr_b16 v[54:55], v36 offset:512
    ds_read_b128 v[48:51], v28 offset:0
    v_mfma_f32_32x32x16_bf16 v[100:115], v[72:75], v[68:71], v[100:115]
    ds_read_b64_tr_b16 v[56:57], v38 offset:0
    ds_read_b64_tr_b16 v[58:59], v38 offset:512
    v_mfma_f32_32x32x16_bf16 v[116:131], v[76:79], v[64:67], v[116:131]
    s_add_u32 m0, s50, 53248
    s_nop 0
    buffer_load_dwordx4 v16, s[8:11], s40 offen offset:0 lds
    v_mfma_f32_32x32x16_bf16 v[132:147], v[76:79], v[68:71], v[132:147]
    buffer_load_dwordx4 v17, s[8:11], s40 offen offset:1024 lds
    s_waitcnt lgkmcnt(0)
    v_mfma_f32_32x32x16_bf16 v[84:99], v[52:55], v[44:47], v[84:99]
    ds_read_b128 v[64:67], v25 offset:0
    ds_read_b64_tr_b16 v[72:73], v36 offset:2048
    ds_read_b64_tr_b16 v[74:75], v36 offset:2560
    ds_read_b128 v[68:71], v29 offset:0
    v_mfma_f32_32x32x16_bf16 v[100:115], v[52:55], v[48:51], v[100:115]
    ds_read_b64_tr_b16 v[76:77], v38 offset:2048
    ds_read_b64_tr_b16 v[78:79], v38 offset:2560
    v_mfma_f32_32x32x16_bf16 v[116:131], v[56:59], v[44:47], v[116:131]
    buffer_load_dwordx4 v18, s[8:11], s40 offen offset:2048 lds
    v_mfma_f32_32x32x16_bf16 v[132:147], v[56:59], v[48:51], v[132:147]
    buffer_load_dwordx4 v19, s[8:11], s40 offen offset:3072 lds
    s_waitcnt lgkmcnt(0)
    v_mfma_f32_32x32x16_bf16 v[84:99], v[72:75], v[64:67], v[84:99]
    ds_read_b128 v[44:47], v26 offset:0
    ds_read_b64_tr_b16 v[52:53], v36 offset:4096
    ds_read_b64_tr_b16 v[54:55], v36 offset:4608
    ds_read_b128 v[48:51], v30 offset:0
    v_mfma_f32_32x32x16_bf16 v[100:115], v[72:75], v[68:71], v[100:115]
    ds_read_b64_tr_b16 v[56:57], v38 offset:4096
    ds_read_b64_tr_b16 v[58:59], v38 offset:4608
    v_mfma_f32_32x32x16_bf16 v[116:131], v[76:79], v[64:67], v[116:131]
    s_add_u32 m0, s51, 53248
    s_nop 0
    buffer_load_dwordx4 v225, s[12:15], s41 offen lds
    v_mfma_f32_32x32x16_bf16 v[132:147], v[76:79], v[68:71], v[132:147]
    s_add_u32 m0, s52, 53248
    s_nop 0
    buffer_load_dwordx4 v227, s[16:19], s41 offen lds
    s_waitcnt lgkmcnt(0)
    v_mfma_f32_32x32x16_bf16 v[84:99], v[52:55], v[44:47], v[84:99]
    ds_read_b128 v[64:67], v27 offset:0
    ds_read_b64_tr_b16 v[72:73], v36 offset:6144
    ds_read_b64_tr_b16 v[74:75], v36 offset:6656
    ds_read_b128 v[68:71], v31 offset:0
    v_mfma_f32_32x32x16_bf16 v[100:115], v[52:55], v[48:51], v[100:115]
    ds_read_b64_tr_b16 v[76:77], v38 offset:6144
    ds_read_b64_tr_b16 v[78:79], v38 offset:6656
    v_mfma_f32_32x32x16_bf16 v[116:131], v[56:59], v[44:47], v[116:131]
    s_add_u32 m0, s53, 53248
    s_mov_b32 exec_hi, 0
    buffer_load_dwordx4 v229, s[20:23], s42 offen lds
    s_mov_b32 exec_hi, -1
    s_cmp_lg_u32 s34, 5
    s_cbranch_scc1 K1_F4_P2
    s_waitcnt vmcnt(7)
    v_and_b32 v11, v223, v221
    v_cmp_ne_u32 vcc, v11, v221
    v_mov_b32 v4, 162816
    v_mov_b32 v5, 0
    s_nop 2
    s_cbranch_vccnz K1_F4_SLOW
K1_F4_RDY:
    ds_write_b32 v4, v5
K1_F4_P2:
    v_mfma_f32_32x32x16_bf16 v[132:147], v[56:59], v[48:51], v[132:147]
    v_subrev_u32 v24, 106496, v24
    v_subrev_u32 v25, 106496, v25
    v_subrev_u32 v26, 106496, v26
    v_subrev_u32 v27, 106496, v27
    v_subrev_u32 v28, 106496, v28
    v_subrev_u32 v29, 106496, v29
    v_subrev_u32 v30, 106496, v30
    v_subrev_u32 v31, 106496, v31
    v_subrev_u32 v36, 106496, v36
    v_subrev_u32 v40, 106496, v40
    v_subrev_u32 v41, 106496, v41
    v_subrev_u32 v38, 106496, v38
    s_waitcnt vmcnt(7) lgkmcnt(0)
    s_barrier
    v_mfma_f32_32x32x16_bf16 v[84:99], v[72:75], v[64:67], v[84:99]
    ds_read_b128 v[44:47], v24 offset:0
    ds_read_b64_tr_b16 v[52:53], v36 offset:0
    ds_read_b64_tr_b16 v[54:55], v36 offset:512
    ds_read_b128 v[48:51], v28 offset:0
    v_mfma_f32_32x32x16_bf16 v[100:115], v[72:75], v[68:71], v[100:115]
    ds_read_b64_tr_b16 v[56:57], v38 offset:0
    ds_read_b64_tr_b16 v[58:59], v38 offset:512
    v_mfma_f32_32x32x16_bf16 v[116:131], v[76:79], v[64:67], v[116:131]
    v_mov_b32 v11, 162816
    ds_read_b32 v11, v11
    s_mul_i32 s46, s48, 5120
    s_add_u32 s46, s46, 8388608
    s_lshl_b32 s47, s37, 8
    s_add_u32 s47, s47, s46
    v_lshl_add_u32 v4, v1, 2, s47
    v_add_u32 v6, 2560, v4
    s_lshl_b32 s46, s35, 8
    v_mfma_f32_32x32x16_bf16 v[132:147], v[76:79], v[68:71], v[132:147]
    s_lshl_b32 s47, s38, 6
    s_add_u32 s46, s46, s47
    s_lshl_b32 s47, s37, 5
    s_add_u32 s46, s46, s47
    v_add_u32 v8, s46, v2
    v_lshlrev_b32 v8, 3, v8
    v_add_u32 v8, 9437184, v8
    v_xor_b32 v9, 256, v8
    s_waitcnt lgkmcnt(0)
    v_mfma_f32_32x32x16_bf16 v[84:99], v[52:55], v[44:47], v[84:99]
    ds_read_b128 v[64:67], v25 offset:0
    ds_read_b64_tr_b16 v[72:73], v36 offset:2048
    ds_read_b64_tr_b16 v[74:75], v36 offset:2560
    ds_read_b128 v[68:71], v29 offset:0
    v_mfma_f32_32x32x16_bf16 v[100:115], v[52:55], v[48:51], v[100:115]
    ds_read_b64_tr_b16 v[76:77], v38 offset:2048
    ds_read_b64_tr_b16 v[78:79], v38 offset:2560
    v_mfma_f32_32x32x16_bf16 v[116:131], v[56:59], v[44:47], v[116:131]
    v_readfirstlane_b32 s46, v11
    s_nop 3
    s_cmp_lg_u32 s46, 0
    s_cbranch_scc1 K1_F4_FB
    global_load_dword v232, v4, s[32:33] offset:0 sc1
    global_load_dword v233, v4, s[32:33] offset:640 sc1
    global_load_dword v234, v4, s[32:33] offset:1280 sc1
    global_load_dword v235, v4, s[32:33] offset:1920 sc1
    global_load_dword v236, v6, s[32:33] offset:0 sc1
    global_load_dword v237, v6, s[32:33] offset:640 sc1
    global_load_dword v238, v6, s[32:33] offset:1280 sc1
    global_load_dword v239, v6, s[32:33] offset:1920 sc1
    global_load_dwordx2 v[248:249], v8, s[32:33] sc1
    global_load_dwordx2 v[250:251], v9, s[32:33] sc1
K1_F4_HB:
    v_mfma_f32_32x32x16_bf16 v[132:147], v[56:59], v[48:51], v[132:147]
    s_waitcnt lgkmcnt(0)
    v_mfma_f32_32x32x16_bf16 v[84:99], v[72:75], v[64:67], v[84:99]
    ds_read_b128 v[44:47], v26 offset:0
    ds_read_b64_tr_b16 v[52:53], v36 offset:4096
    ds_read_b64_tr_b16 v[54:55], v36 offset:4608
    ds_read_b128 v[48:51], v30 offset:0
    v_mfma_f32_32x32x16_bf16 v[100:115], v[72:75], v[68:71], v[100:115]
    ds_read_b64_tr_b16 v[56:57], v38 offset:4096
    ds_read_b64_tr_b16 v[58:59], v38 offset:4608
    v_mfma_f32_32x32x16_bf16 v[116:131], v[76:79], v[64:67], v[116:131]
    global_load_dword v15, v199, s[70:71]
    v_mfma_f32_32x32x16_bf16 v[132:147], v[76:79], v[68:71], v[132:147]
    global_load_dword v15, v196, s[70:71]
    s_waitcnt lgkmcnt(0)
    v_mfma_f32_32x32x16_bf16 v[84:99], v[52:55], v[44:47], v[84:99]
    ds_read_b128 v[64:67], v27 offset:0
    ds_read_b64_tr_b16 v[72:73], v36 offset:6144
    ds_read_b64_tr_b16 v[74:75], v36 offset:6656
    ds_read_b128 v[68:71], v31 offset:0
    v_mfma_f32_32x32x16_bf16 v[100:115], v[52:55], v[48:51], v[100:115]
    ds_read_b64_tr_b16 v[76:77], v38 offset:6144
    ds_read_b64_tr_b16 v[78:79], v38 offset:6656
    v_mfma_f32_32x32x16_bf16 v[116:131], v[56:59], v[44:47], v[116:131]
    v_mfma_f32_32x32x16_bf16 v[132:147], v[56:59], v[48:51], v[132:147]
    s_waitcnt vmcnt(12) lgkmcnt(0)
    s_barrier
    v_mfma_f32_32x32x16_bf16 v[84:99], v[72:75], v[64:67], v[84:99]
    ds_read_b128 v[44:47], v24 offset:53248
    ds_read_b64_tr_b16 v[52:53], v36 offset:53248
    ds_read_b64_tr_b16 v[54:55], v36 offset:53760
    ds_read_b128 v[48:51], v28 offset:53248
    v_mfma_f32_32x32x16_bf16 v[100:115], v[72:75], v[68:71], v[100:115]
    ds_read_b64_tr_b16 v[56:57], v38 offset:53248
    ds_read_b64_tr_b16 v[58:59], v38 offset:53760
    v_mfma_f32_32x32x16_bf16 v[116:131], v[76:79], v[64:67], v[116:131]
    s_cmp_lt_u32 s34, 4
    s_cbranch_scc1 K1_F4_PR
    s_setprio 1
K1_F4_PR:
    v_mfma_f32_32x32x16_bf16 v[132:147], v[76:79], v[68:71], v[132:147]
    s_waitcnt lgkmcnt(0)
    v_mfma_f32_32x32x16_bf16 v[84:99], v[52:55], v[44:47], v[84:99]
    ds_read_b128 v[64:67], v25 offset:53248
    ds_read_b64_tr_b16 v[72:73], v36 offset:55296
    ds_read_b64_tr_b16 v[74:75], v36 offset:55808
    ds_read_b128 v[68:71], v29 offset:53248
    v_mfma_f32_32x32x16_bf16 v[100:115], v[52:55], v[48:51], v[100:115]
    ds_read_b64_tr_b16 v[76:77], v38 offset:55296
    ds_read_b64_tr_b16 v[78:79], v38 offset:55808
    v_mfma_f32_32x32x16_bf16 v[116:131], v[56:59], v[44:47], v[116:131]
    s_waitcnt vmcnt(2)
    v_add_f32 v232, v232, v233
    v_add_f32 v234, v234, v235
    v_add_f32 v236, v236, v237
    v_add_f32 v238, v238, v239
    v_add_f32 v232, v232, v234
    v_mfma_f32_32x32x16_bf16 v[132:147], v[56:59], v[48:51], v[132:147]
    v_add_f32 v236, v236, v238
    v_add_f32 v232, v232, v236
    s_lshl_b32 s47, s34, 9
    v_lshl_add_u32 v8, v1, 2, s47
    v_lshl_add_u32 v9, v3, 4, s47
    ds_write_b32 v8, v232
    s_waitcnt lgkmcnt(0)
    v_mfma_f32_32x32x16_bf16 v[84:99], v[72:75], v[64:67], v[84:99]
    ds_read_b128 v[44:47], v26 offset:53248
    ds_read_b64_tr_b16 v[52:53], v36 offset:57344
    ds_read_b64_tr_b16 v[54:55], v36 offset:57856
    ds_read_b128 v[48:51], v30 offset:53248
    v_mfma_f32_32x32x16_bf16 v[100:115], v[72:75], v[68:71], v[100:115]
    ds_read_b64_tr_b16 v[56:57], v38 offset:57344
    ds_read_b64_tr_b16 v[58:59], v38 offset:57856
    v_mfma_f32_32x32x16_bf16 v[116:131], v[76:79], v[64:67], v[116:131]
    ds_read_b128 v[164:167], v9 offset:0
    ds_read_b128 v[168:171], v9 offset:32
    ds_read_b128 v[172:175], v9 offset:64
    ds_read_b128 v[176:179], v9 offset:96
    v_mfma_f32_32x32x16_bf16 v[132:147], v[76:79], v[68:71], v[132:147]
    ds_read_b128 v[180:183], v9 offset:128
    ds_read_b128 v[184:187], v9 offset:160
    ds_read_b128 v[188:191], v9 offset:192
    ds_read_b128 v[192:195], v9 offset:224
    s_waitcnt lgkmcnt(0)
    v_mfma_f32_32x32x16_bf16 v[84:99], v[52:55], v[44:47], v[84:99]
    ds_read_b128 v[64:67], v27 offset:53248
    ds_read_b64_tr_b16 v[72:73], v36 offset:59392
    ds_read_b64_tr_b16 v[74:75], v36 offset:59904
    ds_read_b128 v[68:71], v31 offset:53248
    v_mfma_f32_32x32x16_bf16 v[100:115], v[52:55], v[48:51], v[100:115]
    ds_read_b64_tr_b16 v[76:77], v38 offset:59392
    ds_read_b64_tr_b16 v[78:79], v38 offset:59904
    v_mfma_f32_32x32x16_bf16 v[116:131], v[56:59], v[44:47], v[116:131]
    s_mov_b32 s47, 0x3b000000
    v_mul_f32 v212, 0xbb000000, v248
    v_mul_f32 v12, v212, v212
    v_fma_f32 v12, v249, s47, -v12
    v_max_f32 v12, 0, v12
    v_add_f32 v213, 0x3727c5ac, v12
    v_rsq_f32 v218, v213
    s_nop 0
    v_mul_f32 v224, 0xbfb8aa3b, v218
    v_mfma_f32_32x32x16_bf16 v[132:147], v[56:59], v[48:51], v[132:147]
    v_mul_f32 v214, 0xbb000000, v250
    v_mul_f32 v12, v214, v214
    v_fma_f32 v12, v251, s47, -v12
    v_max_f32 v12, 0, v12
    v_add_f32 v215, 0x3727c5ac, v12
    v_rsq_f32 v220, v215
    s_nop 0
    v_mul_f32 v226, 0xbfb8aa3b, v220
    s_waitcnt lgkmcnt(0)
    v_mfma_f32_32x32x16_bf16 v[84:99], v[72:75], v[64:67], v[84:99]
    v_mfma_f32_32x32x16_bf16 v[100:115], v[72:75], v[68:71], v[100:115]
    v_mfma_f32_32x32x16_bf16 v[116:131], v[76:79], v[64:67], v[116:131]
    v_mfma_f32_32x32x16_bf16 v[132:147], v[76:79], v[68:71], v[132:147]
    s_nop 7
    s_lshl_b32 s60, s35, 2
    s_add_u32 s60, s60, s38
    s_mul_i32 s60, s60, 241664
    s_lshl_b32 s47, s37, 10
    s_add_u32 s60, s60, s47
    s_xor_b32 s61, s60, 1024
    s_lshl_b32 s46, s37, 1
    s_add_u32 s46, s46, s58
    s_add_u32 s46, s46, 32
    s_lshl_b32 s46, s46, 11
    s_add_u32 s62, s60, s46
    s_add_u32 s63, s61, s46
    s_add_u32 s64, s62, 2048
    s_add_u32 s65, s63, 2048
    s_add_u32 s46, s57, 32
    s_lshl_b32 s46, s46, 11
    s_add_u32 s66, s60, s46
    v_pk_fma_f32 v[84:85], v[212:213], v[164:165], v[84:85] op_sel:[0,0,0] op_sel_hi:[0,1,1]
    v_pk_fma_f32 v[86:87], v[212:213], v[166:167], v[86:87] op_sel:[0,0,0] op_sel_hi:[0,1,1]
    v_pk_fma_f32 v[88:89], v[212:213], v[168:169], v[88:89] op_sel:[0,0,0] op_sel_hi:[0,1,1]
    v_pk_fma_f32 v[90:91], v[212:213], v[170:171], v[90:91] op_sel:[0,0,0] op_sel_hi:[0,1,1]
    v_pk_fma_f32 v[92:93], v[212:213], v[172:173], v[92:93] op_sel:[0,0,0] op_sel_hi:[0,1,1]
    v_pk_fma_f32 v[94:95], v[212:213], v[174:175], v[94:95] op_sel:[0,0,0] op_sel_hi:[0,1,1]
    v_pk_fma_f32 v[96:97], v[212:213], v[176:177], v[96:97] op_sel:[0,0,0] op_sel_hi:[0,1,1]
    v_pk_fma_f32 v[98:99], v[212:213], v[178:179], v[98:99] op_sel:[0,0,0] op_sel_hi:[0,1,1]
    v_pk_mul_f32 v[232:233], v[224:225], v[84:85] op_sel:[0,0] op_sel_hi:[0,1]
    v_pk_mul_f32 v[234:235], v[224:225], v[86:87] op_sel:[0,0] op_sel_hi:[0,1]
    v_pk_mul_f32 v[236:237], v[224:225], v[88:89] op_sel:[0,0] op_sel_hi:[0,1]
    v_pk_mul_f32 v[238:239], v[224:225], v[90:91] op_sel:[0,0] op_sel_hi:[0,1]
    v_exp_f32 v232, v232
    v_exp_f32 v233, v233
    v_exp_f32 v234, v234
    v_exp_f32 v235, v235
    v_exp_f32 v236, v236
    v_exp_f32 v237, v237
    v_exp_f32 v238, v238
    v_exp_f32 v239, v239
    v_pk_mul_f32 v[84:85], v[84:85], v[92:93] op_sel:[0,0] op_sel_hi:[1,1]
    v_pk_mul_f32 v[86:87], v[86:87], v[94:95] op_sel:[0,0] op_sel_hi:[1,1]
    v_pk_mul_f32 v[88:89], v[88:89], v[96:97] op_sel:[0,0] op_sel_hi:[1,1]
    v_pk_mul_f32 v[90:91], v[90:91], v[98:99] op_sel:[0,0] op_sel_hi:[1,1]
    v_fma_f32 v232, v232, v213, v213
    v_fma_f32 v233, v233, v213, v213
    v_fma_f32 v234, v234, v213, v213
    v_fma_f32 v235, v235, v213, v213
    v_fma_f32 v236, v236, v213, v213
    v_fma_f32 v237, v237, v213, v213
    v_fma_f32 v238, v238, v213, v213
    v_fma_f32 v239, v239, v213, v213
    v_rcp_f32 v232, v232
    v_rcp_f32 v233, v233
    v_rcp_f32 v234, v234
    v_rcp_f32 v235, v235
    v_rcp_f32 v236, v236
    v_rcp_f32 v237, v237
    v_rcp_f32 v238, v238
    v_rcp_f32 v239, v239
    s_nop 0
    v_pk_mul_f32 v[84:85], v[84:85], v[232:233] op_sel:[0,0] op_sel_hi:[1,1]
    v_pk_mul_f32 v[86:87], v[86:87], v[234:235] op_sel:[0,0] op_sel_hi:[1,1]
    v_pk_mul_f32 v[88:89], v[88:89], v[236:237] op_sel:[0,0] op_sel_hi:[1,1]
    v_pk_mul_f32 v[90:91], v[90:91], v[238:239] op_sel:[0,0] op_sel_hi:[1,1]
    v_cvt_pk_bf16_f32 v92, v84, v85
    v_cvt_pk_bf16_f32 v93, v86, v87
    v_cvt_pk_bf16_f32 v94, v88, v89
    v_cvt_pk_bf16_f32 v95, v90, v91
    buffer_store_dwordx4 v[92:95], v219, s[24:27], s62 offen sc0 sc1
    v_pk_fma_f32 v[100:101], v[214:215], v[164:165], v[100:101] op_sel:[0,0,0] op_sel_hi:[0,1,1]
    v_pk_fma_f32 v[102:103], v[214:215], v[166:167], v[102:103] op_sel:[0,0,0] op_sel_hi:[0,1,1]
    v_pk_fma_f32 v[104:105], v[214:215], v[168:169], v[104:105] op_sel:[0,0,0] op_sel_hi:[0,1,1]
    v_pk_fma_f32 v[106:107], v[214:215], v[170:171], v[106:107] op_sel:[0,0,0] op_sel_hi:[0,1,1]
    v_pk_fma_f32 v[108:109], v[214:215], v[172:173], v[108:109] op_sel:[0,0,0] op_sel_hi:[0,1,1]
    v_pk_fma_f32 v[110:111], v[214:215], v[174:175], v[110:111] op_sel:[0,0,0] op_sel_hi:[0,1,1]
    v_pk_fma_f32 v[112:113], v[214:215], v[176:177], v[112:113] op_sel:[0,0,0] op_sel_hi:[0,1,1]
    v_pk_fma_f32 v[114:115], v[214:215], v[178:179], v[114:115] op_sel:[0,0,0] op_sel_hi:[0,1,1]
    v_pk_mul_f32 v[232:233], v[226:227], v[100:101] op_sel:[0,0] op_sel_hi:[0,1]
    v_pk_mul_f32 v[234:235], v[226:227], v[102:103] op_sel:[0,0] op_sel_hi:[0,1]
    v_pk_mul_f32 v[236:237], v[226:227], v[104:105] op_sel:[0,0] op_sel_hi:[0,1]
    v_pk_mul_f32 v[238:239], v[226:227], v[106:107] op_sel:[0,0] op_sel_hi:[0,1]
    v_exp_f32 v232, v232
    v_exp_f32 v233, v233
    v_exp_f32 v234, v234
    v_exp_f32 v235, v235
    v_exp_f32 v236, v236
    v_exp_f32 v237, v237
    v_exp_f32 v238, v238
    v_exp_f32 v239, v239
    v_pk_mul_f32 v[100:101], v[100:101], v[108:109] op_sel:[0,0] op_sel_hi:[1,1]
    v_pk_mul_f32 v[102:103], v[102:103], v[110:111] op_sel:[0,0] op_sel_hi:[1,1]
    v_pk_mul_f32 v[104:105], v[104:105], v[112:113] op_sel:[0,0] op_sel_hi:[1,1]
    v_pk_mul_f32 v[106:107], v[106:107], v[114:115] op_sel:[0,0] op_sel_hi:[1,1]
    v_fma_f32 v232, v232, v215, v215
    v_fma_f32 v233, v233, v215, v215
    v_fma_f32 v234, v234, v215, v215
    v_fma_f32 v235, v235, v215, v215
    v_fma_f32 v236, v236, v215, v215
    v_fma_f32 v237, v237, v215, v215
    v_fma_f32 v238, v238, v215, v215
    v_fma_f32 v239, v239, v215, v215
    v_rcp_f32 v232, v232
    v_rcp_f32 v233, v233
    v_rcp_f32 v234, v234
    v_rcp_f32 v235, v235
    v_rcp_f32 v236, v236
    v_rcp_f32 v237, v237
    v_rcp_f32 v238, v238
    v_rcp_f32 v239, v239
    s_nop 0
    v_pk_mul_f32 v[100:101], v[100:101], v[232:233] op_sel:[0,0] op_sel_hi:[1,1]
    v_pk_mul_f32 v[102:103], v[102:103], v[234:235] op_sel:[0,0] op_sel_hi:[1,1]
    v_pk_mul_f32 v[104:105], v[104:105], v[236:237] op_sel:[0,0] op_sel_hi:[1,1]
    v_pk_mul_f32 v[106:107], v[106:107], v[238:239] op_sel:[0,0] op_sel_hi:[1,1]
    v_cvt_pk_bf16_f32 v108, v100, v101
    v_cvt_pk_bf16_f32 v109, v102, v103
    v_cvt_pk_bf16_f32 v110, v104, v105
    v_cvt_pk_bf16_f32 v111, v106, v107
    buffer_store_dwordx4 v[108:111], v219, s[24:27], s63 offen sc0 sc1
    v_pk_fma_f32 v[116:117], v[212:213], v[180:181], v[116:117] op_sel:[0,0,0] op_sel_hi:[0,1,1]
    v_pk_fma_f32 v[118:119], v[212:213], v[182:183], v[118:119] op_sel:[0,0,0] op_sel_hi:[0,1,1]
    v_pk_fma_f32 v[120:121], v[212:213], v[184:185], v[120:121] op_sel:[0,0,0] op_sel_hi:[0,1,1]
    v_pk_fma_f32 v[122:123], v[212:213], v[186:187], v[122:123] op_sel:[0,0,0] op_sel_hi:[0,1,1]
    v_pk_fma_f32 v[124:125], v[212:213], v[188:189], v[124:125] op_sel:[0,0,0] op_sel_hi:[0,1,1]
    v_pk_fma_f32 v[126:127], v[212:213], v[190:191], v[126:127] op_sel:[0,0,0] op_sel_hi:[0,1,1]
    v_pk_fma_f32 v[128:129], v[212:213], v[192:193], v[128:129] op_sel:[0,0,0] op_sel_hi:[0,1,1]
    v_pk_fma_f32 v[130:131], v[212:213], v[194:195], v[130:131] op_sel:[0,0,0] op_sel_hi:[0,1,1]
    v_pk_mul_f32 v[232:233], v[224:225], v[116:117] op_sel:[0,0] op_sel_hi:[0,1]
    v_pk_mul_f32 v[234:235], v[224:225], v[118:119] op_sel:[0,0] op_sel_hi:[0,1]
    v_pk_mul_f32 v[236:237], v[224:225], v[120:121] op_sel:[0,0] op_sel_hi:[0,1]
    v_pk_mul_f32 v[238:239], v[224:225], v[122:123] op_sel:[0,0] op_sel_hi:[0,1]
    v_exp_f32 v232, v232
    v_exp_f32 v233, v233
    v_exp_f32 v234, v234
    v_exp_f32 v235, v235
    v_exp_f32 v236, v236
    v_exp_f32 v237, v237
    v_exp_f32 v238, v238
    v_exp_f32 v239, v239
    v_pk_mul_f32 v[116:117], v[116:117], v[124:125] op_sel:[0,0] op_sel_hi:[1,1]
    v_pk_mul_f32 v[118:119], v[118:119], v[126:127] op_sel:[0,0] op_sel_hi:[1,1]
    v_pk_mul_f32 v[120:121], v[120:121], v[128:129] op_sel:[0,0] op_sel_hi:[1,1]
    v_pk_mul_f32 v[122:123], v[122:123], v[130:131] op_sel:[0,0] op_sel_hi:[1,1]
    v_fma_f32 v232, v232, v213, v213
    v_fma_f32 v233, v233, v213, v213
    v_fma_f32 v234, v234, v213, v213
    v_fma_f32 v235, v235, v213, v213
    v_fma_f32 v236, v236, v213, v213
    v_fma_f32 v237, v237, v213, v213
    v_fma_f32 v238, v238, v213, v213
    v_fma_f32 v239, v239, v213, v213
    v_rcp_f32 v232, v232
    v_rcp_f32 v233, v233
    v_rcp_f32 v234, v234
    v_rcp_f32 v235, v235
    v_rcp_f32 v236, v236
    v_rcp_f32 v237, v237
    v_rcp_f32 v238, v238
    v_rcp_f32 v239, v239
    s_nop 0
    v_pk_mul_f32 v[116:117], v[116:117], v[232:233] op_sel:[0,0] op_sel_hi:[1,1]
    v_pk_mul_f32 v[118:119], v[118:119], v[234:235] op_sel:[0,0] op_sel_hi:[1,1]
    v_pk_mul_f32 v[120:121], v[120:121], v[236:237] op_sel:[0,0] op_sel_hi:[1,1]
    v_pk_mul_f32 v[122:123], v[122:123], v[238:239] op_sel:[0,0] op_sel_hi:[1,1]
    v_cvt_pk_bf16_f32 v124, v116, v117
    v_cvt_pk_bf16_f32 v125, v118, v119
    v_cvt_pk_bf16_f32 v126, v120, v121
    v_cvt_pk_bf16_f32 v127, v122, v123
    buffer_store_dwordx4 v[124:127], v219, s[24:27], s64 offen sc0 sc1
    v_pk_fma_f32 v[132:133], v[214:215], v[180:181], v[132:133] op_sel:[0,0,0] op_sel_hi:[0,1,1]
    v_pk_fma_f32 v[134:135], v[214:215], v[182:183], v[134:135] op_sel:[0,0,0] op_sel_hi:[0,1,1]
    v_pk_fma_f32 v[136:137], v[214:215], v[184:185], v[136:137] op_sel:[0,0,0] op_sel_hi:[0,1,1]
    v_pk_fma_f32 v[138:139], v[214:215], v[186:187], v[138:139] op_sel:[0,0,0] op_sel_hi:[0,1,1]
    v_pk_fma_f32 v[140:141], v[214:215], v[188:189], v[140:141] op_sel:[0,0,0] op_sel_hi:[0,1,1]
    v_pk_fma_f32 v[142:143], v[214:215], v[190:191], v[142:143] op_sel:[0,0,0] op_sel_hi:[0,1,1]
    v_pk_fma_f32 v[144:145], v[214:215], v[192:193], v[144:145] op_sel:[0,0,0] op_sel_hi:[0,1,1]
    v_pk_fma_f32 v[146:147], v[214:215], v[194:195], v[146:147] op_sel:[0,0,0] op_sel_hi:[0,1,1]
    v_pk_mul_f32 v[232:233], v[226:227], v[132:133] op_sel:[0,0] op_sel_hi:[0,1]
    v_pk_mul_f32 v[234:235], v[226:227], v[134:135] op_sel:[0,0] op_sel_hi:[0,1]
    v_pk_mul_f32 v[236:237], v[226:227], v[136:137] op_sel:[0,0] op_sel_hi:[0,1]
    v_pk_mul_f32 v[238:239], v[226:227], v[138:139] op_sel:[0,0] op_sel_hi:[0,1]
    v_exp_f32 v232, v232
    v_exp_f32 v233, v233
    v_exp_f32 v234, v234
    v_exp_f32 v235, v235
    v_exp_f32 v236, v236
    v_exp_f32 v237, v237
    v_exp_f32 v238, v238
    v_exp_f32 v239, v239
    v_pk_mul_f32 v[132:133], v[132:133], v[140:141] op_sel:[0,0] op_sel_hi:[1,1]
    v_pk_mul_f32 v[134:135], v[134:135], v[142:143] op_sel:[0,0] op_sel_hi:[1,1]
    v_pk_mul_f32 v[136:137], v[136:137], v[144:145] op_sel:[0,0] op_sel_hi:[1,1]
    v_pk_mul_f32 v[138:139], v[138:139], v[146:147] op_sel:[0,0] op_sel_hi:[1,1]
    v_fma_f32 v232, v232, v215, v215
    v_fma_f32 v233, v233, v215, v215
    v_fma_f32 v234, v234, v215, v215
    v_fma_f32 v235, v235, v215, v215
    v_fma_f32 v236, v236, v215, v215
    v_fma_f32 v237, v237, v215, v215
    v_fma_f32 v238, v238, v215, v215
    v_fma_f32 v239, v239, v215, v215
    v_rcp_f32 v232, v232
    v_rcp_f32 v233, v233
    v_rcp_f32 v234, v234
    v_rcp_f32 v235, v235
    v_rcp_f32 v236, v236
    v_rcp_f32 v237, v237
    v_rcp_f32 v238, v238
    v_rcp_f32 v239, v239
    s_nop 0
    v_pk_mul_f32 v[132:133], v[132:133], v[232:233] op_sel:[0,0] op_sel_hi:[1,1]
    v_pk_mul_f32 v[134:135], v[134:135], v[234:235] op_sel:[0,0] op_sel_hi:[1,1]
    v_pk_mul_f32 v[136:137], v[136:137], v[236:237] op_sel:[0,0] op_sel_hi:[1,1]
    v_pk_mul_f32 v[138:139], v[138:139], v[238:239] op_sel:[0,0] op_sel_hi:[1,1]
    v_cvt_pk_bf16_f32 v140, v132, v133
    v_cvt_pk_bf16_f32 v141, v134, v135
    v_cvt_pk_bf16_f32 v142, v136, v137
    v_cvt_pk_bf16_f32 v143, v138, v139
    buffer_store_dwordx4 v[140:143], v219, s[24:27], s65 offen sc0 sc1
    s_endpgm
K1_F5_SLOW:
    s_mov_b32 s62, 0
K1_F5_SPIN:
    s_add_u32 s62, s62, 1
    s_cmp_ge_u32 s62, 4000
    s_cbranch_scc1 K1_F5_FB1
    s_sleep 4
    v_lshlrev_b32 v11, 2, v1
    global_load_dword v223, v11, s[76:77] sc1
    s_waitcnt vmcnt(0)
    v_and_b32 v11, v223, v221
    v_cmp_ne_u32 vcc, v11, v221
    s_nop 4
    s_cbranch_vccz K1_F5_RDY
    s_branch K1_F5_SPIN
K1_F5_FB1:
    v_mov_b32 v5, 1
    s_branch K1_F5_RDY
K1_F5_FB:
    s_lshl_b32 s63, s35, 8
    s_lshl_b32 s47, s38, 6
    s_add_u32 s63, s63, s47
    s_lshl_b32 s47, s37, 5
    s_add_u32 s63, s63, s47
    s_mov_b32 s62, 0
K1_F5_FS0:
    s_add_u32 s64, s63, s62
    s_lshl_b32 s64, s64, 10
    buffer_load_dwordx4 v[164:167], v219, s[8:11], s64 offen
    s_waitcnt vmcnt(0)
    v_mov_b32 v8, 0
    v_mov_b32 v9, 0
    v_dot2c_f32_bf16 v8, s54, v164
    v_dot2c_f32_bf16 v9, v164, v164
    v_dot2c_f32_bf16 v8, s54, v165
    v_dot2c_f32_bf16 v9, v165, v165
    v_dot2c_f32_bf16 v8, s54, v166
    v_dot2c_f32_bf16 v9, v166, v166
    v_dot2c_f32_bf16 v8, s54, v167
    v_dot2c_f32_bf16 v9, v167, v167
    s_nop 2
    v_add_f32_dpp v8, v8, v8 row_shr:1 row_mask:0xf bank_mask:0xf bound_ctrl:0
    v_add_f32_dpp v9, v9, v9 row_shr:1 row_mask:0xf bank_mask:0xf bound_ctrl:0
    s_nop 0
    v_add_f32_dpp v8, v8, v8 row_shr:2 row_mask:0xf bank_mask:0xf bound_ctrl:0
    v_add_f32_dpp v9, v9, v9 row_shr:2 row_mask:0xf bank_mask:0xf bound_ctrl:0
    s_nop 0
    v_add_f32_dpp v8, v8, v8 row_shr:4 row_mask:0xf bank_mask:0xf bound_ctrl:0
    v_add_f32_dpp v9, v9, v9 row_shr:4 row_mask:0xf bank_mask:0xf bound_ctrl:0
    s_nop 0
    v_add_f32_dpp v8, v8, v8 row_shr:8 row_mask:0xf bank_mask:0xf bound_ctrl:0
    v_add_f32_dpp v9, v9, v9 row_shr:8 row_mask:0xf bank_mask:0xf bound_ctrl:0
    s_nop 0
    v_add_f32_dpp v8, v8, v8 row_bcast:15 row_mask:0xa bank_mask:0xf
    v_add_f32_dpp v9, v9, v9 row_bcast:15 row_mask:0xa bank_mask:0xf
    s_nop 0
    v_add_f32_dpp v8, v8, v8 row_bcast:31 row_mask:0xc bank_mask:0xf
    v_add_f32_dpp v9, v9, v9 row_bcast:31 row_mask:0xc bank_mask:0xf
    s_nop 0
    v_readlane_b32 s46, v8, 63
    v_readlane_b32 s47, v9, 63
    s_nop 1
    v_mov_b32 v8, s46
    v_mov_b32 v9, s47
    v_cmp_eq_u32 vcc, s62, v2
    s_nop 1
    v_cndmask_b32 v248, v248, v8, vcc
    v_cndmask_b32 v249, v249, v9, vcc
    s_add_u32 s62, s62, 1
    s_cmp_lt_u32 s62, 32
    s_cbranch_scc1 K1_F5_FS0
    s_xor_b32 s63, s63, 32
    s_mov_b32 s62, 0
K1_F5_FS1:
    s_add_u32 s64, s63, s62
    s_lshl_b32 s64, s64, 10
    buffer_load_dwordx4 v[164:167], v219, s[8:11], s64 offen
    s_waitcnt vmcnt(0)
    v_mov_b32 v8, 0
    v_mov_b32 v9, 0
    v_dot2c_f32_bf16 v8, s54, v164
    v_dot2c_f32_bf16 v9, v164, v164
    v_dot2c_f32_bf16 v8, s54, v165
    v_dot2c_f32_bf16 v9, v165, v165
    v_dot2c_f32_bf16 v8, s54, v166
    v_dot2c_f32_bf16 v9, v166, v166
    v_dot2c_f32_bf16 v8, s54, v167
    v_dot2c_f32_bf16 v9, v167, v167
    s_nop 2
    v_add_f32_dpp v8, v8, v8 row_shr:1 row_mask:0xf bank_mask:0xf bound_ctrl:0
    v_add_f32_dpp v9, v9, v9 row_shr:1 row_mask:0xf bank_mask:0xf bound_ctrl:0
    s_nop 0
    v_add_f32_dpp v8, v8, v8 row_shr:2 row_mask:0xf bank_mask:0xf bound_ctrl:0
    v_add_f32_dpp v9, v9, v9 row_shr:2 row_mask:0xf bank_mask:0xf bound_ctrl:0
    s_nop 0
    v_add_f32_dpp v8, v8, v8 row_shr:4 row_mask:0xf bank_mask:0xf bound_ctrl:0
    v_add_f32_dpp v9, v9, v9 row_shr:4 row_mask:0xf bank_mask:0xf bound_ctrl:0
    s_nop 0
    v_add_f32_dpp v8, v8, v8 row_shr:8 row_mask:0xf bank_mask:0xf bound_ctrl:0
    v_add_f32_dpp v9, v9, v9 row_shr:8 row_mask:0xf bank_mask:0xf bound_ctrl:0
    s_nop 0
    v_add_f32_dpp v8, v8, v8 row_bcast:15 row_mask:0xa bank_mask:0xf
    v_add_f32_dpp v9, v9, v9 row_bcast:15 row_mask:0xa bank_mask:0xf
    s_nop 0
    v_add_f32_dpp v8, v8, v8 row_bcast:31 row_mask:0xc bank_mask:0xf
    v_add_f32_dpp v9, v9, v9 row_bcast:31 row_mask:0xc bank_mask:0xf
    s_nop 0
    v_readlane_b32 s46, v8, 63
    v_readlane_b32 s47, v9, 63
    s_nop 1
    v_mov_b32 v8, s46
    v_mov_b32 v9, s47
    v_cmp_eq_u32 vcc, s62, v2
    s_nop 1
    v_cndmask_b32 v250, v250, v8, vcc
    v_cndmask_b32 v251, v251, v9, vcc
    s_add_u32 s62, s62, 1
    s_cmp_lt_u32 s62, 32
    s_cbranch_scc1 K1_F5_FS1
    v_mov_b32 v232, 0
    v_mov_b32 v233, 0
    v_mov_b32 v234, 0
    v_mov_b32 v235, 0
    v_mov_b32 v236, 0
    v_mov_b32 v237, 0
    v_mov_b32 v238, 0
    v_mov_b32 v239, 0
    v_mov_b32 v240, 0
    v_mov_b32 v241, 0
    v_mov_b32 v242, 0
    v_mov_b32 v243, 0
    v_mov_b32 v244, 0
    v_mov_b32 v245, 0
    v_mov_b32 v246, 0
    v_mov_b32 v247, 0
    s_lshl_b32 s46, s37, 1
    s_add_u32 s46, s46, s58
    v_add_u32 v4, s46, v3
    v_and_b32 v5, 15, v2
    v_lshlrev_b32 v5, 1, v5
    v_lshl_add_u32 v4, v4, 5, v5
    v_mov_b32 v164, s28
    v_mov_b32 v165, s29
    v_mov_b32 v6, s30
    v_mov_b32 v7, s31
    v_cmp_lt_u32 vcc, 15, v2
    s_nop 1
    v_cndmask_b32 v164, v164, v6, vcc
    v_cndmask_b32 v165, v165, v7, vcc
    v_mov_b32 v166, 2752
    v_mov_b32 v167, 0
    v_mov_b32 v5, 0
    v_add_co_u32 v164, vcc, v164, v4
    s_nop 1
    v_addc_co_u32 v165, vcc, v165, v5, vcc
    s_mov_b32 s62, 0
K1_F5_FC0:
    global_load_ushort v6, v[164:165], off
    v_lshl_add_u64 v[164:165], v[166:167], 0, v[164:165]
    s_waitcnt vmcnt(0)
    v_lshlrev_b32 v6, 16, v6
    v_add_f32 v232, v232, v6
    s_add_u32 s62, s62, 1
    s_cmp_lt_u32 s62, 512
    s_cbranch_scc1 K1_F5_FC0
    v_mov_b32 v4, s57
    v_and_b32 v5, 15, v2
    v_lshlrev_b32 v5, 1, v5
    v_lshl_add_u32 v4, v4, 5, v5
    v_mov_b32 v164, s28
    v_mov_b32 v165, s29
    v_mov_b32 v6, s30
    v_mov_b32 v7, s31
    v_cmp_lt_u32 vcc, 15, v2
    s_nop 1
    v_cndmask_b32 v164, v164, v6, vcc
    v_cndmask_b32 v165, v165, v7, vcc
    v_mov_b32 v166, 2752
    v_mov_b32 v167, 0
    v_mov_b32 v5, 0
    v_add_co_u32 v164, vcc, v164, v4
    s_nop 1
    v_addc_co_u32 v165, vcc, v165, v5, vcc
    s_mov_b32 s62, 0
K1_F5_FC1:
    global_load_ushort v6, v[164:165], off
    v_lshl_add_u64 v[164:165], v[166:167], 0, v[164:165]
    s_waitcnt vmcnt(0)
    v_lshlrev_b32 v6, 16, v6
    v_add_f32 v240, v240, v6
    s_add_u32 s62, s62, 1
    s_cmp_lt_u32 s62, 512
    s_cbranch_scc1 K1_F5_FC1
    s_branch K1_F5_HB
K1_F5:
    s_barrier
    ds_read_b128 v[44:47], v24 offset:0
    ds_read_b64_tr_b16 v[52:53], v36 offset:0
    ds_read_b64_tr_b16 v[54:55], v36 offset:512
    ds_read_b128 v[48:51], v28 offset:0
    ds_read_b64_tr_b16 v[56:57], v38 offset:0
    ds_read_b64_tr_b16 v[58:59], v38 offset:512
    ds_read_b64_tr_b16 v[60:61], v40 offset:0
    ds_read_b64_tr_b16 v[62:63], v41 offset:0
    s_add_u32 m0, s50, 106496
    s_nop 0
    buffer_load_dwordx4 v16, s[8:11], s40 offen offset:0 lds
    buffer_load_dwordx4 v17, s[8:11], s40 offen offset:1024 lds
    s_waitcnt lgkmcnt(0)
    v_mfma_f32_32x32x16_bf16 v[84:99], v[52:55], v[44:47], 0
    ds_read_b128 v[64:67], v25 offset:0
    ds_read_b64_tr_b16 v[72:73], v36 offset:2048
    ds_read_b64_tr_b16 v[74:75], v36 offset:2560
    ds_read_b128 v[68:71], v29 offset:0
    v_mfma_f32_32x32x16_bf16 v[100:115], v[52:55], v[48:51], 0
    ds_read_b64_tr_b16 v[76:77], v38 offset:2048
    ds_read_b64_tr_b16 v[78:79], v38 offset:2560
    ds_read_b64_tr_b16 v[80:81], v40 offset:512
    ds_read_b64_tr_b16 v[82:83], v41 offset:512
    v_mfma_f32_32x32x16_bf16 v[116:131], v[56:59], v[44:47], 0
    buffer_load_dwordx4 v18, s[8:11], s40 offen offset:2048 lds
    buffer_load_dwordx4 v19, s[8:11], s40 offen offset:3072 lds
    s_mul_i32 s46, s38, 2048
    v_add_u32 v4, s46, v36
    ds_read_b64_tr_b16 v[164:165], v4 offset:0
    ds_read_b64_tr_b16 v[166:167], v4 offset:512
    s_mul_i32 s46, s38, 2048
    v_add_u32 v4, s46, v38
    ds_read_b64_tr_b16 v[168:169], v4 offset:0
    v_mfma_f32_32x32x16_bf16 v[132:147], v[56:59], v[48:51], 0
    ds_read_b64_tr_b16 v[170:171], v4 offset:512
    s_lshl_b32 s46, s38, 9
    v_add_u32 v4, s46, v40
    v_add_u32 v5, s46, v41
    ds_read_b64_tr_b16 v[172:173], v4 offset:0
    ds_read_b64_tr_b16 v[174:175], v5 offset:0
    v_mov_b32 v6, 0
    v_mov_b32 v7, 0
    v_mfma_f32_32x32x16_bf16 v[148:163], v[60:63], v[44:47], 0
    v_mov_b32 v8, 0
    s_mul_i32 s46, s38, 640
    s_lshl_b32 s47, s37, 8
    s_add_u32 s47, s47, s46
    v_lshl_add_u32 v10, v1, 2, s47
    v_lshl_add_u32 v11, v2, 2, s46
    v_add_u32 v10, 159744, v10
    v_add_u32 v11, 160256, v11
    s_waitcnt lgkmcnt(0)
    v_mfma_f32_32x32x16_bf16 v[84:99], v[72:75], v[64:67], v[84:99]
    ds_read_b128 v[44:47], v26 offset:0
    ds_read_b64_tr_b16 v[52:53], v36 offset:4096
    ds_read_b64_tr_b16 v[54:55], v36 offset:4608
    ds_read_b128 v[48:51], v30 offset:0
    v_mfma_f32_32x32x16_bf16 v[100:115], v[72:75], v[68:71], v[100:115]
    ds_read_b64_tr_b16 v[56:57], v38 offset:4096
    ds_read_b64_tr_b16 v[58:59], v38 offset:4608
    ds_read_b64_tr_b16 v[60:61], v40 offset:1024
    ds_read_b64_tr_b16 v[62:63], v41 offset:1024
    v_mfma_f32_32x32x16_bf16 v[116:131], v[76:79], v[64:67], v[116:131]
    s_add_u32 m0, s51, 106496
    s_nop 0
    buffer_load_dwordx4 v225, s[12:15], s41 offen lds
    s_add_u32 m0, s52, 106496
    s_nop 0
    buffer_load_dwordx4 v227, s[16:19], s41 offen lds
    v_mfma_f32_32x32x16_bf16 v[132:147], v[76:79], v[68:71], v[132:147]
    v_dot2c_f32_bf16 v6, s54, v164
    v_dot2c_f32_bf16 v7, s54, v168
    v_dot2c_f32_bf16 v8, s54, v172
    v_dot2c_f32_bf16 v6, s54, v165
    v_dot2c_f32_bf16 v7, s54, v169
    v_dot2c_f32_bf16 v8, s54, v173
    v_mfma_f32_32x32x16_bf16 v[148:163], v[80:83], v[64:67], v[148:163]
    v_dot2c_f32_bf16 v6, s54, v166
    v_dot2c_f32_bf16 v7, s54, v170
    v_dot2c_f32_bf16 v8, s54, v174
    v_dot2c_f32_bf16 v6, s54, v167
    v_dot2c_f32_bf16 v7, s54, v171
    v_dot2c_f32_bf16 v8, s54, v175
    s_waitcnt lgkmcnt(0)
    v_mfma_f32_32x32x16_bf16 v[84:99], v[52:55], v[44:47], v[84:99]
    ds_read_b128 v[64:67], v27 offset:0
    ds_read_b64_tr_b16 v[72:73], v36 offset:6144
    ds_read_b64_tr_b16 v[74:75], v36 offset:6656
    ds_read_b128 v[68:71], v31 offset:0
    v_mfma_f32_32x32x16_bf16 v[100:115], v[52:55], v[48:51], v[100:115]
    ds_read_b64_tr_b16 v[76:77], v38 offset:6144
    ds_read_b64_tr_b16 v[78:79], v38 offset:6656
    ds_read_b64_tr_b16 v[80:81], v40 offset:1536
    ds_read_b64_tr_b16 v[82:83], v41 offset:1536
    v_mfma_f32_32x32x16_bf16 v[116:131], v[56:59], v[44:47], v[116:131]
    s_add_u32 m0, s53, 106496
    s_mov_b32 exec_hi, 0
    buffer_load_dwordx4 v229, s[20:23], s42 offen lds
    s_mov_b32 exec_hi, -1
    s_add_u32 s49, s49, 1
    s_and_b32 s49, s49, 7
    s_lshl_b32 s40, s49, 7
    s_mul_i32 s42, s49, 176128
    s_mov_b32 s41, s42
    v_mfma_f32_32x32x16_bf16 v[132:147], v[56:59], v[48:51], v[132:147]
    v_mov_b32 v9, v8
    s_nop 1
    v_permlane32_swap_b32 v6, v7
    v_permlane32_swap_b32 v8, v9
    s_nop 1
    v_add_f32 v6, v6, v7
    v_add_f32 v8, v8, v9
    ds_write_b32 v10, v6
    ds_write_b32 v11, v8
    v_mfma_f32_32x32x16_bf16 v[148:163], v[60:63], v[44:47], v[148:163]
    s_waitcnt vmcnt(7) lgkmcnt(0)
    s_barrier
    v_mfma_f32_32x32x16_bf16 v[84:99], v[72:75], v[64:67], v[84:99]
    ds_read_b128 v[44:47], v24 offset:53248
    ds_read_b64_tr_b16 v[52:53], v36 offset:53248
    ds_read_b64_tr_b16 v[54:55], v36 offset:53760
    ds_read_b128 v[48:51], v28 offset:53248
    v_mfma_f32_32x32x16_bf16 v[100:115], v[72:75], v[68:71], v[100:115]
    ds_read_b64_tr_b16 v[56:57], v38 offset:53248
    ds_read_b64_tr_b16 v[58:59], v38 offset:53760
    ds_read_b64_tr_b16 v[60:61], v40 offset:53248
    ds_read_b64_tr_b16 v[62:63], v41 offset:53248
    v_mfma_f32_32x32x16_bf16 v[116:131], v[76:79], v[64:67], v[116:131]
    s_add_u32 m0, s50, 0
    s_nop 0
    buffer_load_dwordx4 v16, s[8:11], s40 offen offset:0 lds
    buffer_load_dwordx4 v17, s[8:11], s40 offen offset:1024 lds
    s_lshl_b32 s46, s34, 8
    v_lshl_add_u32 v4, v1, 2, s46
    v_min_u32 v5, 636, v4
    v_add_u32 v5, 159744, v5
    ds_read_b32 v6, v5 offset:0
    ds_read_b32 v7, v5 offset:640
    ds_read_b32 v8, v5 offset:1280
    v_mfma_f32_32x32x16_bf16 v[132:147], v[76:79], v[68:71], v[132:147]
    ds_read_b32 v9, v5 offset:1920
    s_lshl_b32 s46, s48, 3
    s_add_u32 s46, s46, s35
    s_mul_i32 s46, s46, 640
    s_add_u32 s46, s46, 8388608
    v_add_u32 v4, s46, v4
    v_mov_b32 v10, 0
    v_mov_b32 v11, 0
    v_dot2c_f32_bf16 v10, s54, v232
    v_dot2c_f32_bf16 v11, v232, v232
    v_mfma_f32_32x32x16_bf16 v[148:163], v[80:83], v[64:67], v[148:163]
    v_dot2c_f32_bf16 v10, s54, v233
    v_dot2c_f32_bf16 v11, v233, v233
    v_dot2c_f32_bf16 v10, s54, v234
    v_dot2c_f32_bf16 v11, v234, v234
    v_dot2c_f32_bf16 v10, s54, v235
    v_dot2c_f32_bf16 v11, v235, v235
    s_nop 2
    v_add_f32_dpp v10, v10, v10 row_shr:1 row_mask:0xf bank_mask:0xf bound_ctrl:0
    v_add_f32_dpp v11, v11, v11 row_shr:1 row_mask:0xf bank_mask:0xf bound_ctrl:0
    s_nop 0
    s_waitcnt lgkmcnt(0)
    v_mfma_f32_32x32x16_bf16 v[84:99], v[52:55], v[44:47], v[84:99]
    ds_read_b128 v[64:67], v25 offset:53248
    ds_read_b64_tr_b16 v[72:73], v36 offset:55296
    ds_read_b64_tr_b16 v[74:75], v36 offset:55808
    ds_read_b128 v[68:71], v29 offset:53248
    v_mfma_f32_32x32x16_bf16 v[100:115], v[52:55], v[48:51], v[100:115]
    ds_read_b64_tr_b16 v[76:77], v38 offset:55296
    ds_read_b64_tr_b16 v[78:79], v38 offset:55808
    ds_read_b64_tr_b16 v[80:81], v40 offset:53760
    ds_read_b64_tr_b16 v[82:83], v41 offset:53760
    v_mfma_f32_32x32x16_bf16 v[116:131], v[56:59], v[44:47], v[116:131]
    v_add_f32 v6, v6, v7
    v_add_f32 v8, v8, v9
    v_add_f32 v6, v6, v8
    s_cmp_ge_u32 s34, 3
    s_cbranch_scc1 K1_F5_H1
    s_cmp_eq_u32 s34, 2
    s_cselect_b32 exec_hi, 0, -1
    global_store_dword v4, v6, s[32:33] sc1
    s_mov_b32 exec_hi, -1
K1_F5_H1:
    v_add_f32_dpp v10, v10, v10 row_shr:2 row_mask:0xf bank_mask:0xf bound_ctrl:0
    v_add_f32_dpp v11, v11, v11 row_shr:2 row_mask:0xf bank_mask:0xf bound_ctrl:0
    v_mfma_f32_32x32x16_bf16 v[132:147], v[56:59], v[48:51], v[132:147]
    s_nop 0
    v_add_f32_dpp v10, v10, v10 row_shr:4 row_mask:0xf bank_mask:0xf bound_ctrl:0
    v_add_f32_dpp v11, v11, v11 row_shr:4 row_mask:0xf bank_mask:0xf bound_ctrl:0
    s_nop 0
    v_add_f32_dpp v10, v10, v10 row_shr:8 row_mask:0xf bank_mask:0xf bound_ctrl:0
    v_add_f32_dpp v11, v11, v11 row_shr:8 row_mask:0xf bank_mask:0xf bound_ctrl:0
    s_nop 0
    v_add_f32_dpp v10, v10, v10 row_bcast:15 row_mask:0xa bank_mask:0xf
    v_add_f32_dpp v11, v11, v11 row_bcast:15 row_mask:0xa bank_mask:0xf
    s_nop 0
    v_add_f32_dpp v10, v10, v10 row_bcast:31 row_mask:0xc bank_mask:0xf
    v_add_f32_dpp v11, v11, v11 row_bcast:31 row_mask:0xc bank_mask:0xf
    v_mfma_f32_32x32x16_bf16 v[148:163], v[60:63], v[44:47], v[148:163]
    s_nop 0
    v_readlane_b32 s44, v10, 63
    v_readlane_b32 s45, v11, 63
    s_nop 1
    v_mov_b32 v236, s44
    v_mov_b32 v237, s45
    v_mov_b32 v10, s60
    s_mov_b64 exec, 1
    global_store_dwordx2 v10, v[236:237], s[32:33] sc1
    s_mov_b64 exec, -1
    buffer_load_dwordx4 v18, s[8:11], s40 offen offset:2048 lds
    buffer_load_dwordx4 v19, s[8:11], s40 offen offset:3072 lds
    s_waitcnt lgkmcnt(0)
    v_mfma_f32_32x32x16_bf16 v[84:99], v[72:75], v[64:67], v[84:99]
    ds_read_b128 v[44:47], v26 offset:53248
    ds_read_b64_tr_b16 v[52:53], v36 offset:57344
    ds_read_b64_tr_b16 v[54:55], v36 offset:57856
    ds_read_b128 v[48:51], v30 offset:53248
    v_mfma_f32_32x32x16_bf16 v[100:115], v[72:75], v[68:71], v[100:115]
    ds_read_b64_tr_b16 v[56:57], v38 offset:57344
    ds_read_b64_tr_b16 v[58:59], v38 offset:57856
    ds_read_b64_tr_b16 v[60:61], v40 offset:54272
    ds_read_b64_tr_b16 v[62:63], v41 offset:54272
    v_mfma_f32_32x32x16_bf16 v[116:131], v[76:79], v[64:67], v[116:131]
    s_add_u32 m0, s51, 0
    s_nop 0
    buffer_load_dwordx4 v225, s[12:15], s41 offen lds
    v_mfma_f32_32x32x16_bf16 v[132:147], v[76:79], v[68:71], v[132:147]
    s_add_u32 m0, s52, 0
    s_nop 0
    buffer_load_dwordx4 v227, s[16:19], s41 offen lds
    v_mfma_f32_32x32x16_bf16 v[148:163], v[80:83], v[64:67], v[148:163]
    s_waitcnt lgkmcnt(0)
    v_mfma_f32_32x32x16_bf16 v[84:99], v[52:55], v[44:47], v[84:99]
    ds_read_b128 v[64:67], v27 offset:53248
    ds_read_b64_tr_b16 v[72:73], v36 offset:59392
    ds_read_b64_tr_b16 v[74:75], v36 offset:59904
    ds_read_b128 v[68:71], v31 offset:53248
    v_mfma_f32_32x32x16_bf16 v[100:115], v[52:55], v[48:51], v[100:115]
    ds_read_b64_tr_b16 v[76:77], v38 offset:59392
    ds_read_b64_tr_b16 v[78:79], v38 offset:59904
    ds_read_b64_tr_b16 v[80:81], v40 offset:54784
    ds_read_b64_tr_b16 v[82:83], v41 offset:54784
    v_mfma_f32_32x32x16_bf16 v[116:131], v[56:59], v[44:47], v[116:131]
    s_add_u32 m0, s53, 0
    s_mov_b32 exec_hi, 0
    buffer_load_dwordx4 v229, s[20:23], s42 offen lds
    s_mov_b32 exec_hi, -1
    s_add_u32 s49, s49, 1
    s_and_b32 s49, s49, 7
    s_lshl_b32 s40, s49, 7
    s_mul_i32 s42, s49, 176128
    s_mov_b32 s41, s42
    v_mfma_f32_32x32x16_bf16 v[132:147], v[56:59], v[48:51], v[132:147]
    v_add_u32 v24, 106496, v24
    v_add_u32 v25, 106496, v25
    v_add_u32 v26, 106496, v26
    v_add_u32 v27, 106496, v27
    v_add_u32 v28, 106496, v28
    v_mfma_f32_32x32x16_bf16 v[148:163], v[60:63], v[44:47], v[148:163]
    v_add_u32 v29, 106496, v29
    v_add_u32 v30, 106496, v30
    v_add_u32 v31, 106496, v31
    v_add_u32 v36, 106496, v36
    v_add_u32 v40, 106496, v40
    v_add_u32 v41, 106496, v41
    v_add_u32 v38, 106496, v38
    s_waitcnt vmcnt(5) lgkmcnt(0)
    s_barrier
    v_mfma_f32_32x32x16_bf16 v[84:99], v[72:75], v[64:67], v[84:99]
    ds_read_b128 v[44:47], v24 offset:0
    ds_read_b64_tr_b16 v[52:53], v36 offset:0
    ds_read_b64_tr_b16 v[54:55], v36 offset:512
    ds_read_b128 v[48:51], v28 offset:0
    v_mfma_f32_32x32x16_bf16 v[100:115], v[72:75], v[68:71], v[100:115]
    ds_read_b64_tr_b16 v[56:57], v38 offset:0
    ds_read_b64_tr_b16 v[58:59], v38 offset:512
    ds_read_b64_tr_b16 v[60:61], v40 offset:0
    ds_read_b64_tr_b16 v[62:63], v41 offset:0
    v_mfma_f32_32x32x16_bf16 v[116:131], v[76:79], v[64:67], v[116:131]
    s_add_u32 m0, s50, 53248
    s_nop 0
    buffer_load_dwordx4 v16, s[8:11], s40 offen offset:0 lds
    buffer_load_dwordx4 v17, s[8:11], s40 offen offset:1024 lds
    s_cmp_lg_u32 s34, 0
    s_cbranch_scc1 K1_F5_H2
    s_lshl_b32 s46, s35, 5
    s_add_u32 s46, s46, s48
    s_and_b32 s47, s46, 3
    s_lshl_b32 s47, s47, 3
    s_lshl_b32 s47, 1, s47
    s_and_b32 s46, s46, 252
    v_mov_b32 v4, s46
    v_mov_b32 v5, s47
    s_mov_b64 exec, 1
    global_atomic_add v4, v5, s[76:77] sc1
    s_mov_b64 exec, -1
K1_F5_H2:
    v_mfma_f32_32x32x16_bf16 v[132:147], v[76:79], v[68:71], v[132:147]
    v_mfma_f32_32x32x16_bf16 v[148:163], v[80:83], v[64:67], v[148:163]
    s_waitcnt lgkmcnt(0)
    v_mfma_f32_32x32x16_bf16 v[84:99], v[52:55], v[44:47], v[84:99]
    ds_read_b128 v[64:67], v25 offset:0
    ds_read_b64_tr_b16 v[72:73], v36 offset:2048
    ds_read_b64_tr_b16 v[74:75], v36 offset:2560
    ds_read_b128 v[68:71], v29 offset:0
    v_mfma_f32_32x32x16_bf16 v[100:115], v[52:55], v[48:51], v[100:115]
    ds_read_b64_tr_b16 v[76:77], v38 offset:2048
    ds_read_b64_tr_b16 v[78:79], v38 offset:2560
    ds_read_b64_tr_b16 v[80:81], v40 offset:512
    ds_read_b64_tr_b16 v[82:83], v41 offset:512
    v_mfma_f32_32x32x16_bf16 v[116:131], v[56:59], v[44:47], v[116:131]
    buffer_load_dwordx4 v18, s[8:11], s40 offen offset:2048 lds
    v_mfma_f32_32x32x16_bf16 v[132:147], v[56:59], v[48:51], v[132:147]
    buffer_load_dwordx4 v19, s[8:11], s40 offen offset:3072 lds
    v_mfma_f32_32x32x16_bf16 v[148:163], v[60:63], v[44:47], v[148:163]
    s_waitcnt lgkmcnt(0)
    v_mfma_f32_32x32x16_bf16 v[84:99], v[72:75], v[64:67], v[84:99]
    ds_read_b128 v[44:47], v26 offset:0
    ds_read_b64_tr_b16 v[52:53], v36 offset:4096
    ds_read_b64_tr_b16 v[54:55], v36 offset:4608
    ds_read_b128 v[48:51], v30 offset:0
    v_mfma_f32_32x32x16_bf16 v[100:115], v[72:75], v[68:71], v[100:115]
    ds_read_b64_tr_b16 v[56:57], v38 offset:4096
    ds_read_b64_tr_b16 v[58:59], v38 offset:4608
    ds_read_b64_tr_b16 v[60:61], v40 offset:1024
    ds_read_b64_tr_b16 v[62:63], v41 offset:1024
    v_mfma_f32_32x32x16_bf16 v[116:131], v[76:79], v[64:67], v[116:131]
    s_add_u32 m0, s51, 53248
    s_nop 0
    buffer_load_dwordx4 v225, s[12:15], s41 offen lds
    v_mfma_f32_32x32x16_bf16 v[132:147], v[76:79], v[68:71], v[132:147]
    s_add_u32 m0, s52, 53248
    s_nop 0
    buffer_load_dwordx4 v227, s[16:19], s41 offen lds
    v_mfma_f32_32x32x16_bf16 v[148:163], v[80:83], v[64:67], v[148:163]
    s_waitcnt lgkmcnt(0)
    v_mfma_f32_32x32x16_bf16 v[84:99], v[52:55], v[44:47], v[84:99]
    ds_read_b128 v[64:67], v27 offset:0
    ds_read_b64_tr_b16 v[72:73], v36 offset:6144
    ds_read_b64_tr_b16 v[74:75], v36 offset:6656
    ds_read_b128 v[68:71], v31 offset:0
    v_mfma_f32_32x32x16_bf16 v[100:115], v[52:55], v[48:51], v[100:115]
    ds_read_b64_tr_b16 v[76:77], v38 offset:6144
    ds_read_b64_tr_b16 v[78:79], v38 offset:6656
    ds_read_b64_tr_b16 v[80:81], v40 offset:1536
    ds_read_b64_tr_b16 v[82:83], v41 offset:1536
    v_mfma_f32_32x32x16_bf16 v[116:131], v[56:59], v[44:47], v[116:131]
    s_add_u32 m0, s53, 53248
    s_mov_b32 exec_hi, 0
    buffer_load_dwordx4 v229, s[20:23], s42 offen lds
    s_mov_b32 exec_hi, -1
    s_add_u32 s49, s49, 1
    s_and_b32 s49, s49, 7
    s_lshl_b32 s40, s49, 7
    s_mul_i32 s42, s49, 176128
    s_mov_b32 s41, s42
    v_mfma_f32_32x32x16_bf16 v[132:147], v[56:59], v[48:51], v[132:147]
    v_subrev_u32 v24, 106496, v24
    v_subrev_u32 v25, 106496, v25
    v_subrev_u32 v26, 106496, v26
    v_subrev_u32 v27, 106496, v27
    v_subrev_u32 v28, 106496, v28
    v_mfma_f32_32x32x16_bf16 v[148:163], v[60:63], v[44:47], v[148:163]
    v_subrev_u32 v29, 106496, v29
    v_subrev_u32 v30, 106496, v30
    v_subrev_u32 v31, 106496, v31
    v_subrev_u32 v36, 106496, v36
    v_subrev_u32 v40, 106496, v40
    v_subrev_u32 v41, 106496, v41
    v_subrev_u32 v38, 106496, v38
    s_waitcnt vmcnt(7) lgkmcnt(0)
    s_barrier
    v_mfma_f32_32x32x16_bf16 v[84:99], v[72:75], v[64:67], v[84:99]
    ds_read_b128 v[44:47], v24 offset:0
    ds_read_b64_tr_b16 v[52:53], v36 offset:0
    ds_read_b64_tr_b16 v[54:55], v36 offset:512
    ds_read_b128 v[48:51], v28 offset:0
    v_mfma_f32_32x32x16_bf16 v[100:115], v[72:75], v[68:71], v[100:115]
    ds_read_b64_tr_b16 v[56:57], v38 offset:0
    ds_read_b64_tr_b16 v[58:59], v38 offset:512
    ds_read_b64_tr_b16 v[60:61], v40 offset:0
    ds_read_b64_tr_b16 v[62:63], v41 offset:0
    v_mfma_f32_32x32x16_bf16 v[116:131], v[76:79], v[64:67], v[116:131]
    s_add_u32 m0, s50, 106496
    s_nop 0
    buffer_load_dwordx4 v16, s[8:11], s40 offen offset:0 lds
    v_mfma_f32_32x32x16_bf16 v[132:147], v[76:79], v[68:71], v[132:147]
    v_mfma_f32_32x32x16_bf16 v[148:163], v[80:83], v[64:67], v[148:163]
    buffer_load_dwordx4 v17, s[8:11], s40 offen offset:1024 lds
    s_waitcnt lgkmcnt(0)
    v_mfma_f32_32x32x16_bf16 v[84:99], v[52:55], v[44:47], v[84:99]
    ds_read_b128 v[64:67], v25 offset:0
    ds_read_b64_tr_b16 v[72:73], v36 offset:2048
    ds_read_b64_tr_b16 v[74:75], v36 offset:2560
    ds_read_b128 v[68:71], v29 offset:0
    v_mfma_f32_32x32x16_bf16 v[100:115], v[52:55], v[48:51], v[100:115]
    ds_read_b64_tr_b16 v[76:77], v38 offset:2048
    ds_read_b64_tr_b16 v[78:79], v38 offset:2560
    ds_read_b64_tr_b16 v[80:81], v40 offset:512
    ds_read_b64_tr_b16 v[82:83], v41 offset:512
    v_mfma_f32_32x32x16_bf16 v[116:131], v[56:59], v[44:47], v[116:131]
    buffer_load_dwordx4 v18, s[8:11], s40 offen offset:2048 lds
    v_mfma_f32_32x32x16_bf16 v[132:147], v[56:59], v[48:51], v[132:147]
    buffer_load_dwordx4 v19, s[8:11], s40 offen offset:3072 lds
    v_mfma_f32_32x32x16_bf16 v[148:163], v[60:63], v[44:47], v[148:163]
    s_waitcnt lgkmcnt(0)
    v_mfma_f32_32x32x16_bf16 v[84:99], v[72:75], v[64:67], v[84:99]
    ds_read_b128 v[44:47], v26 offset:0
    ds_read_b64_tr_b16 v[52:53], v36 offset:4096
    ds_read_b64_tr_b16 v[54:55], v36 offset:4608
    ds_read_b128 v[48:51], v30 offset:0
    v_mfma_f32_32x32x16_bf16 v[100:115], v[72:75], v[68:71], v[100:115]
    ds_read_b64_tr_b16 v[56:57], v38 offset:4096
    ds_read_b64_tr_b16 v[58:59], v38 offset:4608
    ds_read_b64_tr_b16 v[60:61], v40 offset:1024
    ds_read_b64_tr_b16 v[62:63], v41 offset:1024
    v_mfma_f32_32x32x16_bf16 v[116:131], v[76:79], v[64:67], v[116:131]
    s_add_u32 m0, s51, 106496
    s_nop 0
    buffer_load_dwordx4 v225, s[12:15], s41 offen lds
    v_mfma_f32_32x32x16_bf16 v[132:147], v[76:79], v[68:71], v[132:147]
    s_add_u32 m0, s52, 106496
    s_nop 0
    buffer_load_dwordx4 v227, s[16:19], s41 offen lds
    v_mfma_f32_32x32x16_bf16 v[148:163], v[80:83], v[64:67], v[148:163]
    s_waitcnt lgkmcnt(0)
    v_mfma_f32_32x32x16_bf16 v[84:99], v[52:55], v[44:47], v[84:99]
    ds_read_b128 v[64:67], v27 offset:0
    ds_read_b64_tr_b16 v[72:73], v36 offset:6144
    ds_read_b64_tr_b16 v[74:75], v36 offset:6656
    ds_read_b128 v[68:71], v31 offset:0
    v_mfma_f32_32x32x16_bf16 v[100:115], v[52:55], v[48:51], v[100:115]
    ds_read_b64_tr_b16 v[76:77], v38 offset:6144
    ds_read_b64_tr_b16 v[78:79], v38 offset:6656
    ds_read_b64_tr_b16 v[80:81], v40 offset:1536
    ds_read_b64_tr_b16 v[82:83], v41 offset:1536
    v_mfma_f32_32x32x16_bf16 v[116:131], v[56:59], v[44:47], v[116:131]
    s_add_u32 m0, s53, 106496
    s_mov_b32 exec_hi, 0
    buffer_load_dwordx4 v229, s[20:23], s42 offen lds
    s_mov_b32 exec_hi, -1
    s_add_u32 s49, s49, 1
    s_and_b32 s49, s49, 7
    s_lshl_b32 s40, s49, 7
    s_mul_i32 s42, s49, 176128
    s_mov_b32 s41, s42
    v_mfma_f32_32x32x16_bf16 v[132:147], v[56:59], v[48:51], v[132:147]
    v_mfma_f32_32x32x16_bf16 v[148:163], v[60:63], v[44:47], v[148:163]
    s_waitcnt vmcnt(7) lgkmcnt(0)
    s_barrier
    v_mfma_f32_32x32x16_bf16 v[84:99], v[72:75], v[64:67], v[84:99]
    ds_read_b128 v[44:47], v24 offset:53248
    ds_read_b64_tr_b16 v[52:53], v36 offset:53248
    ds_read_b64_tr_b16 v[54:55], v36 offset:53760
    ds_read_b128 v[48:51], v28 offset:53248
    v_mfma_f32_32x32x16_bf16 v[100:115], v[72:75], v[68:71], v[100:115]
    ds_read_b64_tr_b16 v[56:57], v38 offset:53248
    ds_read_b64_tr_b16 v[58:59], v38 offset:53760
    ds_read_b64_tr_b16 v[60:61], v40 offset:53248
    ds_read_b64_tr_b16 v[62:63], v41 offset:53248
    v_mfma_f32_32x32x16_bf16 v[116:131], v[76:79], v[64:67], v[116:131]
    s_add_u32 m0, s50, 0
    s_nop 0
    buffer_load_dwordx4 v16, s[8:11], s40 offen offset:0 lds
    v_mfma_f32_32x32x16_bf16 v[132:147], v[76:79], v[68:71], v[132:147]
    v_mfma_f32_32x32x16_bf16 v[148:163], v[80:83], v[64:67], v[148:163]
    buffer_load_dwordx4 v17, s[8:11], s40 offen offset:1024 lds
    s_waitcnt lgkmcnt(0)
    v_mfma_f32_32x32x16_bf16 v[84:99], v[52:55], v[44:47], v[84:99]
    ds_read_b128 v[64:67], v25 offset:53248
    ds_read_b64_tr_b16 v[72:73], v36 offset:55296
    ds_read_b64_tr_b16 v[74:75], v36 offset:55808
    ds_read_b128 v[68:71], v29 offset:53248
    v_mfma_f32_32x32x16_bf16 v[100:115], v[52:55], v[48:51], v[100:115]
    ds_read_b64_tr_b16 v[76:77], v38 offset:55296
    ds_read_b64_tr_b16 v[78:79], v38 offset:55808
    ds_read_b64_tr_b16 v[80:81], v40 offset:53760
    ds_read_b64_tr_b16 v[82:83], v41 offset:53760
    v_mfma_f32_32x32x16_bf16 v[116:131], v[56:59], v[44:47], v[116:131]
    buffer_load_dwordx4 v18, s[8:11], s40 offen offset:2048 lds
    v_mfma_f32_32x32x16_bf16 v[132:147], v[56:59], v[48:51], v[132:147]
    buffer_load_dwordx4 v19, s[8:11], s40 offen offset:3072 lds
    v_mfma_f32_32x32x16_bf16 v[148:163], v[60:63], v[44:47], v[148:163]
    s_waitcnt lgkmcnt(0)
    v_mfma_f32_32x32x16_bf16 v[84:99], v[72:75], v[64:67], v[84:99]
    ds_read_b128 v[44:47], v26 offset:53248
    ds_read_b64_tr_b16 v[52:53], v36 offset:57344
    ds_read_b64_tr_b16 v[54:55], v36 offset:57856
    ds_read_b128 v[48:51], v30 offset:53248
    v_mfma_f32_32x32x16_bf16 v[100:115], v[72:75], v[68:71], v[100:115]
    ds_read_b64_tr_b16 v[56:57], v38 offset:57344
    ds_read_b64_tr_b16 v[58:59], v38 offset:57856
    ds_read_b64_tr_b16 v[60:61], v40 offset:54272
    ds_read_b64_tr_b16 v[62:63], v41 offset:54272
    v_mfma_f32_32x32x16_bf16 v[116:131], v[76:79], v[64:67], v[116:131]
    s_add_u32 m0, s51, 0
    s_nop 0
    buffer_load_dwordx4 v225, s[12:15], s41 offen lds
    v_mfma_f32_32x32x16_bf16 v[132:147], v[76:79], v[68:71], v[132:147]
    s_add_u32 m0, s52, 0
    s_nop 0
    buffer_load_dwordx4 v227, s[16:19], s41 offen lds
    v_mfma_f32_32x32x16_bf16 v[148:163], v[80:83], v[64:67], v[148:163]
    s_waitcnt lgkmcnt(0)
    v_mfma_f32_32x32x16_bf16 v[84:99], v[52:55], v[44:47], v[84:99]
    ds_read_b128 v[64:67], v27 offset:53248
    ds_read_b64_tr_b16 v[72:73], v36 offset:59392
    ds_read_b64_tr_b16 v[74:75], v36 offset:59904
    ds_read_b128 v[68:71], v31 offset:53248
    v_mfma_f32_32x32x16_bf16 v[100:115], v[52:55], v[48:51], v[100:115]
    ds_read_b64_tr_b16 v[76:77], v38 offset:59392
    ds_read_b64_tr_b16 v[78:79], v38 offset:59904
    ds_read_b64_tr_b16 v[80:81], v40 offset:54784
    ds_read_b64_tr_b16 v[82:83], v41 offset:54784
    v_mfma_f32_32x32x16_bf16 v[116:131], v[56:59], v[44:47], v[116:131]
    s_add_u32 m0, s53, 0
    s_mov_b32 exec_hi, 0
    buffer_load_dwordx4 v229, s[20:23], s42 offen lds
    s_mov_b32 exec_hi, -1
    s_add_u32 s49, s49, 1
    s_and_b32 s49, s49, 7
    s_lshl_b32 s40, s49, 7
    s_mul_i32 s42, s49, 176128
    s_mov_b32 s41, s42
    v_mfma_f32_32x32x16_bf16 v[132:147], v[56:59], v[48:51], v[132:147]
    s_cmp_lg_u32 s34, 5
    s_cbranch_scc1 K1_F5_P1
    v_lshlrev_b32 v4, 2, v1
    global_load_dword v223, v4, s[76:77] sc1
K1_F5_P1:
    v_add_u32 v24, 106496, v24
    v_add_u32 v25, 106496, v25
    v_add_u32 v26, 106496, v26
    v_add_u32 v27, 106496, v27
    v_mfma_f32_32x32x16_bf16 v[148:163], v[60:63], v[44:47], v[148:163]
    v_add_u32 v28, 106496, v28
    v_add_u32 v29, 106496, v29
    v_add_u32 v30, 106496, v30
    v_add_u32 v31, 106496, v31
    v_add_u32 v36, 106496, v36
    v_add_u32 v40, 106496, v40
    v_add_u32 v41, 106496, v41
    v_add_u32 v38, 106496, v38
    s_waitcnt vmcnt(7) lgkmcnt(0)
    s_barrier
    v_mfma_f32_32x32x16_bf16 v[84:99], v[72:75], v[64:67], v[84:99]
    ds_read_b128 v[44:47], v24 offset:0
    ds_read_b64_tr_b16 v[52:53], v36 offset:0
    ds_read_b64_tr_b16 v[54:55], v36 offset:512
    ds_read_b128 v[48:51], v28 offset:0
    v_mfma_f32_32x32x16_bf16 v[100:115], v[72:75], v[68:71], v[100:115]
    ds_read_b64_tr_b16 v[56:57], v38 offset:0
    ds_read_b64_tr_b16 v[58:59], v38 offset:512
    ds_read_b64_tr_b16 v[60:61], v40 offset:0
    ds_read_b64_tr_b16 v[62:63], v41 offset:0
    v_mfma_f32_32x32x16_bf16 v[116:131], v[76:79], v[64:67], v[116:131]
    s_add_u32 m0, s50, 53248
    s_nop 0
    buffer_load_dwordx4 v16, s[8:11], s40 offen offset:0 lds
    v_mfma_f32_32x32x16_bf16 v[132:147], v[76:79], v[68:71], v[132:147]
    v_mfma_f32_32x32x16_bf16 v[148:163], v[80:83], v[64:67], v[148:163]
    buffer_load_dwordx4 v17, s[8:11], s40 offen offset:1024 lds
    s_waitcnt lgkmcnt(0)
    v_mfma_f32_32x32x16_bf16 v[84:99], v[52:55], v[44:47], v[84:99]
    ds_read_b128 v[64:67], v25 offset:0
    ds_read_b64_tr_b16 v[72:73], v36 offset:2048
    ds_read_b64_tr_b16 v[74:75], v36 offset:2560
    ds_read_b128 v[68:71], v29 offset:0
    v_mfma_f32_32x32x16_bf16 v[100:115], v[52:55], v[48:51], v[100:115]
    ds_read_b64_tr_b16 v[76:77], v38 offset:2048
    ds_read_b64_tr_b16 v[78:79], v38 offset:2560
    ds_read_b64_tr_b16 v[80:81], v40 offset:512
    ds_read_b64_tr_b16 v[82:83], v41 offset:512
    v_mfma_f32_32x32x16_bf16 v[116:131], v[56:59], v[44:47], v[116:131]
    buffer_load_dwordx4 v18, s[8:11], s40 offen offset:2048 lds
    v_mfma_f32_32x32x16_bf16 v[132:147], v[56:59], v[48:51], v[132:147]
    buffer_load_dwordx4 v19, s[8:11], s40 offen offset:3072 lds
    v_mfma_f32_32x32x16_bf16 v[148:163], v[60:63], v[44:47], v[148:163]
    s_waitcnt lgkmcnt(0)
    v_mfma_f32_32x32x16_bf16 v[84:99], v[72:75], v[64:67], v[84:99]
    ds_read_b128 v[44:47], v26 offset:0
    ds_read_b64_tr_b16 v[52:53], v36 offset:4096
    ds_read_b64_tr_b16 v[54:55], v36 offset:4608
    ds_read_b128 v[48:51], v30 offset:0
    v_mfma_f32_32x32x16_bf16 v[100:115], v[72:75], v[68:71], v[100:115]
    ds_read_b64_tr_b16 v[56:57], v38 offset:4096
    ds_read_b64_tr_b16 v[58:59], v38 offset:4608
    ds_read_b64_tr_b16 v[60:61], v40 offset:1024
    ds_read_b64_tr_b16 v[62:63], v41 offset:1024
    v_mfma_f32_32x32x16_bf16 v[116:131], v[76:79], v[64:67], v[116:131]
    s_add_u32 m0, s51, 53248
    s_nop 0
    buffer_load_dwordx4 v225, s[12:15], s41 offen lds
    v_mfma_f32_32x32x16_bf16 v[132:147], v[76:79], v[68:71], v[132:147]
    s_add_u32 m0, s52, 53248
    s_nop 0
    buffer_load_dwordx4 v227, s[16:19], s41 offen lds
    v_mfma_f32_32x32x16_bf16 v[148:163], v[80:83], v[64:67], v[148:163]
    s_waitcnt lgkmcnt(0)
    v_mfma_f32_32x32x16_bf16 v[84:99], v[52:55], v[44:47], v[84:99]
    ds_read_b128 v[64:67], v27 offset:0
    ds_read_b64_tr_b16 v[72:73], v36 offset:6144
    ds_read_b64_tr_b16 v[74:75], v36 offset:6656
    ds_read_b128 v[68:71], v31 offset:0
    v_mfma_f32_32x32x16_bf16 v[100:115], v[52:55], v[48:51], v[100:115]
    ds_read_b64_tr_b16 v[76:77], v38 offset:6144
    ds_read_b64_tr_b16 v[78:79], v38 offset:6656
    ds_read_b64_tr_b16 v[80:81], v40 offset:1536
    ds_read_b64_tr_b16 v[82:83], v41 offset:1536
    v_mfma_f32_32x32x16_bf16 v[116:131], v[56:59], v[44:47], v[116:131]
    s_add_u32 m0, s53, 53248
    s_mov_b32 exec_hi, 0
    buffer_load_dwordx4 v229, s[20:23], s42 offen lds
    s_mov_b32 exec_hi, -1
    s_cmp_lg_u32 s34, 5
    s_cbranch_scc1 K1_F5_P2
    s_waitcnt vmcnt(7)
    v_and_b32 v11, v223, v221
    v_cmp_ne_u32 vcc, v11, v221
    v_mov_b32 v4, 162816
    v_mov_b32 v5, 0
    s_nop 2
    s_cbranch_vccnz K1_F5_SLOW
K1_F5_RDY:
    ds_write_b32 v4, v5
K1_F5_P2:
    v_mfma_f32_32x32x16_bf16 v[132:147], v[56:59], v[48:51], v[132:147]
    v_subrev_u32 v24, 106496, v24
    v_subrev_u32 v25, 106496, v25
    v_subrev_u32 v26, 106496, v26
    v_mfma_f32_32x32x16_bf16 v[148:163], v[60:63], v[44:47], v[148:163]
    v_subrev_u32 v27, 106496, v27
    v_subrev_u32 v28, 106496, v28
    v_subrev_u32 v29, 106496, v29
    v_subrev_u32 v30, 106496, v30
    v_subrev_u32 v31, 106496, v31
    v_subrev_u32 v36, 106496, v36
    v_subrev_u32 v40, 106496, v40
    v_subrev_u32 v41, 106496, v41
    v_subrev_u32 v38, 106496, v38
    s_waitcnt vmcnt(7) lgkmcnt(0)
    s_barrier
    v_mfma_f32_32x32x16_bf16 v[84:99], v[72:75], v[64:67], v[84:99]
    ds_read_b128 v[44:47], v24 offset:0
    ds_read_b64_tr_b16 v[52:53], v36 offset:0
    ds_read_b64_tr_b16 v[54:55], v36 offset:512
    ds_read_b128 v[48:51], v28 offset:0
    v_mfma_f32_32x32x16_bf16 v[100:115], v[72:75], v[68:71], v[100:115]
    ds_read_b64_tr_b16 v[56:57], v38 offset:0
    ds_read_b64_tr_b16 v[58:59], v38 offset:512
    ds_read_b64_tr_b16 v[60:61], v40 offset:0
    ds_read_b64_tr_b16 v[62:63], v41 offset:0
    v_mfma_f32_32x32x16_bf16 v[116:131], v[76:79], v[64:67], v[116:131]
    v_mov_b32 v11, 162816
    ds_read_b32 v11, v11
    s_mul_i32 s46, s48, 5120
    s_add_u32 s46, s46, 8388608
    s_lshl_b32 s47, s37, 8
    s_add_u32 s47, s47, s46
    v_lshl_add_u32 v4, v1, 2, s47
    v_mfma_f32_32x32x16_bf16 v[132:147], v[76:79], v[68:71], v[132:147]
    v_add_u32 v6, 2560, v4
    v_lshl_add_u32 v5, v2, 2, s46
    v_add_u32 v7, 2560, v5
    s_lshl_b32 s46, s35, 8
    s_lshl_b32 s47, s38, 6
    s_add_u32 s46, s46, s47
    v_mfma_f32_32x32x16_bf16 v[148:163], v[80:83], v[64:67], v[148:163]
    s_lshl_b32 s47, s37, 5
    s_add_u32 s46, s46, s47
    v_add_u32 v8, s46, v2
    v_lshlrev_b32 v8, 3, v8
    v_add_u32 v8, 9437184, v8
    v_xor_b32 v9, 256, v8
    s_waitcnt lgkmcnt(0)
    v_mfma_f32_32x32x16_bf16 v[84:99], v[52:55], v[44:47], v[84:99]
    ds_read_b128 v[64:67], v25 offset:0
    ds_read_b64_tr_b16 v[72:73], v36 offset:2048
    ds_read_b64_tr_b16 v[74:75], v36 offset:2560
    ds_read_b128 v[68:71], v29 offset:0
    v_mfma_f32_32x32x16_bf16 v[100:115], v[52:55], v[48:51], v[100:115]
    ds_read_b64_tr_b16 v[76:77], v38 offset:2048
    ds_read_b64_tr_b16 v[78:79], v38 offset:2560
    ds_read_b64_tr_b16 v[80:81], v40 offset:512
    ds_read_b64_tr_b16 v[82:83], v41 offset:512
    v_mfma_f32_32x32x16_bf16 v[116:131], v[56:59], v[44:47], v[116:131]
    v_readfirstlane_b32 s46, v11
    s_nop 3
    s_cmp_lg_u32 s46, 0
    s_cbranch_scc1 K1_F5_FB
    global_load_dword v232, v4, s[32:33] offset:0 sc1
    global_load_dword v233, v4, s[32:33] offset:640 sc1
    global_load_dword v234, v4, s[32:33] offset:1280 sc1
    global_load_dword v235, v4, s[32:33] offset:1920 sc1
    global_load_dword v236, v6, s[32:33] offset:0 sc1
    global_load_dword v237, v6, s[32:33] offset:640 sc1
    global_load_dword v238, v6, s[32:33] offset:1280 sc1
    global_load_dword v239, v6, s[32:33] offset:1920 sc1
    global_load_dword v240, v5, s[32:33] offset:512 sc1
    global_load_dword v241, v5, s[32:33] offset:1152 sc1
    global_load_dword v242, v5, s[32:33] offset:1792 sc1
    global_load_dword v243, v5, s[32:33] offset:2432 sc1
    global_load_dword v244, v7, s[32:33] offset:512 sc1
    global_load_dword v245, v7, s[32:33] offset:1152 sc1
    global_load_dword v246, v7, s[32:33] offset:1792 sc1
    global_load_dword v247, v7, s[32:33] offset:2432 sc1
    global_load_dwordx2 v[248:249], v8, s[32:33] sc1
    global_load_dwordx2 v[250:251], v9, s[32:33] sc1
K1_F5_HB:
    v_mfma_f32_32x32x16_bf16 v[132:147], v[56:59], v[48:51], v[132:147]
    v_mfma_f32_32x32x16_bf16 v[148:163], v[60:63], v[44:47], v[148:163]
    s_waitcnt lgkmcnt(0)
    v_mfma_f32_32x32x16_bf16 v[84:99], v[72:75], v[64:67], v[84:99]
    ds_read_b128 v[44:47], v26 offset:0
    ds_read_b64_tr_b16 v[52:53], v36 offset:4096
    ds_read_b64_tr_b16 v[54:55], v36 offset:4608
    ds_read_b128 v[48:51], v30 offset:0
    v_mfma_f32_32x32x16_bf16 v[100:115], v[72:75], v[68:71], v[100:115]
    ds_read_b64_tr_b16 v[56:57], v38 offset:4096
    ds_read_b64_tr_b16 v[58:59], v38 offset:4608
    ds_read_b64_tr_b16 v[60:61], v40 offset:1024
    ds_read_b64_tr_b16 v[62:63], v41 offset:1024
    v_mfma_f32_32x32x16_bf16 v[116:131], v[76:79], v[64:67], v[116:131]
    global_load_dword v15, v199, s[70:71]
    v_mfma_f32_32x32x16_bf16 v[132:147], v[76:79], v[68:71], v[132:147]
    global_load_dword v15, v196, s[70:71]
    v_mfma_f32_32x32x16_bf16 v[148:163], v[80:83], v[64:67], v[148:163]
    s_waitcnt lgkmcnt(0)
    v_mfma_f32_32x32x16_bf16 v[84:99], v[52:55], v[44:47], v[84:99]
    ds_read_b128 v[64:67], v27 offset:0
    ds_read_b64_tr_b16 v[72:73], v36 offset:6144
    ds_read_b64_tr_b16 v[74:75], v36 offset:6656
    ds_read_b128 v[68:71], v31 offset:0
    v_mfma_f32_32x32x16_bf16 v[100:115], v[52:55], v[48:51], v[100:115]
    ds_read_b64_tr_b16 v[76:77], v38 offset:6144
    ds_read_b64_tr_b16 v[78:79], v38 offset:6656
    ds_read_b64_tr_b16 v[80:81], v40 offset:1536
    ds_read_b64_tr_b16 v[82:83], v41 offset:1536
    v_mfma_f32_32x32x16_bf16 v[116:131], v[56:59], v[44:47], v[116:131]
    v_mfma_f32_32x32x16_bf16 v[132:147], v[56:59], v[48:51], v[132:147]
    v_mfma_f32_32x32x16_bf16 v[148:163], v[60:63], v[44:47], v[148:163]
    s_waitcnt vmcnt(20) lgkmcnt(0)
    s_barrier
    v_mfma_f32_32x32x16_bf16 v[84:99], v[72:75], v[64:67], v[84:99]
    ds_read_b128 v[44:47], v24 offset:53248
    ds_read_b64_tr_b16 v[52:53], v36 offset:53248
    ds_read_b64_tr_b16 v[54:55], v36 offset:53760
    ds_read_b128 v[48:51], v28 offset:53248
    v_mfma_f32_32x32x16_bf16 v[100:115], v[72:75], v[68:71], v[100:115]
    ds_read_b64_tr_b16 v[56:57], v38 offset:53248
    ds_read_b64_tr_b16 v[58:59], v38 offset:53760
    ds_read_b64_tr_b16 v[60:61], v40 offset:53248
    ds_read_b64_tr_b16 v[62:63], v41 offset:53248
    v_mfma_f32_32x32x16_bf16 v[116:131], v[76:79], v[64:67], v[116:131]
    s_cmp_lt_u32 s34, 4
    s_cbranch_scc1 K1_F5_PR
    s_setprio 1
K1_F5_PR:
    v_mfma_f32_32x32x16_bf16 v[132:147], v[76:79], v[68:71], v[132:147]
    v_mfma_f32_32x32x16_bf16 v[148:163], v[80:83], v[64:67], v[148:163]
    s_waitcnt lgkmcnt(0)
    v_mfma_f32_32x32x16_bf16 v[84:99], v[52:55], v[44:47], v[84:99]
    ds_read_b128 v[64:67], v25 offset:53248
    ds_read_b64_tr_b16 v[72:73], v36 offset:55296
    ds_read_b64_tr_b16 v[74:75], v36 offset:55808
    ds_read_b128 v[68:71], v29 offset:53248
    v_mfma_f32_32x32x16_bf16 v[100:115], v[52:55], v[48:51], v[100:115]
    ds_read_b64_tr_b16 v[76:77], v38 offset:55296
    ds_read_b64_tr_b16 v[78:79], v38 offset:55808
    ds_read_b64_tr_b16 v[80:81], v40 offset:53760
    ds_read_b64_tr_b16 v[82:83], v41 offset:53760
    v_mfma_f32_32x32x16_bf16 v[116:131], v[56:59], v[44:47], v[116:131]
    s_waitcnt vmcnt(2)
    v_add_f32 v232, v232, v233
    v_add_f32 v234, v234, v235
    v_add_f32 v236, v236, v237
    v_add_f32 v238, v238, v239
    v_add_f32 v232, v232, v234
    v_add_f32 v236, v236, v238
    v_mfma_f32_32x32x16_bf16 v[132:147], v[56:59], v[48:51], v[132:147]
    v_add_f32 v232, v232, v236
    v_add_f32 v240, v240, v241
    v_add_f32 v242, v242, v243
    v_add_f32 v244, v244, v245
    v_add_f32 v246, v246, v247
    v_add_f32 v240, v240, v242
    v_add_f32 v244, v244, v246
    v_mfma_f32_32x32x16_bf16 v[148:163], v[60:63], v[44:47], v[148:163]
    v_add_f32 v240, v240, v244
    s_lshl_b32 s47, s34, 9
    v_lshl_add_u32 v8, v1, 2, s47
    v_lshl_add_u32 v9, v3, 4, s47
    ds_write_b32 v8, v232
    ds_write_b32 v8, v240 offset:256
    s_waitcnt lgkmcnt(0)
    v_mfma_f32_32x32x16_bf16 v[84:99], v[72:75], v[64:67], v[84:99]
    ds_read_b128 v[44:47], v26 offset:53248
    ds_read_b64_tr_b16 v[52:53], v36 offset:57344
    ds_read_b64_tr_b16 v[54:55], v36 offset:57856
    ds_read_b128 v[48:51], v30 offset:53248
    v_mfma_f32_32x32x16_bf16 v[100:115], v[72:75], v[68:71], v[100:115]
    ds_read_b64_tr_b16 v[56:57], v38 offset:57344
    ds_read_b64_tr_b16 v[58:59], v38 offset:57856
    ds_read_b64_tr_b16 v[60:61], v40 offset:54272
    ds_read_b64_tr_b16 v[62:63], v41 offset:54272
    v_mfma_f32_32x32x16_bf16 v[116:131], v[76:79], v[64:67], v[116:131]
    ds_read_b128 v[164:167], v9 offset:0
    ds_read_b128 v[168:171], v9 offset:32
    ds_read_b128 v[172:175], v9 offset:64
    ds_read_b128 v[176:179], v9 offset:96
    v_mfma_f32_32x32x16_bf16 v[132:147], v[76:79], v[68:71], v[132:147]
    ds_read_b128 v[180:183], v9 offset:128
    ds_read_b128 v[184:187], v9 offset:160
    ds_read_b128 v[188:191], v9 offset:192
    ds_read_b128 v[192:195], v9 offset:224
    v_mfma_f32_32x32x16_bf16 v[148:163], v[80:83], v[64:67], v[148:163]
    ds_read_b128 v[196:199], v9 offset:256
    ds_read_b128 v[200:203], v9 offset:288
    ds_read_b128 v[204:207], v9 offset:320
    ds_read_b128 v[208:211], v9 offset:352
    s_waitcnt lgkmcnt(0)
    v_mfma_f32_32x32x16_bf16 v[84:99], v[52:55], v[44:47], v[84:99]
    ds_read_b128 v[64:67], v27 offset:53248
    ds_read_b64_tr_b16 v[72:73], v36 offset:59392
    ds_read_b64_tr_b16 v[74:75], v36 offset:59904
    ds_read_b128 v[68:71], v31 offset:53248
    v_mfma_f32_32x32x16_bf16 v[100:115], v[52:55], v[48:51], v[100:115]
    ds_read_b64_tr_b16 v[76:77], v38 offset:59392
    ds_read_b64_tr_b16 v[78:79], v38 offset:59904
    ds_read_b64_tr_b16 v[80:81], v40 offset:54784
    ds_read_b64_tr_b16 v[82:83], v41 offset:54784
    v_mfma_f32_32x32x16_bf16 v[116:131], v[56:59], v[44:47], v[116:131]
    s_mov_b32 s47, 0x3b000000
    v_mul_f32 v212, 0xbb000000, v248
    v_mul_f32 v12, v212, v212
    v_fma_f32 v12, v249, s47, -v12
    v_max_f32 v12, 0, v12
    v_add_f32 v213, 0x3727c5ac, v12
    v_mfma_f32_32x32x16_bf16 v[132:147], v[56:59], v[48:51], v[132:147]
    v_rsq_f32 v218, v213
    s_nop 0
    v_mul_f32 v224, 0xbfb8aa3b, v218
    v_mul_f32 v214, 0xbb000000, v250
    v_mul_f32 v12, v214, v214
    v_fma_f32 v12, v251, s47, -v12
    v_mfma_f32_32x32x16_bf16 v[148:163], v[60:63], v[44:47], v[148:163]
    v_max_f32 v12, 0, v12
    v_add_f32 v215, 0x3727c5ac, v12
    v_rsq_f32 v220, v215
    s_nop 0
    v_mul_f32 v226, 0xbfb8aa3b, v220
    s_waitcnt lgkmcnt(0)
    v_mfma_f32_32x32x16_bf16 v[84:99], v[72:75], v[64:67], v[84:99]
    v_mfma_f32_32x32x16_bf16 v[100:115], v[72:75], v[68:71], v[100:115]
    v_mfma_f32_32x32x16_bf16 v[116:131], v[76:79], v[64:67], v[116:131]
    v_mfma_f32_32x32x16_bf16 v[132:147], v[76:79], v[68:71], v[132:147]
    v_mfma_f32_32x32x16_bf16 v[148:163], v[80:83], v[64:67], v[148:163]
    s_nop 7
    s_lshl_b32 s60, s35, 2
    s_add_u32 s60, s60, s38
    s_mul_i32 s60, s60, 241664
    s_lshl_b32 s47, s37, 10
    s_add_u32 s60, s60, s47
    s_xor_b32 s61, s60, 1024
    s_lshl_b32 s46, s37, 1
    s_add_u32 s46, s46, s58
    s_add_u32 s46, s46, 32
    s_lshl_b32 s46, s46, 11
    s_add_u32 s62, s60, s46
    s_add_u32 s63, s61, s46
    s_add_u32 s64, s62, 2048
    s_add_u32 s65, s63, 2048
    s_add_u32 s46, s57, 32
    s_lshl_b32 s46, s46, 11
    s_add_u32 s66, s60, s46
    v_pk_fma_f32 v[84:85], v[212:213], v[164:165], v[84:85] op_sel:[0,0,0] op_sel_hi:[0,1,1]
    v_pk_fma_f32 v[86:87], v[212:213], v[166:167], v[86:87] op_sel:[0,0,0] op_sel_hi:[0,1,1]
    v_pk_fma_f32 v[88:89], v[212:213], v[168:169], v[88:89] op_sel:[0,0,0] op_sel_hi:[0,1,1]
    v_pk_fma_f32 v[90:91], v[212:213], v[170:171], v[90:91] op_sel:[0,0,0] op_sel_hi:[0,1,1]
    v_pk_fma_f32 v[92:93], v[212:213], v[172:173], v[92:93] op_sel:[0,0,0] op_sel_hi:[0,1,1]
    v_pk_fma_f32 v[94:95], v[212:213], v[174:175], v[94:95] op_sel:[0,0,0] op_sel_hi:[0,1,1]
    v_pk_fma_f32 v[96:97], v[212:213], v[176:177], v[96:97] op_sel:[0,0,0] op_sel_hi:[0,1,1]
    v_pk_fma_f32 v[98:99], v[212:213], v[178:179], v[98:99] op_sel:[0,0,0] op_sel_hi:[0,1,1]
    v_pk_mul_f32 v[232:233], v[224:225], v[84:85] op_sel:[0,0] op_sel_hi:[0,1]
    v_pk_mul_f32 v[234:235], v[224:225], v[86:87] op_sel:[0,0] op_sel_hi:[0,1]
    v_pk_mul_f32 v[236:237], v[224:225], v[88:89] op_sel:[0,0] op_sel_hi:[0,1]
    v_pk_mul_f32 v[238:239], v[224:225], v[90:91] op_sel:[0,0] op_sel_hi:[0,1]
    v_exp_f32 v232, v232
    v_exp_f32 v233, v233
    v_exp_f32 v234, v234
    v_exp_f32 v235, v235
    v_exp_f32 v236, v236
    v_exp_f32 v237, v237
    v_exp_f32 v238, v238
    v_exp_f32 v239, v239
    v_pk_mul_f32 v[84:85], v[84:85], v[92:93] op_sel:[0,0] op_sel_hi:[1,1]
    v_pk_mul_f32 v[86:87], v[86:87], v[94:95] op_sel:[0,0] op_sel_hi:[1,1]
    v_pk_mul_f32 v[88:89], v[88:89], v[96:97] op_sel:[0,0] op_sel_hi:[1,1]
    v_pk_mul_f32 v[90:91], v[90:91], v[98:99] op_sel:[0,0] op_sel_hi:[1,1]
    v_fma_f32 v232, v232, v213, v213
    v_fma_f32 v233, v233, v213, v213
    v_fma_f32 v234, v234, v213, v213
    v_fma_f32 v235, v235, v213, v213
    v_fma_f32 v236, v236, v213, v213
    v_fma_f32 v237, v237, v213, v213
    v_fma_f32 v238, v238, v213, v213
    v_fma_f32 v239, v239, v213, v213
    v_rcp_f32 v232, v232
    v_rcp_f32 v233, v233
    v_rcp_f32 v234, v234
    v_rcp_f32 v235, v235
    v_rcp_f32 v236, v236
    v_rcp_f32 v237, v237
    v_rcp_f32 v238, v238
    v_rcp_f32 v239, v239
    s_nop 0
    v_pk_mul_f32 v[84:85], v[84:85], v[232:233] op_sel:[0,0] op_sel_hi:[1,1]
    v_pk_mul_f32 v[86:87], v[86:87], v[234:235] op_sel:[0,0] op_sel_hi:[1,1]
    v_pk_mul_f32 v[88:89], v[88:89], v[236:237] op_sel:[0,0] op_sel_hi:[1,1]
    v_pk_mul_f32 v[90:91], v[90:91], v[238:239] op_sel:[0,0] op_sel_hi:[1,1]
    v_cvt_pk_bf16_f32 v92, v84, v85
    v_cvt_pk_bf16_f32 v93, v86, v87
    v_cvt_pk_bf16_f32 v94, v88, v89
    v_cvt_pk_bf16_f32 v95, v90, v91
    buffer_store_dwordx4 v[92:95], v219, s[24:27], s62 offen sc0 sc1
    v_pk_fma_f32 v[100:101], v[214:215], v[164:165], v[100:101] op_sel:[0,0,0] op_sel_hi:[0,1,1]
    v_pk_fma_f32 v[102:103], v[214:215], v[166:167], v[102:103] op_sel:[0,0,0] op_sel_hi:[0,1,1]
    v_pk_fma_f32 v[104:105], v[214:215], v[168:169], v[104:105] op_sel:[0,0,0] op_sel_hi:[0,1,1]
    v_pk_fma_f32 v[106:107], v[214:215], v[170:171], v[106:107] op_sel:[0,0,0] op_sel_hi:[0,1,1]
    v_pk_fma_f32 v[108:109], v[214:215], v[172:173], v[108:109] op_sel:[0,0,0] op_sel_hi:[0,1,1]
    v_pk_fma_f32 v[110:111], v[214:215], v[174:175], v[110:111] op_sel:[0,0,0] op_sel_hi:[0,1,1]
    v_pk_fma_f32 v[112:113], v[214:215], v[176:177], v[112:113] op_sel:[0,0,0] op_sel_hi:[0,1,1]
    v_pk_fma_f32 v[114:115], v[214:215], v[178:179], v[114:115] op_sel:[0,0,0] op_sel_hi:[0,1,1]
    v_pk_mul_f32 v[232:233], v[226:227], v[100:101] op_sel:[0,0] op_sel_hi:[0,1]
    v_pk_mul_f32 v[234:235], v[226:227], v[102:103] op_sel:[0,0] op_sel_hi:[0,1]
    v_pk_mul_f32 v[236:237], v[226:227], v[104:105] op_sel:[0,0] op_sel_hi:[0,1]
    v_pk_mul_f32 v[238:239], v[226:227], v[106:107] op_sel:[0,0] op_sel_hi:[0,1]
    v_exp_f32 v232, v232
    v_exp_f32 v233, v233
    v_exp_f32 v234, v234
    v_exp_f32 v235, v235
    v_exp_f32 v236, v236
    v_exp_f32 v237, v237
    v_exp_f32 v238, v238
    v_exp_f32 v239, v239
    v_pk_mul_f32 v[100:101], v[100:101], v[108:109] op_sel:[0,0] op_sel_hi:[1,1]
    v_pk_mul_f32 v[102:103], v[102:103], v[110:111] op_sel:[0,0] op_sel_hi:[1,1]
    v_pk_mul_f32 v[104:105], v[104:105], v[112:113] op_sel:[0,0] op_sel_hi:[1,1]
    v_pk_mul_f32 v[106:107], v[106:107], v[114:115] op_sel:[0,0] op_sel_hi:[1,1]
    v_fma_f32 v232, v232, v215, v215
    v_fma_f32 v233, v233, v215, v215
    v_fma_f32 v234, v234, v215, v215
    v_fma_f32 v235, v235, v215, v215
    v_fma_f32 v236, v236, v215, v215
    v_fma_f32 v237, v237, v215, v215
    v_fma_f32 v238, v238, v215, v215
    v_fma_f32 v239, v239, v215, v215
    v_rcp_f32 v232, v232
    v_rcp_f32 v233, v233
    v_rcp_f32 v234, v234
    v_rcp_f32 v235, v235
    v_rcp_f32 v236, v236
    v_rcp_f32 v237, v237
    v_rcp_f32 v238, v238
    v_rcp_f32 v239, v239
    s_nop 0
    v_pk_mul_f32 v[100:101], v[100:101], v[232:233] op_sel:[0,0] op_sel_hi:[1,1]
    v_pk_mul_f32 v[102:103], v[102:103], v[234:235] op_sel:[0,0] op_sel_hi:[1,1]
    v_pk_mul_f32 v[104:105], v[104:105], v[236:237] op_sel:[0,0] op_sel_hi:[1,1]
    v_pk_mul_f32 v[106:107], v[106:107], v[238:239] op_sel:[0,0] op_sel_hi:[1,1]
    v_cvt_pk_bf16_f32 v108, v100, v101
    v_cvt_pk_bf16_f32 v109, v102, v103
    v_cvt_pk_bf16_f32 v110, v104, v105
    v_cvt_pk_bf16_f32 v111, v106, v107
    buffer_store_dwordx4 v[108:111], v219, s[24:27], s63 offen sc0 sc1
    v_pk_fma_f32 v[116:117], v[212:213], v[180:181], v[116:117] op_sel:[0,0,0] op_sel_hi:[0,1,1]
    v_pk_fma_f32 v[118:119], v[212:213], v[182:183], v[118:119] op_sel:[0,0,0] op_sel_hi:[0,1,1]
    v_pk_fma_f32 v[120:121], v[212:213], v[184:185], v[120:121] op_sel:[0,0,0] op_sel_hi:[0,1,1]
    v_pk_fma_f32 v[122:123], v[212:213], v[186:187], v[122:123] op_sel:[0,0,0] op_sel_hi:[0,1,1]
    v_pk_fma_f32 v[124:125], v[212:213], v[188:189], v[124:125] op_sel:[0,0,0] op_sel_hi:[0,1,1]
    v_pk_fma_f32 v[126:127], v[212:213], v[190:191], v[126:127] op_sel:[0,0,0] op_sel_hi:[0,1,1]
    v_pk_fma_f32 v[128:129], v[212:213], v[192:193], v[128:129] op_sel:[0,0,0] op_sel_hi:[0,1,1]
    v_pk_fma_f32 v[130:131], v[212:213], v[194:195], v[130:131] op_sel:[0,0,0] op_sel_hi:[0,1,1]
    v_pk_mul_f32 v[232:233], v[224:225], v[116:117] op_sel:[0,0] op_sel_hi:[0,1]
    v_pk_mul_f32 v[234:235], v[224:225], v[118:119] op_sel:[0,0] op_sel_hi:[0,1]
    v_pk_mul_f32 v[236:237], v[224:225], v[120:121] op_sel:[0,0] op_sel_hi:[0,1]
    v_pk_mul_f32 v[238:239], v[224:225], v[122:123] op_sel:[0,0] op_sel_hi:[0,1]
    v_exp_f32 v232, v232
    v_exp_f32 v233, v233
    v_exp_f32 v234, v234
    v_exp_f32 v235, v235
    v_exp_f32 v236, v236
    v_exp_f32 v237, v237
    v_exp_f32 v238, v238
    v_exp_f32 v239, v239
    v_pk_mul_f32 v[116:117], v[116:117], v[124:125] op_sel:[0,0] op_sel_hi:[1,1]
    v_pk_mul_f32 v[118:119], v[118:119], v[126:127] op_sel:[0,0] op_sel_hi:[1,1]
    v_pk_mul_f32 v[120:121], v[120:121], v[128:129] op_sel:[0,0] op_sel_hi:[1,1]
    v_pk_mul_f32 v[122:123], v[122:123], v[130:131] op_sel:[0,0] op_sel_hi:[1,1]
    v_fma_f32 v232, v232, v213, v213
    v_fma_f32 v233, v233, v213, v213
    v_fma_f32 v234, v234, v213, v213
    v_fma_f32 v235, v235, v213, v213
    v_fma_f32 v236, v236, v213, v213
    v_fma_f32 v237, v237, v213, v213
    v_fma_f32 v238, v238, v213, v213
    v_fma_f32 v239, v239, v213, v213
    v_rcp_f32 v232, v232
    v_rcp_f32 v233, v233
    v_rcp_f32 v234, v234
    v_rcp_f32 v235, v235
    v_rcp_f32 v236, v236
    v_rcp_f32 v237, v237
    v_rcp_f32 v238, v238
    v_rcp_f32 v239, v239
    s_nop 0
    v_pk_mul_f32 v[116:117], v[116:117], v[232:233] op_sel:[0,0] op_sel_hi:[1,1]
    v_pk_mul_f32 v[118:119], v[118:119], v[234:235] op_sel:[0,0] op_sel_hi:[1,1]
    v_pk_mul_f32 v[120:121], v[120:121], v[236:237] op_sel:[0,0] op_sel_hi:[1,1]
    v_pk_mul_f32 v[122:123], v[122:123], v[238:239] op_sel:[0,0] op_sel_hi:[1,1]
    v_cvt_pk_bf16_f32 v124, v116, v117
    v_cvt_pk_bf16_f32 v125, v118, v119
    v_cvt_pk_bf16_f32 v126, v120, v121
    v_cvt_pk_bf16_f32 v127, v122, v123
    buffer_store_dwordx4 v[124:127], v219, s[24:27], s64 offen sc0 sc1
    v_pk_fma_f32 v[132:133], v[214:215], v[180:181], v[132:133] op_sel:[0,0,0] op_sel_hi:[0,1,1]
    v_pk_fma_f32 v[134:135], v[214:215], v[182:183], v[134:135] op_sel:[0,0,0] op_sel_hi:[0,1,1]
    v_pk_fma_f32 v[136:137], v[214:215], v[184:185], v[136:137] op_sel:[0,0,0] op_sel_hi:[0,1,1]
    v_pk_fma_f32 v[138:139], v[214:215], v[186:187], v[138:139] op_sel:[0,0,0] op_sel_hi:[0,1,1]
    v_pk_fma_f32 v[140:141], v[214:215], v[188:189], v[140:141] op_sel:[0,0,0] op_sel_hi:[0,1,1]
    v_pk_fma_f32 v[142:143], v[214:215], v[190:191], v[142:143] op_sel:[0,0,0] op_sel_hi:[0,1,1]
    v_pk_fma_f32 v[144:145], v[214:215], v[192:193], v[144:145] op_sel:[0,0,0] op_sel_hi:[0,1,1]
    v_pk_fma_f32 v[146:147], v[214:215], v[194:195], v[146:147] op_sel:[0,0,0] op_sel_hi:[0,1,1]
    v_pk_mul_f32 v[232:233], v[226:227], v[132:133] op_sel:[0,0] op_sel_hi:[0,1]
    v_pk_mul_f32 v[234:235], v[226:227], v[134:135] op_sel:[0,0] op_sel_hi:[0,1]
    v_pk_mul_f32 v[236:237], v[226:227], v[136:137] op_sel:[0,0] op_sel_hi:[0,1]
    v_pk_mul_f32 v[238:239], v[226:227], v[138:139] op_sel:[0,0] op_sel_hi:[0,1]
    v_exp_f32 v232, v232
    v_exp_f32 v233, v233
    v_exp_f32 v234, v234
    v_exp_f32 v235, v235
    v_exp_f32 v236, v236
    v_exp_f32 v237, v237
    v_exp_f32 v238, v238
    v_exp_f32 v239, v239
    v_pk_mul_f32 v[132:133], v[132:133], v[140:141] op_sel:[0,0] op_sel_hi:[1,1]
    v_pk_mul_f32 v[134:135], v[134:135], v[142:143] op_sel:[0,0] op_sel_hi:[1,1]
    v_pk_mul_f32 v[136:137], v[136:137], v[144:145] op_sel:[0,0] op_sel_hi:[1,1]
    v_pk_mul_f32 v[138:139], v[138:139], v[146:147] op_sel:[0,0] op_sel_hi:[1,1]
    v_fma_f32 v232, v232, v215, v215
    v_fma_f32 v233, v233, v215, v215
    v_fma_f32 v234, v234, v215, v215
    v_fma_f32 v235, v235, v215, v215
    v_fma_f32 v236, v236, v215, v215
    v_fma_f32 v237, v237, v215, v215
    v_fma_f32 v238, v238, v215, v215
    v_fma_f32 v239, v239, v215, v215
    v_rcp_f32 v232, v232
    v_rcp_f32 v233, v233
    v_rcp_f32 v234, v234
    v_rcp_f32 v235, v235
    v_rcp_f32 v236, v236
    v_rcp_f32 v237, v237
    v_rcp_f32 v238, v238
    v_rcp_f32 v239, v239
    s_nop 0
    v_pk_mul_f32 v[132:133], v[132:133], v[232:233] op_sel:[0,0] op_sel_hi:[1,1]
    v_pk_mul_f32 v[134:135], v[134:135], v[234:235] op_sel:[0,0] op_sel_hi:[1,1]
    v_pk_mul_f32 v[136:137], v[136:137], v[236:237] op_sel:[0,0] op_sel_hi:[1,1]
    v_pk_mul_f32 v[138:139], v[138:139], v[238:239] op_sel:[0,0] op_sel_hi:[1,1]
    v_cvt_pk_bf16_f32 v140, v132, v133
    v_cvt_pk_bf16_f32 v141, v134, v135
    v_cvt_pk_bf16_f32 v142, v136, v137
    v_cvt_pk_bf16_f32 v143, v138, v139
    buffer_store_dwordx4 v[140:143], v219, s[24:27], s65 offen sc0 sc1
    v_pk_fma_f32 v[148:149], v[212:213], v[196:197], v[148:149] op_sel:[0,0,0] op_sel_hi:[0,1,1]
    v_pk_fma_f32 v[150:151], v[212:213], v[198:199], v[150:151] op_sel:[0,0,0] op_sel_hi:[0,1,1]
    v_pk_fma_f32 v[152:153], v[212:213], v[200:201], v[152:153] op_sel:[0,0,0] op_sel_hi:[0,1,1]
    v_pk_fma_f32 v[154:155], v[212:213], v[202:203], v[154:155] op_sel:[0,0,0] op_sel_hi:[0,1,1]
    v_pk_fma_f32 v[156:157], v[212:213], v[204:205], v[156:157] op_sel:[0,0,0] op_sel_hi:[0,1,1]
    v_pk_fma_f32 v[158:159], v[212:213], v[206:207], v[158:159] op_sel:[0,0,0] op_sel_hi:[0,1,1]
    v_pk_fma_f32 v[160:161], v[212:213], v[208:209], v[160:161] op_sel:[0,0,0] op_sel_hi:[0,1,1]
    v_pk_fma_f32 v[162:163], v[212:213], v[210:211], v[162:163] op_sel:[0,0,0] op_sel_hi:[0,1,1]
    v_pk_mul_f32 v[232:233], v[224:225], v[148:149] op_sel:[0,0] op_sel_hi:[0,1]
    v_pk_mul_f32 v[234:235], v[224:225], v[150:151] op_sel:[0,0] op_sel_hi:[0,1]
    v_pk_mul_f32 v[236:237], v[224:225], v[152:153] op_sel:[0,0] op_sel_hi:[0,1]
    v_pk_mul_f32 v[238:239], v[224:225], v[154:155] op_sel:[0,0] op_sel_hi:[0,1]
    v_exp_f32 v232, v232
    v_exp_f32 v233, v233
    v_exp_f32 v234, v234
    v_exp_f32 v235, v235
    v_exp_f32 v236, v236
    v_exp_f32 v237, v237
    v_exp_f32 v238, v238
    v_exp_f32 v239, v239
    v_pk_mul_f32 v[148:149], v[148:149], v[156:157] op_sel:[0,0] op_sel_hi:[1,1]
    v_pk_mul_f32 v[150:151], v[150:151], v[158:159] op_sel:[0,0] op_sel_hi:[1,1]
    v_pk_mul_f32 v[152:153], v[152:153], v[160:161] op_sel:[0,0] op_sel_hi:[1,1]
    v_pk_mul_f32 v[154:155], v[154:155], v[162:163] op_sel:[0,0] op_sel_hi:[1,1]
    v_fma_f32 v232, v232, v213, v213
    v_fma_f32 v233, v233, v213, v213
    v_fma_f32 v234, v234, v213, v213
    v_fma_f32 v235, v235, v213, v213
    v_fma_f32 v236, v236, v213, v213
    v_fma_f32 v237, v237, v213, v213
    v_fma_f32 v238, v238, v213, v213
    v_fma_f32 v239, v239, v213, v213
    v_rcp_f32 v232, v232
    v_rcp_f32 v233, v233
    v_rcp_f32 v234, v234
    v_rcp_f32 v235, v235
    v_rcp_f32 v236, v236
    v_rcp_f32 v237, v237
    v_rcp_f32 v238, v238
    v_rcp_f32 v239, v239
    s_nop 0
    v_pk_mul_f32 v[148:149], v[148:149], v[232:233] op_sel:[0,0] op_sel_hi:[1,1]
    v_pk_mul_f32 v[150:151], v[150:151], v[234:235] op_sel:[0,0] op_sel_hi:[1,1]
    v_pk_mul_f32 v[152:153], v[152:153], v[236:237] op_sel:[0,0] op_sel_hi:[1,1]
    v_pk_mul_f32 v[154:155], v[154:155], v[238:239] op_sel:[0,0] op_sel_hi:[1,1]
    v_cvt_pk_bf16_f32 v156, v148, v149
    v_cvt_pk_bf16_f32 v157, v150, v151
    v_cvt_pk_bf16_f32 v158, v152, v153
    v_cvt_pk_bf16_f32 v159, v154, v155
    buffer_store_dwordx4 v[156:159], v219, s[24:27], s66 offen sc0 sc1
    s_endpgm
K1_ATT_SETUP:
    s_mul_i32 s41, s49, 196608
    s_mul_i32 s51, s34, 1536
    s_add_u32 s51, s51, 32768
    s_lshl_b32 s52, s34, 9
    s_add_u32 s52, s52, 45056
    s_lshl_b32 s46, s34, 3
    s_lshl_b32 s47, s36, 6
    v_add_u32 v8, 0, v1
    v_mul_u32_u24 v9, 171, v8
    v_lshrrev_b32 v9, 11, v9
    v_mul_u32_u24 v14, 12, v9
    v_sub_u32 v8, v8, v14
    v_add_u32 v9, s46, v9
    v_mul_u32_u24 v9, 3072, v9
    v_lshrrev_b32 v14, 2, v8
    v_lshl_add_u32 v9, v14, 10, v9
    v_and_b32 v8, 3, v8
    v_lshl_add_u32 v9, v8, 4, v9
    v_add_u32 v225, s47, v9
    v_add_u32 v8, 64, v1
    v_mul_u32_u24 v9, 171, v8
    v_lshrrev_b32 v9, 11, v9
    v_mul_u32_u24 v14, 12, v9
    v_sub_u32 v8, v8, v14
    v_add_u32 v9, s46, v9
    v_mul_u32_u24 v9, 3072, v9
    v_lshrrev_b32 v14, 2, v8
    v_lshl_add_u32 v9, v14, 10, v9
    v_and_b32 v8, 3, v8
    v_lshl_add_u32 v9, v8, 4, v9
    v_add_u32 v227, s47, v9
    v_subrev_u32 v227, 1024, v227
    s_lshl_b32 s46, s35, 8
    s_sub_u32 s46, s46, 32
    s_cmp_eq_u32 s35, 0
    s_cselect_b32 s46, 0, s46
    s_lshl_b32 s47, s34, 2
    s_add_u32 s46, s46, s47
    v_add_u32 v8, s46, v5
    v_lshlrev_b32 v8, 10, v8
    s_lshl_b32 s47, s34, 1
    v_add_u32 v9, s47, v6
    v_and_b32 v9, 7, v9
    v_xor_b32 v9, v9, v7
    v_lshl_add_u32 v20, v9, 4, v8
    s_mov_b32 s22, 1409024
    s_mov_b32 s23, 0x20000
    s_mov_b32 s26, 7733248
    s_mov_b32 s27, 0x20000
    s_mov_b32 s15, 0x20000
    s_mov_b32 s19, 0x20000
    s_mov_b32 s14, 1572864
    s_mov_b32 s18, 1572864
    s_cmp_lt_u32 s34, 4
    s_mov_b64 s[12:13], s[6:7]
    s_mov_b64 s[16:17], s[6:7]
    s_cselect_b64 s[20:21], s[28:29], s[30:31]
    s_mov_b64 s[32:33], s[78:79]
    s_mov_b64 s[24:25], s[78:79]
    s_add_u32 m0, s51, 0
    s_nop 0
    buffer_load_dwordx4 v225, s[12:15], s41 offen lds
    s_mov_b32 exec_hi, 0
    buffer_load_dwordx4 v227, s[12:15], s41 offen offset:1024 lds
    s_mov_b32 exec_hi, -1
    s_add_u32 m0, s52, 0
    s_mov_b32 exec_hi, 0
    buffer_load_dwordx4 v20, s[8:11], s40 offen lds
    s_mov_b32 exec_hi, -1
    s_add_u32 m0, s53, 0
    s_mov_b32 exec_hi, 0
    buffer_load_dwordx4 v229, s[20:23], s42 offen lds
    s_mov_b32 exec_hi, -1
    s_add_u32 s49, s49, 1
    s_and_b32 s49, s49, 7
    s_lshl_b32 s40, s49, 7
    s_mul_i32 s42, s49, 176128
    s_mul_i32 s41, s49, 196608
    s_cmp_eq_u32 s34, 3
    s_cselect_b32 s59, 2, s37
    v_mul_u32_u24 v8, 192, v13
    v_lshl_add_u32 v8, v11, 3, v8
    v_lshl_add_u32 v8, v12, 5, v8
    s_lshl_b32 s46, s59, 6
    s_add_u32 s46, s46, 32768
    v_add_u32 v36, s46, v8
    s_sub_u32 s67, 3, s59
    s_lshl_b32 s46, s67, 6
    s_add_u32 s46, s46, 32768
    v_add_u32 v38, s46, v8
    v_lshlrev_b32 v8, 2, v12
    v_xor_b32 v8, v8, v13
    v_lshlrev_b32 v8, 5, v8
    v_lshl_add_u32 v8, v11, 3, v8
    v_lshl_add_u32 v8, v12, 11, v8
    v_add_u32 v40, 49152, v8
    v_lshlrev_b32 v8, 2, v12
    v_xor_b32 v8, v8, v13
    v_xor_b32 v8, 4, v8
    v_lshlrev_b32 v8, 5, v8
    v_lshl_add_u32 v8, v11, 3, v8
    v_lshl_add_u32 v8, v12, 11, v8
    v_add_u32 v41, 49152, v8
    v_bfe_u32 v8, v2, 1, 3
    v_xor_b32 v8, v8, v3
    v_lshlrev_b32 v8, 4, v8
    v_lshl_add_u32 v8, v2, 7, v8
    s_lshl_b32 s46, s38, 13
    s_lshl_b32 s47, s37, 12
    s_add_u32 s46, s46, s47
    s_xor_b32 s47, s46, 4096
    v_xor_b32 v9, 0, v8
    v_add_u32 v24, s46, v9
    v_add_u32 v28, s47, v9
    v_add_u32 v32, 45056, v9
    v_xor_b32 v9, 32, v8
    v_add_u32 v25, s46, v9
    v_add_u32 v29, s47, v9
    v_add_u32 v33, 45056, v9
    v_xor_b32 v9, 64, v8
    v_add_u32 v26, s46, v9
    v_add_u32 v30, s47, v9
    v_add_u32 v34, 45056, v9
    v_xor_b32 v9, 96, v8
    v_add_u32 v27, s46, v9
    v_add_u32 v31, s47, v9
    v_add_u32 v35, 45056, v9
    s_sub_u32 s46, s35, 1
    s_cmp_eq_u32 s35, 0
    s_cselect_b32 s46, 0, s46
    v_mov_b32 v221, 0
    v_mov_b32 v8, 0x01010101
    v_cmp_eq_u32 vcc, s35, v5
    s_nop 1
    v_cndmask_b32 v221, v221, v8, vcc
    v_cmp_eq_u32 vcc, s46, v5
    s_nop 1
    v_cndmask_b32 v221, v221, v8, vcc
    s_and_b32 s46, s48, 3
    s_lshl_b32 s46, s46, 3
    s_lshl_b32 s46, 1, s46
    s_lshr_b32 s47, s48, 2
    v_or_b32 v8, s46, v221
    v_cmp_eq_u32 vcc, s47, v7
    s_nop 1
    v_cndmask_b32 v221, v221, v8, vcc
    s_lshr_b32 s43, s39, 1
    s_lshl_b32 s43, s43, 2
    s_bfe_u32 s46, s2, 0x20003
    s_add_u32 s43, s43, s46
    s_lshl_b32 s43, s43, 3
    s_add_u32 s43, s43, s34
    s_lshl_b32 s43, s43, 1
    s_sub_u32 s46, s43, 64
    s_min_u32 s46, s46, 170
    s_cmp_lt_u32 s43, 64
    s_cselect_b32 s46, s43, s46
    s_lshl_b32 s46, s46, 13
    v_lshl_add_u32 v199, v1, 7, s46
    v_add_u32 v196, 8192, v199
    s_mov_b32 s66, 1572864
    s_mov_b32 s67, 0x20000
    s_lshl_b32 s60, s60, 3
    s_add_u32 s60, s60, 9437184
    s_cmp_lt_u32 s43, 64
    s_cselect_b64 s[70:71], s[72:73], s[96:97]
    s_barrier
    buffer_load_dwordx4 v[232:235], v219, s[8:11], s61 offen
    s_add_u32 m0, s50, 53248
    s_nop 0
    buffer_load_dwordx4 v16, s[8:11], s40 offen offset:0 lds
    buffer_load_dwordx4 v17, s[8:11], s40 offen offset:1024 lds
    buffer_load_dwordx4 v18, s[8:11], s40 offen offset:2048 lds
    buffer_load_dwordx4 v19, s[8:11], s40 offen offset:3072 lds
    s_add_u32 m0, s51, 53248
    s_nop 0
    buffer_load_dwordx4 v225, s[12:15], s41 offen lds
    s_mov_b32 exec_hi, 0
    buffer_load_dwordx4 v227, s[12:15], s41 offen offset:1024 lds
    s_mov_b32 exec_hi, -1
    s_add_u32 m0, s52, 53248
    s_mov_b32 exec_hi, 0
    buffer_load_dwordx4 v20, s[8:11], s40 offen lds
    s_mov_b32 exec_hi, -1
    s_add_u32 m0, s53, 53248
    s_mov_b32 exec_hi, 0
    buffer_load_dwordx4 v229, s[20:23], s42 offen lds
    s_mov_b32 exec_hi, -1
    s_add_u32 s49, s49, 1
    s_and_b32 s49, s49, 7
    s_lshl_b32 s40, s49, 7
    s_mul_i32 s42, s49, 176128
    s_mul_i32 s41, s49, 196608
    s_waitcnt vmcnt(9)
    s_cmp_eq_u32 s37, 0
    s_cbranch_scc1 K1_A0
    s_cmp_lt_u32 s34, 4
    s_cbranch_scc1 K1_A1H
    s_branch K1_A1
K1_A1_SLOW:
    s_mov_b32 s62, 0
K1_A1_SPIN:
    s_add_u32 s62, s62, 1
    s_cmp_ge_u32 s62, 4000
    s_cbranch_scc1 K1_A1_FB1
    s_sleep 4
    v_lshlrev_b32 v11, 2, v1
    global_load_dword v223, v11, s[76:77] sc1
    s_waitcnt vmcnt(0)
    v_and_b32 v11, v223, v221
    v_cmp_ne_u32 vcc, v11, v221
    s_nop 4
    s_cbranch_vccz K1_A1_RDY
    s_branch K1_A1_SPIN
K1_A1_FB1:
    v_mov_b32 v5, 1
    s_branch K1_A1_RDY
K1_A1_FB:
    s_lshl_b32 s63, s35, 8
    s_lshl_b32 s47, s38, 6
    s_add_u32 s63, s63, s47
    s_lshl_b32 s47, s37, 5
    s_add_u32 s63, s63, s47
    s_mov_b32 s62, 0
K1_A1_FS0:
    s_add_u32 s64, s63, s62
    s_lshl_b32 s64, s64, 10
    buffer_load_dwordx4 v[164:167], v219, s[8:11], s64 offen
    s_waitcnt vmcnt(0)
    v_mov_b32 v8, 0
    v_mov_b32 v9, 0
    v_dot2c_f32_bf16 v8, s54, v164
    v_dot2c_f32_bf16 v9, v164, v164
    v_dot2c_f32_bf16 v8, s54, v165
    v_dot2c_f32_bf16 v9, v165, v165
    v_dot2c_f32_bf16 v8, s54, v166
    v_dot2c_f32_bf16 v9, v166, v166
    v_dot2c_f32_bf16 v8, s54, v167
    v_dot2c_f32_bf16 v9, v167, v167
    s_nop 2
    v_add_f32_dpp v8, v8, v8 row_shr:1 row_mask:0xf bank_mask:0xf bound_ctrl:0
    v_add_f32_dpp v9, v9, v9 row_shr:1 row_mask:0xf bank_mask:0xf bound_ctrl:0
    s_nop 0
    v_add_f32_dpp v8, v8, v8 row_shr:2 row_mask:0xf bank_mask:0xf bound_ctrl:0
    v_add_f32_dpp v9, v9, v9 row_shr:2 row_mask:0xf bank_mask:0xf bound_ctrl:0
    s_nop 0
    v_add_f32_dpp v8, v8, v8 row_shr:4 row_mask:0xf bank_mask:0xf bound_ctrl:0
    v_add_f32_dpp v9, v9, v9 row_shr:4 row_mask:0xf bank_mask:0xf bound_ctrl:0
    s_nop 0
    v_add_f32_dpp v8, v8, v8 row_shr:8 row_mask:0xf bank_mask:0xf bound_ctrl:0
    v_add_f32_dpp v9, v9, v9 row_shr:8 row_mask:0xf bank_mask:0xf bound_ctrl:0
    s_nop 0
    v_add_f32_dpp v8, v8, v8 row_bcast:15 row_mask:0xa bank_mask:0xf
    v_add_f32_dpp v9, v9, v9 row_bcast:15 row_mask:0xa bank_mask:0xf
    s_nop 0
    v_add_f32_dpp v8, v8, v8 row_bcast:31 row_mask:0xc bank_mask:0xf
    v_add_f32_dpp v9, v9, v9 row_bcast:31 row_mask:0xc bank_mask:0xf
    s_nop 0
    v_readlane_b32 s46, v8, 63
    v_readlane_b32 s47, v9, 63
    s_nop 1
    v_mov_b32 v8, s46
    v_mov_b32 v9, s47
    v_cmp_eq_u32 vcc, s62, v2
    s_nop 1
    v_cndmask_b32 v248, v248, v8, vcc
    v_cndmask_b32 v249, v249, v9, vcc
    s_add_u32 s62, s62, 1
    s_cmp_lt_u32 s62, 32
    s_cbranch_scc1 K1_A1_FS0
    s_xor_b32 s63, s63, 32
    s_mov_b32 s62, 0
K1_A1_FS1:
    s_add_u32 s64, s63, s62
    s_lshl_b32 s64, s64, 10
    buffer_load_dwordx4 v[164:167], v219, s[8:11], s64 offen
    s_waitcnt vmcnt(0)
    v_mov_b32 v8, 0
    v_mov_b32 v9, 0
    v_dot2c_f32_bf16 v8, s54, v164
    v_dot2c_f32_bf16 v9, v164, v164
    v_dot2c_f32_bf16 v8, s54, v165
    v_dot2c_f32_bf16 v9, v165, v165
    v_dot2c_f32_bf16 v8, s54, v166
    v_dot2c_f32_bf16 v9, v166, v166
    v_dot2c_f32_bf16 v8, s54, v167
    v_dot2c_f32_bf16 v9, v167, v167
    s_nop 2
    v_add_f32_dpp v8, v8, v8 row_shr:1 row_mask:0xf bank_mask:0xf bound_ctrl:0
    v_add_f32_dpp v9, v9, v9 row_shr:1 row_mask:0xf bank_mask:0xf bound_ctrl:0
    s_nop 0
    v_add_f32_dpp v8, v8, v8 row_shr:2 row_mask:0xf bank_mask:0xf bound_ctrl:0
    v_add_f32_dpp v9, v9, v9 row_shr:2 row_mask:0xf bank_mask:0xf bound_ctrl:0
    s_nop 0
    v_add_f32_dpp v8, v8, v8 row_shr:4 row_mask:0xf bank_mask:0xf bound_ctrl:0
    v_add_f32_dpp v9, v9, v9 row_shr:4 row_mask:0xf bank_mask:0xf bound_ctrl:0
    s_nop 0
    v_add_f32_dpp v8, v8, v8 row_shr:8 row_mask:0xf bank_mask:0xf bound_ctrl:0
    v_add_f32_dpp v9, v9, v9 row_shr:8 row_mask:0xf bank_mask:0xf bound_ctrl:0
    s_nop 0
    v_add_f32_dpp v8, v8, v8 row_bcast:15 row_mask:0xa bank_mask:0xf
    v_add_f32_dpp v9, v9, v9 row_bcast:15 row_mask:0xa bank_mask:0xf
    s_nop 0
    v_add_f32_dpp v8, v8, v8 row_bcast:31 row_mask:0xc bank_mask:0xf
    v_add_f32_dpp v9, v9, v9 row_bcast:31 row_mask:0xc bank_mask:0xf
    s_nop 0
    v_readlane_b32 s46, v8, 63
    v_readlane_b32 s47, v9, 63
    s_nop 1
    v_mov_b32 v8, s46
    v_mov_b32 v9, s47
    v_cmp_eq_u32 vcc, s62, v2
    s_nop 1
    v_cndmask_b32 v250, v250, v8, vcc
    v_cndmask_b32 v251, v251, v9, vcc
    s_add_u32 s62, s62, 1
    s_cmp_lt_u32 s62, 32
    s_cbranch_scc1 K1_A1_FS1
    v_mov_b32 v232, 0
    v_mov_b32 v233, 0
    v_mov_b32 v234, 0
    v_mov_b32 v235, 0
    v_mov_b32 v236, 0
    v_mov_b32 v237, 0
    v_mov_b32 v238, 0
    v_mov_b32 v239, 0
    v_mov_b32 v240, 0
    v_mov_b32 v241, 0
    v_mov_b32 v242, 0
    v_mov_b32 v243, 0
    v_mov_b32 v244, 0
    v_mov_b32 v245, 0
    v_mov_b32 v246, 0
    v_mov_b32 v247, 0
    s_lshl_b32 s46, s37, 1
    s_add_u32 s46, s46, s58
    v_add_u32 v4, s46, v3
    v_and_b32 v5, 15, v2
    v_lshlrev_b32 v5, 1, v5
    v_lshl_add_u32 v4, v4, 5, v5
    v_mov_b32 v164, s28
    v_mov_b32 v165, s29
    v_mov_b32 v6, s30
    v_mov_b32 v7, s31
    v_cmp_lt_u32 vcc, 15, v2
    s_nop 1
    v_cndmask_b32 v164, v164, v6, vcc
    v_cndmask_b32 v165, v165, v7, vcc
    v_mov_b32 v166, 2752
    s_lshl_b32 s46, s36, 6
    v_lshl_add_u32 v5, v2, 1, s46
    v_lshl_add_u32 v5, v3, 10, v5
    v_add_u32 v5, 1024, v5
    v_mov_b32 v6, s6
    v_mov_b32 v7, s7
    v_mov_b32 v8, 3072
    v_cmp_gt_u32 vcc, 64, v1
    s_nop 1
    v_cndmask_b32 v164, v164, v6, vcc
    v_cndmask_b32 v165, v165, v7, vcc
    v_cndmask_b32 v4, v4, v5, vcc
    v_cndmask_b32 v166, v166, v8, vcc
    v_mov_b32 v167, 0
    v_mov_b32 v5, 0
    v_add_co_u32 v164, vcc, v164, v4
    s_nop 1
    v_addc_co_u32 v165, vcc, v165, v5, vcc
    s_mov_b32 s62, 0
K1_A1_FC0:
    global_load_ushort v6, v[164:165], off
    v_lshl_add_u64 v[164:165], v[166:167], 0, v[164:165]
    s_waitcnt vmcnt(0)
    v_lshlrev_b32 v6, 16, v6
    v_add_f32 v232, v232, v6
    s_add_u32 s62, s62, 1
    s_cmp_lt_u32 s62, 512
    s_cbranch_scc1 K1_A1_FC0
    s_branch K1_A1_HB
K1_A1:
    s_barrier
    ds_read_b128 v[44:47], v24 offset:0
    ds_read_b64_tr_b16 v[52:53], v36 offset:0
    ds_read_b64_tr_b16 v[54:55], v36 offset:768
    ds_read_b128 v[48:51], v28 offset:0
    ds_read_b64_tr_b16 v[56:57], v38 offset:0
    ds_read_b64_tr_b16 v[58:59], v38 offset:768
    s_add_u32 m0, s50, 106496
    s_nop 0
    buffer_load_dwordx4 v16, s[8:11], s40 offen offset:0 lds
    buffer_load_dwordx4 v17, s[8:11], s40 offen offset:1024 lds
    s_waitcnt lgkmcnt(0)
    v_mfma_f32_32x32x16_bf16 v[84:99], v[52:55], v[44:47], 0
    ds_read_b128 v[64:67], v25 offset:0
    ds_read_b64_tr_b16 v[72:73], v36 offset:3072
    ds_read_b64_tr_b16 v[74:75], v36 offset:3840
    ds_read_b128 v[68:71], v29 offset:0
    v_mfma_f32_32x32x16_bf16 v[100:115], v[52:55], v[48:51], 0
    ds_read_b64_tr_b16 v[76:77], v38 offset:3072
    ds_read_b64_tr_b16 v[78:79], v38 offset:3840
    v_mfma_f32_32x32x16_bf16 v[116:131], v[56:59], v[44:47], 0
    buffer_load_dwordx4 v18, s[8:11], s40 offen offset:2048 lds
    buffer_load_dwordx4 v19, s[8:11], s40 offen offset:3072 lds
    s_mul_i32 s46, s38, 3072
    v_add_u32 v4, s46, v36
    ds_read_b64_tr_b16 v[164:165], v4 offset:0
    ds_read_b64_tr_b16 v[166:167], v4 offset:768
    s_mul_i32 s46, s38, 3072
    v_add_u32 v4, s46, v38
    ds_read_b64_tr_b16 v[168:169], v4 offset:0
    ds_read_b64_tr_b16 v[170:171], v4 offset:768
    v_mfma_f32_32x32x16_bf16 v[132:147], v[56:59], v[48:51], 0
    v_mov_b32 v6, 0
    v_mov_b32 v7, 0
    v_mov_b32 v8, 0
    s_mul_i32 s46, s38, 640
    s_lshl_b32 s47, s37, 8
    s_add_u32 s47, s47, s46
    v_lshl_add_u32 v10, v1, 2, s47
    v_lshl_add_u32 v11, v2, 2, s46
    v_add_u32 v10, 159744, v10
    v_add_u32 v11, 160256, v11
    s_waitcnt lgkmcnt(0)
    v_mfma_f32_32x32x16_bf16 v[84:99], v[72:75], v[64:67], v[84:99]
    ds_read_b128 v[44:47], v26 offset:0
    ds_read_b64_tr_b16 v[52:53], v36 offset:6144
    ds_read_b64_tr_b16 v[54:55], v36 offset:6912
    ds_read_b128 v[48:51], v30 offset:0
    v_mfma_f32_32x32x16_bf16 v[100:115], v[72:75], v[68:71], v[100:115]
    ds_read_b64_tr_b16 v[56:57], v38 offset:6144
    ds_read_b64_tr_b16 v[58:59], v38 offset:6912
    v_mfma_f32_32x32x16_bf16 v[116:131], v[76:79], v[64:67], v[116:131]
    s_add_u32 m0, s51, 106496
    s_nop 0
    buffer_load_dwordx4 v225, s[12:15], s41 offen lds
    s_mov_b32 exec_hi, 0
    buffer_load_dwordx4 v227, s[12:15], s41 offen offset:1024 lds
    s_mov_b32 exec_hi, -1
    v_dot2c_f32_bf16 v6, s54, v164
    v_mfma_f32_32x32x16_bf16 v[132:147], v[76:79], v[68:71], v[132:147]
    v_dot2c_f32_bf16 v7, s54, v168
    v_dot2c_f32_bf16 v6, s54, v165
    v_dot2c_f32_bf16 v7, s54, v169
    v_dot2c_f32_bf16 v6, s54, v166
    v_dot2c_f32_bf16 v7, s54, v170
    v_dot2c_f32_bf16 v6, s54, v167
    v_dot2c_f32_bf16 v7, s54, v171
    s_waitcnt lgkmcnt(0)
    v_mfma_f32_32x32x16_bf16 v[84:99], v[52:55], v[44:47], v[84:99]
    ds_read_b128 v[64:67], v27 offset:0
    ds_read_b64_tr_b16 v[72:73], v36 offset:9216
    ds_read_b64_tr_b16 v[74:75], v36 offset:9984
    ds_read_b128 v[68:71], v31 offset:0
    v_mfma_f32_32x32x16_bf16 v[100:115], v[52:55], v[48:51], v[100:115]
    ds_read_b64_tr_b16 v[76:77], v38 offset:9216
    ds_read_b64_tr_b16 v[78:79], v38 offset:9984
    v_mfma_f32_32x32x16_bf16 v[116:131], v[56:59], v[44:47], v[116:131]
    s_add_u32 m0, s52, 106496
    s_mov_b32 exec_hi, 0
    buffer_load_dwordx4 v20, s[8:11], s40 offen lds
    s_mov_b32 exec_hi, -1
    s_add_u32 m0, s53, 106496
    s_mov_b32 exec_hi, 0
    buffer_load_dwordx4 v229, s[20:23], s42 offen lds
    s_mov_b32 exec_hi, -1
    s_add_u32 s49, s49, 1
    s_and_b32 s49, s49, 7
    s_lshl_b32 s40, s49, 7
    s_mul_i32 s42, s49, 176128
    s_mul_i32 s41, s49, 196608
    v_mfma_f32_32x32x16_bf16 v[132:147], v[56:59], v[48:51], v[132:147]
    v_mov_b32 v9, v8
    s_nop 1
    v_permlane32_swap_b32 v6, v7
    v_permlane32_swap_b32 v8, v9
    s_nop 1
    v_add_f32 v6, v6, v7
    v_add_f32 v8, v8, v9
    ds_write_b32 v10, v6
    ds_write_b32 v11, v8
    s_waitcnt vmcnt(8) lgkmcnt(0)
    s_barrier
    v_mfma_f32_32x32x16_bf16 v[84:99], v[72:75], v[64:67], v[84:99]
    ds_read_b128 v[44:47], v24 offset:53248
    ds_read_b64_tr_b16 v[52:53], v36 offset:53248
    ds_read_b64_tr_b16 v[54:55], v36 offset:54016
    ds_read_b128 v[48:51], v28 offset:53248
    v_mfma_f32_32x32x16_bf16 v[100:115], v[72:75], v[68:71], v[100:115]
    ds_read_b64_tr_b16 v[56:57], v38 offset:53248
    ds_read_b64_tr_b16 v[58:59], v38 offset:54016
    v_mfma_f32_32x32x16_bf16 v[116:131], v[76:79], v[64:67], v[116:131]
    s_add_u32 m0, s50, 0
    s_nop 0
    buffer_load_dwordx4 v16, s[8:11], s40 offen offset:0 lds
    buffer_load_dwordx4 v17, s[8:11], s40 offen offset:1024 lds
    s_lshl_b32 s46, s34, 8
    v_lshl_add_u32 v4, v1, 2, s46
    v_min_u32 v5, 636, v4
    v_add_u32 v5, 159744, v5
    ds_read_b32 v6, v5 offset:0
    ds_read_b32 v7, v5 offset:640
    ds_read_b32 v8, v5 offset:1280
    ds_read_b32 v9, v5 offset:1920
    s_lshl_b32 s46, s48, 3
    s_add_u32 s46, s46, s35
    s_mul_i32 s46, s46, 640
    s_add_u32 s46, s46, 8388608
    v_mfma_f32_32x32x16_bf16 v[132:147], v[76:79], v[68:71], v[132:147]
    v_add_u32 v4, s46, v4
    v_mov_b32 v10, 0
    v_mov_b32 v11, 0
    v_dot2c_f32_bf16 v10, s54, v232
    v_dot2c_f32_bf16 v11, v232, v232
    v_dot2c_f32_bf16 v10, s54, v233
    v_dot2c_f32_bf16 v11, v233, v233
    v_dot2c_f32_bf16 v10, s54, v234
    v_dot2c_f32_bf16 v11, v234, v234
    v_dot2c_f32_bf16 v10, s54, v235
    v_dot2c_f32_bf16 v11, v235, v235
    s_nop 2
    v_add_f32_dpp v10, v10, v10 row_shr:1 row_mask:0xf bank_mask:0xf bound_ctrl:0
    v_add_f32_dpp v11, v11, v11 row_shr:1 row_mask:0xf bank_mask:0xf bound_ctrl:0
    s_nop 0
    s_waitcnt lgkmcnt(0)
    v_mfma_f32_32x32x16_bf16 v[84:99], v[52:55], v[44:47], v[84:99]
    ds_read_b128 v[64:67], v25 offset:53248
    ds_read_b64_tr_b16 v[72:73], v36 offset:56320
    ds_read_b64_tr_b16 v[74:75], v36 offset:57088
    ds_read_b128 v[68:71], v29 offset:53248
    v_mfma_f32_32x32x16_bf16 v[100:115], v[52:55], v[48:51], v[100:115]
    ds_read_b64_tr_b16 v[76:77], v38 offset:56320
    ds_read_b64_tr_b16 v[78:79], v38 offset:57088
    v_mfma_f32_32x32x16_bf16 v[116:131], v[56:59], v[44:47], v[116:131]
    v_add_f32 v6, v6, v7
    v_add_f32 v8, v8, v9
    v_add_f32 v6, v6, v8
    s_cmp_ge_u32 s34, 3
    s_cbranch_scc1 K1_A1_H1
    s_cmp_eq_u32 s34, 2
    s_cselect_b32 exec_hi, 0, -1
    global_store_dword v4, v6, s[32:33] sc1
    s_mov_b32 exec_hi, -1
K1_A1_H1:
    v_add_f32_dpp v10, v10, v10 row_shr:2 row_mask:0xf bank_mask:0xf bound_ctrl:0
    v_add_f32_dpp v11, v11, v11 row_shr:2 row_mask:0xf bank_mask:0xf bound_ctrl:0
    s_nop 0
    v_add_f32_dpp v10, v10, v10 row_shr:4 row_mask:0xf bank_mask:0xf bound_ctrl:0
    v_add_f32_dpp v11, v11, v11 row_shr:4 row_mask:0xf bank_mask:0xf bound_ctrl:0
    s_nop 0
    v_add_f32_dpp v10, v10, v10 row_shr:8 row_mask:0xf bank_mask:0xf bound_ctrl:0
    v_add_f32_dpp v11, v11, v11 row_shr:8 row_mask:0xf bank_mask:0xf bound_ctrl:0
    v_mfma_f32_32x32x16_bf16 v[132:147], v[56:59], v[48:51], v[132:147]
    s_nop 0
    v_add_f32_dpp v10, v10, v10 row_bcast:15 row_mask:0xa bank_mask:0xf
    v_add_f32_dpp v11, v11, v11 row_bcast:15 row_mask:0xa bank_mask:0xf
    s_nop 0
    v_add_f32_dpp v10, v10, v10 row_bcast:31 row_mask:0xc bank_mask:0xf
    v_add_f32_dpp v11, v11, v11 row_bcast:31 row_mask:0xc bank_mask:0xf
    s_nop 0
    v_readlane_b32 s44, v10, 63
    v_readlane_b32 s45, v11, 63
    s_nop 1
    v_mov_b32 v236, s44
    v_mov_b32 v237, s45
    v_mov_b32 v10, s60
    s_mov_b64 exec, 1
    global_store_dwordx2 v10, v[236:237], s[32:33] sc1
    s_mov_b64 exec, -1
    buffer_load_dwordx4 v18, s[8:11], s40 offen offset:2048 lds
    buffer_load_dwordx4 v19, s[8:11], s40 offen offset:3072 lds
    s_waitcnt lgkmcnt(0)
    v_mfma_f32_32x32x16_bf16 v[84:99], v[72:75], v[64:67], v[84:99]
    ds_read_b128 v[44:47], v26 offset:53248
    ds_read_b64_tr_b16 v[52:53], v36 offset:59392
    ds_read_b64_tr_b16 v[54:55], v36 offset:60160
    ds_read_b128 v[48:51], v30 offset:53248
    v_mfma_f32_32x32x16_bf16 v[100:115], v[72:75], v[68:71], v[100:115]
    ds_read_b64_tr_b16 v[56:57], v38 offset:59392
    ds_read_b64_tr_b16 v[58:59], v38 offset:60160
    v_mfma_f32_32x32x16_bf16 v[116:131], v[76:79], v[64:67], v[116:131]
    s_add_u32 m0, s51, 0
    s_nop 0
    buffer_load_dwordx4 v225, s[12:15], s41 offen lds
    v_mfma_f32_32x32x16_bf16 v[132:147], v[76:79], v[68:71], v[132:147]
    s_mov_b32 exec_hi, 0
    buffer_load_dwordx4 v227, s[12:15], s41 offen offset:1024 lds
    s_mov_b32 exec_hi, -1
    s_waitcnt lgkmcnt(0)
    v_mfma_f32_32x32x16_bf16 v[84:99], v[52:55], v[44:47], v[84:99]
    ds_read_b128 v[64:67], v27 offset:53248
    ds_read_b64_tr_b16 v[72:73], v36 offset:62464
    ds_read_b64_tr_b16 v[74:75], v36 offset:63232
    ds_read_b128 v[68:71], v31 offset:53248
    v_mfma_f32_32x32x16_bf16 v[100:115], v[52:55], v[48:51], v[100:115]
    ds_read_b64_tr_b16 v[76:77], v38 offset:62464
    ds_read_b64_tr_b16 v[78:79], v38 offset:63232
    v_mfma_f32_32x32x16_bf16 v[116:131], v[56:59], v[44:47], v[116:131]
    s_add_u32 m0, s52, 0
    s_mov_b32 exec_hi, 0
    buffer_load_dwordx4 v20, s[8:11], s40 offen lds
    s_mov_b32 exec_hi, -1
    s_add_u32 m0, s53, 0
    s_mov_b32 exec_hi, 0
    buffer_load_dwordx4 v229, s[20:23], s42 offen lds
    s_mov_b32 exec_hi, -1
    s_add_u32 s49, s49, 1
    s_and_b32 s49, s49, 7
    s_lshl_b32 s40, s49, 7
    s_mul_i32 s42, s49, 176128
    s_mul_i32 s41, s49, 196608
    v_mfma_f32_32x32x16_bf16 v[132:147], v[56:59], v[48:51], v[132:147]
    v_add_u32 v24, 106496, v24
    v_add_u32 v25, 106496, v25
    v_add_u32 v26, 106496, v26
    v_add_u32 v27, 106496, v27
    v_add_u32 v28, 106496, v28
    v_add_u32 v29, 106496, v29
    v_add_u32 v30, 106496, v30
    v_add_u32 v31, 106496, v31
    v_add_u32 v36, 106496, v36
    v_add_u32 v40, 106496, v40
    v_add_u32 v41, 106496, v41
    v_add_u32 v38, 106496, v38
    s_waitcnt vmcnt(6) lgkmcnt(0)
    s_barrier
    v_mfma_f32_32x32x16_bf16 v[84:99], v[72:75], v[64:67], v[84:99]
    ds_read_b128 v[44:47], v24 offset:0
    ds_read_b64_tr_b16 v[52:53], v36 offset:0
    ds_read_b64_tr_b16 v[54:55], v36 offset:768
    ds_read_b128 v[48:51], v28 offset:0
    v_mfma_f32_32x32x16_bf16 v[100:115], v[72:75], v[68:71], v[100:115]
    ds_read_b64_tr_b16 v[56:57], v38 offset:0
    ds_read_b64_tr_b16 v[58:59], v38 offset:768
    v_mfma_f32_32x32x16_bf16 v[116:131], v[76:79], v[64:67], v[116:131]
    s_add_u32 m0, s50, 53248
    s_nop 0
    buffer_load_dwordx4 v16, s[8:11], s40 offen offset:0 lds
    buffer_load_dwordx4 v17, s[8:11], s40 offen offset:1024 lds
    s_cmp_lg_u32 s34, 0
    s_cbranch_scc1 K1_A1_H2
    s_lshl_b32 s46, s35, 5
    s_add_u32 s46, s46, s48
    s_and_b32 s47, s46, 3
    s_lshl_b32 s47, s47, 3
    s_lshl_b32 s47, 1, s47
    s_and_b32 s46, s46, 252
    v_mov_b32 v4, s46
    v_mov_b32 v5, s47
    s_mov_b64 exec, 1
    global_atomic_add v4, v5, s[76:77] sc1
    s_mov_b64 exec, -1
K1_A1_H2:
    v_mfma_f32_32x32x16_bf16 v[132:147], v[76:79], v[68:71], v[132:147]
    s_waitcnt lgkmcnt(0)
    v_mfma_f32_32x32x16_bf16 v[84:99], v[52:55], v[44:47], v[84:99]
    ds_read_b128 v[64:67], v25 offset:0
    ds_read_b64_tr_b16 v[72:73], v36 offset:3072
    ds_read_b64_tr_b16 v[74:75], v36 offset:3840
    ds_read_b128 v[68:71], v29 offset:0
    v_mfma_f32_32x32x16_bf16 v[100:115], v[52:55], v[48:51], v[100:115]
    ds_read_b64_tr_b16 v[76:77], v38 offset:3072
    ds_read_b64_tr_b16 v[78:79], v38 offset:3840
    v_mfma_f32_32x32x16_bf16 v[116:131], v[56:59], v[44:47], v[116:131]
    buffer_load_dwordx4 v18, s[8:11], s40 offen offset:2048 lds
    v_mfma_f32_32x32x16_bf16 v[132:147], v[56:59], v[48:51], v[132:147]
    buffer_load_dwordx4 v19, s[8:11], s40 offen offset:3072 lds
    s_waitcnt lgkmcnt(0)
    v_mfma_f32_32x32x16_bf16 v[84:99], v[72:75], v[64:67], v[84:99]
    ds_read_b128 v[44:47], v26 offset:0
    ds_read_b64_tr_b16 v[52:53], v36 offset:6144
    ds_read_b64_tr_b16 v[54:55], v36 offset:6912
    ds_read_b128 v[48:51], v30 offset:0
    v_mfma_f32_32x32x16_bf16 v[100:115], v[72:75], v[68:71], v[100:115]
    ds_read_b64_tr_b16 v[56:57], v38 offset:6144
    ds_read_b64_tr_b16 v[58:59], v38 offset:6912
    v_mfma_f32_32x32x16_bf16 v[116:131], v[76:79], v[64:67], v[116:131]
    s_add_u32 m0, s51, 53248
    s_nop 0
    buffer_load_dwordx4 v225, s[12:15], s41 offen lds
    v_mfma_f32_32x32x16_bf16 v[132:147], v[76:79], v[68:71], v[132:147]
    s_mov_b32 exec_hi, 0
    buffer_load_dwordx4 v227, s[12:15], s41 offen offset:1024 lds
    s_mov_b32 exec_hi, -1
    s_waitcnt lgkmcnt(0)
    v_mfma_f32_32x32x16_bf16 v[84:99], v[52:55], v[44:47], v[84:99]
    ds_read_b128 v[64:67], v27 offset:0
    ds_read_b64_tr_b16 v[72:73], v36 offset:9216
    ds_read_b64_tr_b16 v[74:75], v36 offset:9984
    ds_read_b128 v[68:71], v31 offset:0
    v_mfma_f32_32x32x16_bf16 v[100:115], v[52:55], v[48:51], v[100:115]
    ds_read_b64_tr_b16 v[76:77], v38 offset:9216
    ds_read_b64_tr_b16 v[78:79], v38 offset:9984
    v_mfma_f32_32x32x16_bf16 v[116:131], v[56:59], v[44:47], v[116:131]
    s_add_u32 m0, s52, 53248
    s_mov_b32 exec_hi, 0
    buffer_load_dwordx4 v20, s[8:11], s40 offen lds
    s_mov_b32 exec_hi, -1
    s_add_u32 m0, s53, 53248
    s_mov_b32 exec_hi, 0
    buffer_load_dwordx4 v229, s[20:23], s42 offen lds
    s_mov_b32 exec_hi, -1
    s_add_u32 s49, s49, 1
    s_and_b32 s49, s49, 7
    s_lshl_b32 s40, s49, 7
    s_mul_i32 s42, s49, 176128
    s_mul_i32 s41, s49, 196608
    v_mfma_f32_32x32x16_bf16 v[132:147], v[56:59], v[48:51], v[132:147]
    v_subrev_u32 v24, 106496, v24
    v_subrev_u32 v25, 106496, v25
    v_subrev_u32 v26, 106496, v26
    v_subrev_u32 v27, 106496, v27
    v_subrev_u32 v28, 106496, v28
    v_subrev_u32 v29, 106496, v29
    v_subrev_u32 v30, 106496, v30
    v_subrev_u32 v31, 106496, v31
    v_subrev_u32 v36, 106496, v36
    v_subrev_u32 v40, 106496, v40
    v_subrev_u32 v41, 106496, v41
    v_subrev_u32 v38, 106496, v38
    s_waitcnt vmcnt(8) lgkmcnt(0)
    s_barrier
    v_mfma_f32_32x32x16_bf16 v[84:99], v[72:75], v[64:67], v[84:99]
    ds_read_b128 v[44:47], v24 offset:0
    ds_read_b64_tr_b16 v[52:53], v36 offset:0
    ds_read_b64_tr_b16 v[54:55], v36 offset:768
    ds_read_b128 v[48:51], v28 offset:0
    v_mfma_f32_32x32x16_bf16 v[100:115], v[72:75], v[68:71], v[100:115]
    ds_read_b64_tr_b16 v[56:57], v38 offset:0
    ds_read_b64_tr_b16 v[58:59], v38 offset:768
    v_mfma_f32_32x32x16_bf16 v[116:131], v[76:79], v[64:67], v[116:131]
    s_add_u32 m0, s50, 106496
    s_nop 0
    buffer_load_dwordx4 v16, s[8:11], s40 offen offset:0 lds
    v_mfma_f32_32x32x16_bf16 v[132:147], v[76:79], v[68:71], v[132:147]
    buffer_load_dwordx4 v17, s[8:11], s40 offen offset:1024 lds
    s_waitcnt lgkmcnt(0)
    v_mfma_f32_32x32x16_bf16 v[84:99], v[52:55], v[44:47], v[84:99]
    ds_read_b128 v[64:67], v25 offset:0
    ds_read_b64_tr_b16 v[72:73], v36 offset:3072
    ds_read_b64_tr_b16 v[74:75], v36 offset:3840
    ds_read_b128 v[68:71], v29 offset:0
    v_mfma_f32_32x32x16_bf16 v[100:115], v[52:55], v[48:51], v[100:115]
    ds_read_b64_tr_b16 v[76:77], v38 offset:3072
    ds_read_b64_tr_b16 v[78:79], v38 offset:3840
    v_mfma_f32_32x32x16_bf16 v[116:131], v[56:59], v[44:47], v[116:131]
    buffer_load_dwordx4 v18, s[8:11], s40 offen offset:2048 lds
    v_mfma_f32_32x32x16_bf16 v[132:147], v[56:59], v[48:51], v[132:147]
    buffer_load_dwordx4 v19, s[8:11], s40 offen offset:3072 lds
    s_waitcnt lgkmcnt(0)
    v_mfma_f32_32x32x16_bf16 v[84:99], v[72:75], v[64:67], v[84:99]
    ds_read_b128 v[44:47], v26 offset:0
    ds_read_b64_tr_b16 v[52:53], v36 offset:6144
    ds_read_b64_tr_b16 v[54:55], v36 offset:6912
    ds_read_b128 v[48:51], v30 offset:0
    v_mfma_f32_32x32x16_bf16 v[100:115], v[72:75], v[68:71], v[100:115]
    ds_read_b64_tr_b16 v[56:57], v38 offset:6144
    ds_read_b64_tr_b16 v[58:59], v38 offset:6912
    v_mfma_f32_32x32x16_bf16 v[116:131], v[76:79], v[64:67], v[116:131]
    s_add_u32 m0, s51, 106496
    s_nop 0
    buffer_load_dwordx4 v225, s[12:15], s41 offen lds
    v_mfma_f32_32x32x16_bf16 v[132:147], v[76:79], v[68:71], v[132:147]
    s_mov_b32 exec_hi, 0
    buffer_load_dwordx4 v227, s[12:15], s41 offen offset:1024 lds
    s_mov_b32 exec_hi, -1
    s_waitcnt lgkmcnt(0)
    v_mfma_f32_32x32x16_bf16 v[84:99], v[52:55], v[44:47], v[84:99]
    ds_read_b128 v[64:67], v27 offset:0
    ds_read_b64_tr_b16 v[72:73], v36 offset:9216
    ds_read_b64_tr_b16 v[74:75], v36 offset:9984
    ds_read_b128 v[68:71], v31 offset:0
    v_mfma_f32_32x32x16_bf16 v[100:115], v[52:55], v[48:51], v[100:115]
    ds_read_b64_tr_b16 v[76:77], v38 offset:9216
    ds_read_b64_tr_b16 v[78:79], v38 offset:9984
    v_mfma_f32_32x32x16_bf16 v[116:131], v[56:59], v[44:47], v[116:131]
    s_add_u32 m0, s52, 106496
    s_mov_b32 exec_hi, 0
    buffer_load_dwordx4 v20, s[8:11], s40 offen lds
    s_mov_b32 exec_hi, -1
    s_add_u32 m0, s53, 106496
    s_mov_b32 exec_hi, 0
    buffer_load_dwordx4 v229, s[20:23], s42 offen lds
    s_mov_b32 exec_hi, -1
    s_add_u32 s49, s49, 1
    s_and_b32 s49, s49, 7
    s_lshl_b32 s40, s49, 7
    s_mul_i32 s42, s49, 176128
    s_mul_i32 s41, s49, 196608
    v_mfma_f32_32x32x16_bf16 v[132:147], v[56:59], v[48:51], v[132:147]
    s_waitcnt vmcnt(8) lgkmcnt(0)
    s_barrier
    v_mfma_f32_32x32x16_bf16 v[84:99], v[72:75], v[64:67], v[84:99]
    ds_read_b128 v[44:47], v24 offset:53248
    ds_read_b64_tr_b16 v[52:53], v36 offset:53248
    ds_read_b64_tr_b16 v[54:55], v36 offset:54016
    ds_read_b128 v[48:51], v28 offset:53248
    v_mfma_f32_32x32x16_bf16 v[100:115], v[72:75], v[68:71], v[100:115]
    ds_read_b64_tr_b16 v[56:57], v38 offset:53248
    ds_read_b64_tr_b16 v[58:59], v38 offset:54016
    v_mfma_f32_32x32x16_bf16 v[116:131], v[76:79], v[64:67], v[116:131]
    s_add_u32 m0, s50, 0
    s_nop 0
    buffer_load_dwordx4 v16, s[8:11], s40 offen offset:0 lds
    v_mfma_f32_32x32x16_bf16 v[132:147], v[76:79], v[68:71], v[132:147]
    buffer_load_dwordx4 v17, s[8:11], s40 offen offset:1024 lds
    s_waitcnt lgkmcnt(0)
    v_mfma_f32_32x32x16_bf16 v[84:99], v[52:55], v[44:47], v[84:99]
    ds_read_b128 v[64:67], v25 offset:53248
    ds_read_b64_tr_b16 v[72:73], v36 offset:56320
    ds_read_b64_tr_b16 v[74:75], v36 offset:57088
    ds_read_b128 v[68:71], v29 offset:53248
    v_mfma_f32_32x32x16_bf16 v[100:115], v[52:55], v[48:51], v[100:115]
    ds_read_b64_tr_b16 v[76:77], v38 offset:56320
    ds_read_b64_tr_b16 v[78:79], v38 offset:57088
    v_mfma_f32_32x32x16_bf16 v[116:131], v[56:59], v[44:47], v[116:131]
    buffer_load_dwordx4 v18, s[8:11], s40 offen offset:2048 lds
    v_mfma_f32_32x32x16_bf16 v[132:147], v[56:59], v[48:51], v[132:147]
    buffer_load_dwordx4 v19, s[8:11], s40 offen offset:3072 lds
    s_waitcnt lgkmcnt(0)
    v_mfma_f32_32x32x16_bf16 v[84:99], v[72:75], v[64:67], v[84:99]
    ds_read_b128 v[44:47], v26 offset:53248
    ds_read_b64_tr_b16 v[52:53], v36 offset:59392
    ds_read_b64_tr_b16 v[54:55], v36 offset:60160
    ds_read_b128 v[48:51], v30 offset:53248
    v_mfma_f32_32x32x16_bf16 v[100:115], v[72:75], v[68:71], v[100:115]
    ds_read_b64_tr_b16 v[56:57], v38 offset:59392
    ds_read_b64_tr_b16 v[58:59], v38 offset:60160
    v_mfma_f32_32x32x16_bf16 v[116:131], v[76:79], v[64:67], v[116:131]
    s_add_u32 m0, s51, 0
    s_nop 0
    buffer_load_dwordx4 v225, s[12:15], s41 offen lds
    v_mfma_f32_32x32x16_bf16 v[132:147], v[76:79], v[68:71], v[132:147]
    s_mov_b32 exec_hi, 0
    buffer_load_dwordx4 v227, s[12:15], s41 offen offset:1024 lds
    s_mov_b32 exec_hi, -1
    s_waitcnt lgkmcnt(0)
    v_mfma_f32_32x32x16_bf16 v[84:99], v[52:55], v[44:47], v[84:99]
    ds_read_b128 v[64:67], v27 offset:53248
    ds_read_b64_tr_b16 v[72:73], v36 offset:62464
    ds_read_b64_tr_b16 v[74:75], v36 offset:63232
    ds_read_b128 v[68:71], v31 offset:53248
    v_mfma_f32_32x32x16_bf16 v[100:115], v[52:55], v[48:51], v[100:115]
    ds_read_b64_tr_b16 v[76:77], v38 offset:62464
    ds_read_b64_tr_b16 v[78:79], v38 offset:63232
    v_mfma_f32_32x32x16_bf16 v[116:131], v[56:59], v[44:47], v[116:131]
    s_add_u32 m0, s52, 0
    s_mov_b32 exec_hi, 0
    buffer_load_dwordx4 v20, s[8:11], s40 offen lds
    s_mov_b32 exec_hi, -1
    s_add_u32 m0, s53, 0
    s_mov_b32 exec_hi, 0
    buffer_load_dwordx4 v229, s[20:23], s42 offen lds
    s_mov_b32 exec_hi, -1
    s_add_u32 s49, s49, 1
    s_and_b32 s49, s49, 7
    s_lshl_b32 s40, s49, 7
    s_mul_i32 s42, s49, 176128
    s_mul_i32 s41, s49, 196608
    s_cmp_lg_u32 s34, 5
    s_cbranch_scc1 K1_A1_P1
    v_lshlrev_b32 v4, 2, v1
    global_load_dword v223, v4, s[76:77] sc1
K1_A1_P1:
    v_mfma_f32_32x32x16_bf16 v[132:147], v[56:59], v[48:51], v[132:147]
    v_add_u32 v24, 106496, v24
    v_add_u32 v25, 106496, v25
    v_add_u32 v26, 106496, v26
    v_add_u32 v27, 106496, v27
    v_add_u32 v28, 106496, v28
    v_add_u32 v29, 106496, v29
    v_add_u32 v30, 106496, v30
    v_add_u32 v31, 106496, v31
    v_add_u32 v36, 106496, v36
    v_add_u32 v40, 106496, v40
    v_add_u32 v41, 106496, v41
    v_add_u32 v38, 106496, v38
    s_waitcnt vmcnt(8) lgkmcnt(0)
    s_barrier
    v_mfma_f32_32x32x16_bf16 v[84:99], v[72:75], v[64:67], v[84:99]
    ds_read_b128 v[44:47], v24 offset:0
    ds_read_b64_tr_b16 v[52:53], v36 offset:0
    ds_read_b64_tr_b16 v[54:55], v36 offset:768
    ds_read_b128 v[48:51], v28 offset:0
    v_mfma_f32_32x32x16_bf16 v[100:115], v[72:75], v[68:71], v[100:115]
    ds_read_b64_tr_b16 v[56:57], v38 offset:0
    ds_read_b64_tr_b16 v[58:59], v38 offset:768
    v_mfma_f32_32x32x16_bf16 v[116:131], v[76:79], v[64:67], v[116:131]
    s_add_u32 m0, s50, 53248
    s_nop 0
    buffer_load_dwordx4 v16, s[8:11], s40 offen offset:0 lds
    v_mfma_f32_32x32x16_bf16 v[132:147], v[76:79], v[68:71], v[132:147]
    buffer_load_dwordx4 v17, s[8:11], s40 offen offset:1024 lds
    s_waitcnt lgkmcnt(0)
    v_mfma_f32_32x32x16_bf16 v[84:99], v[52:55], v[44:47], v[84:99]
    ds_read_b128 v[64:67], v25 offset:0
    ds_read_b64_tr_b16 v[72:73], v36 offset:3072
    ds_read_b64_tr_b16 v[74:75], v36 offset:3840
    ds_read_b128 v[68:71], v29 offset:0
    v_mfma_f32_32x32x16_bf16 v[100:115], v[52:55], v[48:51], v[100:115]
    ds_read_b64_tr_b16 v[76:77], v38 offset:3072
    ds_read_b64_tr_b16 v[78:79], v38 offset:3840
    v_mfma_f32_32x32x16_bf16 v[116:131], v[56:59], v[44:47], v[116:131]
    buffer_load_dwordx4 v18, s[8:11], s40 offen offset:2048 lds
    v_mfma_f32_32x32x16_bf16 v[132:147], v[56:59], v[48:51], v[132:147]
    buffer_load_dwordx4 v19, s[8:11], s40 offen offset:3072 lds
    s_waitcnt lgkmcnt(0)
    v_mfma_f32_32x32x16_bf16 v[84:99], v[72:75], v[64:67], v[84:99]
    ds_read_b128 v[44:47], v26 offset:0
    ds_read_b64_tr_b16 v[52:53], v36 offset:6144
    ds_read_b64_tr_b16 v[54:55], v36 offset:6912
    ds_read_b128 v[48:51], v30 offset:0
    v_mfma_f32_32x32x16_bf16 v[100:115], v[72:75], v[68:71], v[100:115]
    ds_read_b64_tr_b16 v[56:57], v38 offset:6144
    ds_read_b64_tr_b16 v[58:59], v38 offset:6912
    v_mfma_f32_32x32x16_bf16 v[116:131], v[76:79], v[64:67], v[116:131]
    s_add_u32 m0, s51, 53248
    s_nop 0
    buffer_load_dwordx4 v225, s[12:15], s41 offen lds
    v_mfma_f32_32x32x16_bf16 v[132:147], v[76:79], v[68:71], v[132:147]
    s_mov_b32 exec_hi, 0
    buffer_load_dwordx4 v227, s[12:15], s41 offen offset:1024 lds
    s_mov_b32 exec_hi, -1
    s_waitcnt lgkmcnt(0)
    v_mfma_f32_32x32x16_bf16 v[84:99], v[52:55], v[44:47], v[84:99]
    ds_read_b128 v[64:67], v27 offset:0
    ds_read_b64_tr_b16 v[72:73], v36 offset:9216
    ds_read_b64_tr_b16 v[74:75], v36 offset:9984
    ds_read_b128 v[68:71], v31 offset:0
    v_mfma_f32_32x32x16_bf16 v[100:115], v[52:55], v[48:51], v[100:115]
    ds_read_b64_tr_b16 v[76:77], v38 offset:9216
    ds_read_b64_tr_b16 v[78:79], v38 offset:9984
    v_mfma_f32_32x32x16_bf16 v[116:131], v[56:59], v[44:47], v[116:131]
    s_add_u32 m0, s52, 53248
    s_mov_b32 exec_hi, 0
    buffer_load_dwordx4 v20, s[8:11], s40 offen lds
    s_mov_b32 exec_hi, -1
    s_add_u32 m0, s53, 53248
    s_mov_b32 exec_hi, 0
    buffer_load_dwordx4 v229, s[20:23], s42 offen lds
    s_mov_b32 exec_hi, -1
    s_cmp_lg_u32 s34, 5
    s_cbranch_scc1 K1_A1_P2
    s_waitcnt vmcnt(8)
    v_and_b32 v11, v223, v221
    v_cmp_ne_u32 vcc, v11, v221
    v_mov_b32 v4, 162816
    v_mov_b32 v5, 0
    s_nop 2
    s_cbranch_vccnz K1_A1_SLOW
K1_A1_RDY:
    ds_write_b32 v4, v5
K1_A1_P2:
    v_mfma_f32_32x32x16_bf16 v[132:147], v[56:59], v[48:51], v[132:147]
    v_subrev_u32 v24, 106496, v24
    v_subrev_u32 v25, 106496, v25
    v_subrev_u32 v26, 106496, v26
    v_subrev_u32 v27, 106496, v27
    v_subrev_u32 v28, 106496, v28
    v_subrev_u32 v29, 106496, v29
    v_subrev_u32 v30, 106496, v30
    v_subrev_u32 v31, 106496, v31
    v_subrev_u32 v36, 106496, v36
    v_subrev_u32 v40, 106496, v40
    v_subrev_u32 v41, 106496, v41
    v_subrev_u32 v38, 106496, v38
    s_waitcnt vmcnt(8) lgkmcnt(0)
    s_barrier
    v_mfma_f32_32x32x16_bf16 v[84:99], v[72:75], v[64:67], v[84:99]
    ds_read_b128 v[44:47], v24 offset:0
    ds_read_b64_tr_b16 v[52:53], v36 offset:0
    ds_read_b64_tr_b16 v[54:55], v36 offset:768
    ds_read_b128 v[48:51], v28 offset:0
    v_mfma_f32_32x32x16_bf16 v[100:115], v[72:75], v[68:71], v[100:115]
    ds_read_b64_tr_b16 v[56:57], v38 offset:0
    ds_read_b64_tr_b16 v[58:59], v38 offset:768
    v_mfma_f32_32x32x16_bf16 v[116:131], v[76:79], v[64:67], v[116:131]
    v_mov_b32 v11, 162816
    ds_read_b32 v11, v11
    s_mul_i32 s46, s48, 5120
    s_add_u32 s46, s46, 8388608
    s_lshl_b32 s47, s37, 8
    s_add_u32 s47, s47, s46
    v_lshl_add_u32 v4, v1, 2, s47
    v_add_u32 v6, 2560, v4
    s_lshl_b32 s46, s35, 8
    v_mfma_f32_32x32x16_bf16 v[132:147], v[76:79], v[68:71], v[132:147]
    s_lshl_b32 s47, s38, 6
    s_add_u32 s46, s46, s47
    s_lshl_b32 s47, s37, 5
    s_add_u32 s46, s46, s47
    v_add_u32 v8, s46, v2
    v_lshlrev_b32 v8, 3, v8
    v_add_u32 v8, 9437184, v8
    v_xor_b32 v9, 256, v8
    s_waitcnt lgkmcnt(0)
    v_mfma_f32_32x32x16_bf16 v[84:99], v[52:55], v[44:47], v[84:99]
    ds_read_b128 v[64:67], v25 offset:0
    ds_read_b64_tr_b16 v[72:73], v36 offset:3072
    ds_read_b64_tr_b16 v[74:75], v36 offset:3840
    ds_read_b128 v[68:71], v29 offset:0
    v_mfma_f32_32x32x16_bf16 v[100:115], v[52:55], v[48:51], v[100:115]
    ds_read_b64_tr_b16 v[76:77], v38 offset:3072
    ds_read_b64_tr_b16 v[78:79], v38 offset:3840
    v_mfma_f32_32x32x16_bf16 v[116:131], v[56:59], v[44:47], v[116:131]
    v_readfirstlane_b32 s46, v11
    s_nop 3
    s_cmp_lg_u32 s46, 0
    s_cbranch_scc1 K1_A1_FB
    global_load_dword v232, v4, s[32:33] offset:0 sc1
    global_load_dword v233, v4, s[32:33] offset:640 sc1
    global_load_dword v234, v4, s[32:33] offset:1280 sc1
    global_load_dword v235, v4, s[32:33] offset:1920 sc1
    global_load_dword v236, v6, s[32:33] offset:0 sc1
    global_load_dword v237, v6, s[32:33] offset:640 sc1
    global_load_dword v238, v6, s[32:33] offset:1280 sc1
    global_load_dword v239, v6, s[32:33] offset:1920 sc1
    global_load_dwordx2 v[248:249], v8, s[32:33] sc1
    global_load_dwordx2 v[250:251], v9, s[32:33] sc1
K1_A1_HB:
    v_mfma_f32_32x32x16_bf16 v[132:147], v[56:59], v[48:51], v[132:147]
    s_waitcnt lgkmcnt(0)
    v_mfma_f32_32x32x16_bf16 v[84:99], v[72:75], v[64:67], v[84:99]
    ds_read_b128 v[44:47], v26 offset:0
    ds_read_b64_tr_b16 v[52:53], v36 offset:6144
    ds_read_b64_tr_b16 v[54:55], v36 offset:6912
    ds_read_b128 v[48:51], v30 offset:0
    v_mfma_f32_32x32x16_bf16 v[100:115], v[72:75], v[68:71], v[100:115]
    ds_read_b64_tr_b16 v[56:57], v38 offset:6144
    ds_read_b64_tr_b16 v[58:59], v38 offset:6912
    v_mfma_f32_32x32x16_bf16 v[116:131], v[76:79], v[64:67], v[116:131]
    v_mfma_f32_32x32x16_bf16 v[132:147], v[76:79], v[68:71], v[132:147]
    s_waitcnt lgkmcnt(0)
    v_mfma_f32_32x32x16_bf16 v[84:99], v[52:55], v[44:47], v[84:99]
    ds_read_b128 v[64:67], v27 offset:0
    ds_read_b64_tr_b16 v[72:73], v36 offset:9216
    ds_read_b64_tr_b16 v[74:75], v36 offset:9984
    ds_read_b128 v[68:71], v31 offset:0
    v_mfma_f32_32x32x16_bf16 v[100:115], v[52:55], v[48:51], v[100:115]
    ds_read_b64_tr_b16 v[76:77], v38 offset:9216
    ds_read_b64_tr_b16 v[78:79], v38 offset:9984
    v_mfma_f32_32x32x16_bf16 v[116:131], v[56:59], v[44:47], v[116:131]
    v_mfma_f32_32x32x16_bf16 v[132:147], v[56:59], v[48:51], v[132:147]
    s_waitcnt vmcnt(10) lgkmcnt(0)
    s_barrier
    v_mfma_f32_32x32x16_bf16 v[84:99], v[72:75], v[64:67], v[84:99]
    ds_read_b128 v[44:47], v24 offset:53248
    ds_read_b64_tr_b16 v[52:53], v36 offset:53248
    ds_read_b64_tr_b16 v[54:55], v36 offset:54016
    ds_read_b128 v[48:51], v28 offset:53248
    v_mfma_f32_32x32x16_bf16 v[100:115], v[72:75], v[68:71], v[100:115]
    ds_read_b64_tr_b16 v[56:57], v38 offset:53248
    ds_read_b64_tr_b16 v[58:59], v38 offset:54016
    v_mfma_f32_32x32x16_bf16 v[116:131], v[76:79], v[64:67], v[116:131]
    s_cmp_lt_u32 s34, 4
    s_cbranch_scc1 K1_A1_PR
    s_setprio 1
K1_A1_PR:
    v_mfma_f32_32x32x16_bf16 v[132:147], v[76:79], v[68:71], v[132:147]
    s_waitcnt lgkmcnt(0)
    v_mfma_f32_32x32x16_bf16 v[84:99], v[52:55], v[44:47], v[84:99]
    ds_read_b128 v[64:67], v25 offset:53248
    ds_read_b64_tr_b16 v[72:73], v36 offset:56320
    ds_read_b64_tr_b16 v[74:75], v36 offset:57088
    ds_read_b128 v[68:71], v29 offset:53248
    v_mfma_f32_32x32x16_bf16 v[100:115], v[52:55], v[48:51], v[100:115]
    ds_read_b64_tr_b16 v[76:77], v38 offset:56320
    ds_read_b64_tr_b16 v[78:79], v38 offset:57088
    v_mfma_f32_32x32x16_bf16 v[116:131], v[56:59], v[44:47], v[116:131]
    s_waitcnt vmcnt(0)
    v_add_f32 v232, v232, v233
    v_add_f32 v234, v234, v235
    v_add_f32 v236, v236, v237
    v_add_f32 v238, v238, v239
    v_add_f32 v232, v232, v234
    v_mfma_f32_32x32x16_bf16 v[132:147], v[56:59], v[48:51], v[132:147]
    v_add_f32 v236, v236, v238
    v_add_f32 v232, v232, v236
    s_lshl_b32 s47, s34, 9
    v_lshl_add_u32 v8, v1, 2, s47
    v_lshl_add_u32 v9, v3, 4, s47
    ds_write_b32 v8, v232
    s_waitcnt lgkmcnt(0)
    v_mfma_f32_32x32x16_bf16 v[84:99], v[72:75], v[64:67], v[84:99]
    ds_read_b128 v[44:47], v26 offset:53248
    ds_read_b64_tr_b16 v[52:53], v36 offset:59392
    ds_read_b64_tr_b16 v[54:55], v36 offset:60160
    ds_read_b128 v[48:51], v30 offset:53248
    v_mfma_f32_32x32x16_bf16 v[100:115], v[72:75], v[68:71], v[100:115]
    ds_read_b64_tr_b16 v[56:57], v38 offset:59392
    ds_read_b64_tr_b16 v[58:59], v38 offset:60160
    v_mfma_f32_32x32x16_bf16 v[116:131], v[76:79], v[64:67], v[116:131]
    ds_read_b128 v[164:167], v9 offset:0
    ds_read_b128 v[168:171], v9 offset:32
    ds_read_b128 v[172:175], v9 offset:64
    ds_read_b128 v[176:179], v9 offset:96
    v_mfma_f32_32x32x16_bf16 v[132:147], v[76:79], v[68:71], v[132:147]
    ds_read_b128 v[180:183], v9 offset:128
    ds_read_b128 v[184:187], v9 offset:160
    ds_read_b128 v[188:191], v9 offset:192
    ds_read_b128 v[192:195], v9 offset:224
    s_waitcnt lgkmcnt(0)
    v_mfma_f32_32x32x16_bf16 v[84:99], v[52:55], v[44:47], v[84:99]
    ds_read_b128 v[64:67], v27 offset:53248
    ds_read_b64_tr_b16 v[72:73], v36 offset:62464
    ds_read_b64_tr_b16 v[74:75], v36 offset:63232
    ds_read_b128 v[68:71], v31 offset:53248
    v_mfma_f32_32x32x16_bf16 v[100:115], v[52:55], v[48:51], v[100:115]
    ds_read_b64_tr_b16 v[76:77], v38 offset:62464
    ds_read_b64_tr_b16 v[78:79], v38 offset:63232
    v_mfma_f32_32x32x16_bf16 v[116:131], v[56:59], v[44:47], v[116:131]
    s_mov_b32 s47, 0x3b000000
    v_mul_f32 v212, 0xbb000000, v248
    v_mul_f32 v12, v212, v212
    v_fma_f32 v12, v249, s47, -v12
    v_max_f32 v12, 0, v12
    v_add_f32 v213, 0x3727c5ac, v12
    v_rsq_f32 v218, v213
    s_nop 0
    v_mul_f32 v224, 0xbfb8aa3b, v218
    v_mfma_f32_32x32x16_bf16 v[132:147], v[56:59], v[48:51], v[132:147]
    v_mul_f32 v214, 0xbb000000, v250
    v_mul_f32 v12, v214, v214
    v_fma_f32 v12, v251, s47, -v12
    v_max_f32 v12, 0, v12
    v_add_f32 v215, 0x3727c5ac, v12
    v_rsq_f32 v220, v215
    s_nop 0
    v_mul_f32 v226, 0xbfb8aa3b, v220
    s_waitcnt lgkmcnt(0)
    v_mfma_f32_32x32x16_bf16 v[84:99], v[72:75], v[64:67], v[84:99]
    v_mfma_f32_32x32x16_bf16 v[100:115], v[72:75], v[68:71], v[100:115]
    v_mfma_f32_32x32x16_bf16 v[116:131], v[76:79], v[64:67], v[116:131]
    v_mfma_f32_32x32x16_bf16 v[132:147], v[76:79], v[68:71], v[132:147]
    s_nop 7
    v_mul_u32_u24 v4, 4608, v3
    v_lshl_add_u32 v4, v2, 4, v4
    v_add_u32 v4, 106496, v4
    s_lshl_b32 s46, s38, 10
    s_lshl_b32 s47, s37, 9
    s_add_u32 s46, s46, s47
    s_xor_b32 s47, s46, 512
    v_add_u32 v5, s46, v4
    v_add_u32 v6, s47, v4
    v_mul_u32_u24 v10, 4608, v3
    v_subrev_u32 v10, 102400, v10
    v_add_u32 v7, v10, v4
    v_add_u32 v8, v10, v5
    v_add_u32 v9, v10, v6
    v_pk_fma_f32 v[84:85], v[212:213], v[164:165], v[84:85] op_sel:[0,0,0] op_sel_hi:[0,1,1]
    v_pk_fma_f32 v[86:87], v[212:213], v[166:167], v[86:87] op_sel:[0,0,0] op_sel_hi:[0,1,1]
    v_pk_fma_f32 v[88:89], v[212:213], v[168:169], v[88:89] op_sel:[0,0,0] op_sel_hi:[0,1,1]
    v_pk_fma_f32 v[90:91], v[212:213], v[170:171], v[90:91] op_sel:[0,0,0] op_sel_hi:[0,1,1]
    v_pk_fma_f32 v[92:93], v[212:213], v[172:173], v[92:93] op_sel:[0,0,0] op_sel_hi:[0,1,1]
    v_pk_fma_f32 v[94:95], v[212:213], v[174:175], v[94:95] op_sel:[0,0,0] op_sel_hi:[0,1,1]
    v_pk_fma_f32 v[96:97], v[212:213], v[176:177], v[96:97] op_sel:[0,0,0] op_sel_hi:[0,1,1]
    v_pk_fma_f32 v[98:99], v[212:213], v[178:179], v[98:99] op_sel:[0,0,0] op_sel_hi:[0,1,1]
    v_pk_mul_f32 v[84:85], v[218:219], v[84:85] op_sel:[0,0] op_sel_hi:[0,1]
    v_pk_mul_f32 v[86:87], v[218:219], v[86:87] op_sel:[0,0] op_sel_hi:[0,1]
    v_pk_mul_f32 v[88:89], v[218:219], v[88:89] op_sel:[0,0] op_sel_hi:[0,1]
    v_pk_mul_f32 v[90:91], v[218:219], v[90:91] op_sel:[0,0] op_sel_hi:[0,1]
    v_pk_mul_f32 v[92:93], v[218:219], v[92:93] op_sel:[0,0] op_sel_hi:[0,1]
    v_pk_mul_f32 v[94:95], v[218:219], v[94:95] op_sel:[0,0] op_sel_hi:[0,1]
    v_pk_mul_f32 v[96:97], v[218:219], v[96:97] op_sel:[0,0] op_sel_hi:[0,1]
    v_pk_mul_f32 v[98:99], v[218:219], v[98:99] op_sel:[0,0] op_sel_hi:[0,1]
    v_cvt_pk_bf16_f32 v84, v84, v85
    v_cvt_pk_bf16_f32 v85, v86, v87
    v_cvt_pk_bf16_f32 v86, v88, v89
    v_cvt_pk_bf16_f32 v87, v90, v91
    v_cvt_pk_bf16_f32 v88, v92, v93
    v_cvt_pk_bf16_f32 v89, v94, v95
    v_cvt_pk_bf16_f32 v90, v96, v97
    v_cvt_pk_bf16_f32 v91, v98, v99
    ds_write_b128 v5, v[84:87] offset:18944
    ds_write_b128 v5, v[88:91] offset:28160
    v_pk_fma_f32 v[100:101], v[214:215], v[164:165], v[100:101] op_sel:[0,0,0] op_sel_hi:[0,1,1]
    v_pk_fma_f32 v[102:103], v[214:215], v[166:167], v[102:103] op_sel:[0,0,0] op_sel_hi:[0,1,1]
    v_pk_fma_f32 v[104:105], v[214:215], v[168:169], v[104:105] op_sel:[0,0,0] op_sel_hi:[0,1,1]
    v_pk_fma_f32 v[106:107], v[214:215], v[170:171], v[106:107] op_sel:[0,0,0] op_sel_hi:[0,1,1]
    v_pk_fma_f32 v[108:109], v[214:215], v[172:173], v[108:109] op_sel:[0,0,0] op_sel_hi:[0,1,1]
    v_pk_fma_f32 v[110:111], v[214:215], v[174:175], v[110:111] op_sel:[0,0,0] op_sel_hi:[0,1,1]
    v_pk_fma_f32 v[112:113], v[214:215], v[176:177], v[112:113] op_sel:[0,0,0] op_sel_hi:[0,1,1]
    v_pk_fma_f32 v[114:115], v[214:215], v[178:179], v[114:115] op_sel:[0,0,0] op_sel_hi:[0,1,1]
    v_pk_mul_f32 v[100:101], v[220:221], v[100:101] op_sel:[0,0] op_sel_hi:[0,1]
    v_pk_mul_f32 v[102:103], v[220:221], v[102:103] op_sel:[0,0] op_sel_hi:[0,1]
    v_pk_mul_f32 v[104:105], v[220:221], v[104:105] op_sel:[0,0] op_sel_hi:[0,1]
    v_pk_mul_f32 v[106:107], v[220:221], v[106:107] op_sel:[0,0] op_sel_hi:[0,1]
    v_pk_mul_f32 v[108:109], v[220:221], v[108:109] op_sel:[0,0] op_sel_hi:[0,1]
    v_pk_mul_f32 v[110:111], v[220:221], v[110:111] op_sel:[0,0] op_sel_hi:[0,1]
    v_pk_mul_f32 v[112:113], v[220:221], v[112:113] op_sel:[0,0] op_sel_hi:[0,1]
    v_pk_mul_f32 v[114:115], v[220:221], v[114:115] op_sel:[0,0] op_sel_hi:[0,1]
    v_cvt_pk_bf16_f32 v100, v100, v101
    v_cvt_pk_bf16_f32 v101, v102, v103
    v_cvt_pk_bf16_f32 v102, v104, v105
    v_cvt_pk_bf16_f32 v103, v106, v107
    v_cvt_pk_bf16_f32 v104, v108, v109
    v_cvt_pk_bf16_f32 v105, v110, v111
    v_cvt_pk_bf16_f32 v106, v112, v113
    v_cvt_pk_bf16_f32 v107, v114, v115
    ds_write_b128 v6, v[100:103] offset:18944
    ds_write_b128 v6, v[104:107] offset:28160
    v_pk_fma_f32 v[116:117], v[212:213], v[180:181], v[116:117] op_sel:[0,0,0] op_sel_hi:[0,1,1]
    v_pk_fma_f32 v[118:119], v[212:213], v[182:183], v[118:119] op_sel:[0,0,0] op_sel_hi:[0,1,1]
    v_pk_fma_f32 v[120:121], v[212:213], v[184:185], v[120:121] op_sel:[0,0,0] op_sel_hi:[0,1,1]
    v_pk_fma_f32 v[122:123], v[212:213], v[186:187], v[122:123] op_sel:[0,0,0] op_sel_hi:[0,1,1]
    v_pk_fma_f32 v[124:125], v[212:213], v[188:189], v[124:125] op_sel:[0,0,0] op_sel_hi:[0,1,1]
    v_pk_fma_f32 v[126:127], v[212:213], v[190:191], v[126:127] op_sel:[0,0,0] op_sel_hi:[0,1,1]
    v_pk_fma_f32 v[128:129], v[212:213], v[192:193], v[128:129] op_sel:[0,0,0] op_sel_hi:[0,1,1]
    v_pk_fma_f32 v[130:131], v[212:213], v[194:195], v[130:131] op_sel:[0,0,0] op_sel_hi:[0,1,1]
    v_pk_mul_f32 v[116:117], v[218:219], v[116:117] op_sel:[0,0] op_sel_hi:[0,1]
    v_pk_mul_f32 v[118:119], v[218:219], v[118:119] op_sel:[0,0] op_sel_hi:[0,1]
    v_pk_mul_f32 v[120:121], v[218:219], v[120:121] op_sel:[0,0] op_sel_hi:[0,1]
    v_pk_mul_f32 v[122:123], v[218:219], v[122:123] op_sel:[0,0] op_sel_hi:[0,1]
    v_pk_mul_f32 v[124:125], v[218:219], v[124:125] op_sel:[0,0] op_sel_hi:[0,1]
    v_pk_mul_f32 v[126:127], v[218:219], v[126:127] op_sel:[0,0] op_sel_hi:[0,1]
    v_pk_mul_f32 v[128:129], v[218:219], v[128:129] op_sel:[0,0] op_sel_hi:[0,1]
    v_pk_mul_f32 v[130:131], v[218:219], v[130:131] op_sel:[0,0] op_sel_hi:[0,1]
    ds_write_b128 v8, v[116:119] offset:512
    ds_write_b128 v8, v[120:123] offset:5120
    ds_write_b128 v8, v[124:127] offset:18944
    ds_write_b128 v8, v[128:131] offset:23552
    v_pk_fma_f32 v[132:133], v[214:215], v[180:181], v[132:133] op_sel:[0,0,0] op_sel_hi:[0,1,1]
    v_pk_fma_f32 v[134:135], v[214:215], v[182:183], v[134:135] op_sel:[0,0,0] op_sel_hi:[0,1,1]
    v_pk_fma_f32 v[136:137], v[214:215], v[184:185], v[136:137] op_sel:[0,0,0] op_sel_hi:[0,1,1]
    v_pk_fma_f32 v[138:139], v[214:215], v[186:187], v[138:139] op_sel:[0,0,0] op_sel_hi:[0,1,1]
    v_pk_fma_f32 v[140:141], v[214:215], v[188:189], v[140:141] op_sel:[0,0,0] op_sel_hi:[0,1,1]
    v_pk_fma_f32 v[142:143], v[214:215], v[190:191], v[142:143] op_sel:[0,0,0] op_sel_hi:[0,1,1]
    v_pk_fma_f32 v[144:145], v[214:215], v[192:193], v[144:145] op_sel:[0,0,0] op_sel_hi:[0,1,1]
    v_pk_fma_f32 v[146:147], v[214:215], v[194:195], v[146:147] op_sel:[0,0,0] op_sel_hi:[0,1,1]
    v_pk_mul_f32 v[132:133], v[220:221], v[132:133] op_sel:[0,0] op_sel_hi:[0,1]
    v_pk_mul_f32 v[134:135], v[220:221], v[134:135] op_sel:[0,0] op_sel_hi:[0,1]
    v_pk_mul_f32 v[136:137], v[220:221], v[136:137] op_sel:[0,0] op_sel_hi:[0,1]
    v_pk_mul_f32 v[138:139], v[220:221], v[138:139] op_sel:[0,0] op_sel_hi:[0,1]
    v_pk_mul_f32 v[140:141], v[220:221], v[140:141] op_sel:[0,0] op_sel_hi:[0,1]
    v_pk_mul_f32 v[142:143], v[220:221], v[142:143] op_sel:[0,0] op_sel_hi:[0,1]
    v_pk_mul_f32 v[144:145], v[220:221], v[144:145] op_sel:[0,0] op_sel_hi:[0,1]
    v_pk_mul_f32 v[146:147], v[220:221], v[146:147] op_sel:[0,0] op_sel_hi:[0,1]
    ds_write_b128 v9, v[132:135] offset:512
    ds_write_b128 v9, v[136:139] offset:5120
    ds_write_b128 v9, v[140:143] offset:18944
    ds_write_b128 v9, v[144:147] offset:23552
    s_branch K1_ATTN
K1_A1H_SLOW:
    s_mov_b32 s62, 0
K1_A1H_SPIN:
    s_add_u32 s62, s62, 1
    s_cmp_ge_u32 s62, 4000
    s_cbranch_scc1 K1_A1H_FB1
    s_sleep 4
    v_lshlrev_b32 v11, 2, v1
    global_load_dword v223, v11, s[76:77] sc1
    s_waitcnt vmcnt(0)
    v_and_b32 v11, v223, v221
    v_cmp_ne_u32 vcc, v11, v221
    s_nop 4
    s_cbranch_vccz K1_A1H_RDY
    s_branch K1_A1H_SPIN
K1_A1H_FB1:
    v_mov_b32 v5, 1
    s_branch K1_A1H_RDY
K1_A1H_FB:
    s_lshl_b32 s63, s35, 8
    s_lshl_b32 s47, s38, 6
    s_add_u32 s63, s63, s47
    s_lshl_b32 s47, s37, 5
    s_add_u32 s63, s63, s47
    s_mov_b32 s62, 0
K1_A1H_FS0:
    s_add_u32 s64, s63, s62
    s_lshl_b32 s64, s64, 10
    buffer_load_dwordx4 v[164:167], v219, s[8:11], s64 offen
    s_waitcnt vmcnt(0)
    v_mov_b32 v8, 0
    v_mov_b32 v9, 0
    v_dot2c_f32_bf16 v8, s54, v164
    v_dot2c_f32_bf16 v9, v164, v164
    v_dot2c_f32_bf16 v8, s54, v165
    v_dot2c_f32_bf16 v9, v165, v165
    v_dot2c_f32_bf16 v8, s54, v166
    v_dot2c_f32_bf16 v9, v166, v166
    v_dot2c_f32_bf16 v8, s54, v167
    v_dot2c_f32_bf16 v9, v167, v167
    s_nop 2
    v_add_f32_dpp v8, v8, v8 row_shr:1 row_mask:0xf bank_mask:0xf bound_ctrl:0
    v_add_f32_dpp v9, v9, v9 row_shr:1 row_mask:0xf bank_mask:0xf bound_ctrl:0
    s_nop 0
    v_add_f32_dpp v8, v8, v8 row_shr:2 row_mask:0xf bank_mask:0xf bound_ctrl:0
    v_add_f32_dpp v9, v9, v9 row_shr:2 row_mask:0xf bank_mask:0xf bound_ctrl:0
    s_nop 0
    v_add_f32_dpp v8, v8, v8 row_shr:4 row_mask:0xf bank_mask:0xf bound_ctrl:0
    v_add_f32_dpp v9, v9, v9 row_shr:4 row_mask:0xf bank_mask:0xf bound_ctrl:0
    s_nop 0
    v_add_f32_dpp v8, v8, v8 row_shr:8 row_mask:0xf bank_mask:0xf bound_ctrl:0
    v_add_f32_dpp v9, v9, v9 row_shr:8 row_mask:0xf bank_mask:0xf bound_ctrl:0
    s_nop 0
    v_add_f32_dpp v8, v8, v8 row_bcast:15 row_mask:0xa bank_mask:0xf
    v_add_f32_dpp v9, v9, v9 row_bcast:15 row_mask:0xa bank_mask:0xf
    s_nop 0
    v_add_f32_dpp v8, v8, v8 row_bcast:31 row_mask:0xc bank_mask:0xf
    v_add_f32_dpp v9, v9, v9 row_bcast:31 row_mask:0xc bank_mask:0xf
    s_nop 0
    v_readlane_b32 s46, v8, 63
    v_readlane_b32 s47, v9, 63
    s_nop 1
    v_mov_b32 v8, s46
    v_mov_b32 v9, s47
    v_cmp_eq_u32 vcc, s62, v2
    s_nop 1
    v_cndmask_b32 v248, v248, v8, vcc
    v_cndmask_b32 v249, v249, v9, vcc
    s_add_u32 s62, s62, 1
    s_cmp_lt_u32 s62, 32
    s_cbranch_scc1 K1_A1H_FS0
    s_xor_b32 s63, s63, 32
    s_mov_b32 s62, 0
K1_A1H_FS1:
    s_add_u32 s64, s63, s62
    s_lshl_b32 s64, s64, 10
    buffer_load_dwordx4 v[164:167], v219, s[8:11], s64 offen
    s_waitcnt vmcnt(0)
    v_mov_b32 v8, 0
    v_mov_b32 v9, 0
    v_dot2c_f32_bf16 v8, s54, v164
    v_dot2c_f32_bf16 v9, v164, v164
    v_dot2c_f32_bf16 v8, s54, v165
    v_dot2c_f32_bf16 v9, v165, v165
    v_dot2c_f32_bf16 v8, s54, v166
    v_dot2c_f32_bf16 v9, v166, v166
    v_dot2c_f32_bf16 v8, s54, v167
    v_dot2c_f32_bf16 v9, v167, v167
    s_nop 2
    v_add_f32_dpp v8, v8, v8 row_shr:1 row_mask:0xf bank_mask:0xf bound_ctrl:0
    v_add_f32_dpp v9, v9, v9 row_shr:1 row_mask:0xf bank_mask:0xf bound_ctrl:0
    s_nop 0
    v_add_f32_dpp v8, v8, v8 row_shr:2 row_mask:0xf bank_mask:0xf bound_ctrl:0
    v_add_f32_dpp v9, v9, v9 row_shr:2 row_mask:0xf bank_mask:0xf bound_ctrl:0
    s_nop 0
    v_add_f32_dpp v8, v8, v8 row_shr:4 row_mask:0xf bank_mask:0xf bound_ctrl:0
    v_add_f32_dpp v9, v9, v9 row_shr:4 row_mask:0xf bank_mask:0xf bound_ctrl:0
    s_nop 0
    v_add_f32_dpp v8, v8, v8 row_shr:8 row_mask:0xf bank_mask:0xf bound_ctrl:0
    v_add_f32_dpp v9, v9, v9 row_shr:8 row_mask:0xf bank_mask:0xf bound_ctrl:0
    s_nop 0
    v_add_f32_dpp v8, v8, v8 row_bcast:15 row_mask:0xa bank_mask:0xf
    v_add_f32_dpp v9, v9, v9 row_bcast:15 row_mask:0xa bank_mask:0xf
    s_nop 0
    v_add_f32_dpp v8, v8, v8 row_bcast:31 row_mask:0xc bank_mask:0xf
    v_add_f32_dpp v9, v9, v9 row_bcast:31 row_mask:0xc bank_mask:0xf
    s_nop 0
    v_readlane_b32 s46, v8, 63
    v_readlane_b32 s47, v9, 63
    s_nop 1
    v_mov_b32 v8, s46
    v_mov_b32 v9, s47
    v_cmp_eq_u32 vcc, s62, v2
    s_nop 1
    v_cndmask_b32 v250, v250, v8, vcc
    v_cndmask_b32 v251, v251, v9, vcc
    s_add_u32 s62, s62, 1
    s_cmp_lt_u32 s62, 32
    s_cbranch_scc1 K1_A1H_FS1
    s_lshl_b32 s63, s35, 8
    s_sub_u32 s63, s63, 32
    s_cmp_eq_u32 s35, 0
    s_cselect_b32 s63, 0, s63
    s_mov_b32 s62, 0
K1_A1H_FS2:
    s_add_u32 s64, s63, s62
    s_lshl_b32 s64, s64, 10
    buffer_load_dwordx4 v[164:167], v219, s[8:11], s64 offen
    s_waitcnt vmcnt(0)
    v_mov_b32 v8, 0
    v_mov_b32 v9, 0
    v_dot2c_f32_bf16 v8, s54, v164
    v_dot2c_f32_bf16 v9, v164, v164
    v_dot2c_f32_bf16 v8, s54, v165
    v_dot2c_f32_bf16 v9, v165, v165
    v_dot2c_f32_bf16 v8, s54, v166
    v_dot2c_f32_bf16 v9, v166, v166
    v_dot2c_f32_bf16 v8, s54, v167
    v_dot2c_f32_bf16 v9, v167, v167
    s_nop 2
    v_add_f32_dpp v8, v8, v8 row_shr:1 row_mask:0xf bank_mask:0xf bound_ctrl:0
    v_add_f32_dpp v9, v9, v9 row_shr:1 row_mask:0xf bank_mask:0xf bound_ctrl:0
    s_nop 0
    v_add_f32_dpp v8, v8, v8 row_shr:2 row_mask:0xf bank_mask:0xf bound_ctrl:0
    v_add_f32_dpp v9, v9, v9 row_shr:2 row_mask:0xf bank_mask:0xf bound_ctrl:0
    s_nop 0
    v_add_f32_dpp v8, v8, v8 row_shr:4 row_mask:0xf bank_mask:0xf bound_ctrl:0
    v_add_f32_dpp v9, v9, v9 row_shr:4 row_mask:0xf bank_mask:0xf bound_ctrl:0
    s_nop 0
    v_add_f32_dpp v8, v8, v8 row_shr:8 row_mask:0xf bank_mask:0xf bound_ctrl:0
    v_add_f32_dpp v9, v9, v9 row_shr:8 row_mask:0xf bank_mask:0xf bound_ctrl:0
    s_nop 0
    v_add_f32_dpp v8, v8, v8 row_bcast:15 row_mask:0xa bank_mask:0xf
    v_add_f32_dpp v9, v9, v9 row_bcast:15 row_mask:0xa bank_mask:0xf
    s_nop 0
    v_add_f32_dpp v8, v8, v8 row_bcast:31 row_mask:0xc bank_mask:0xf
    v_add_f32_dpp v9, v9, v9 row_bcast:31 row_mask:0xc bank_mask:0xf
    s_nop 0
    v_readlane_b32 s46, v8, 63
    v_readlane_b32 s47, v9, 63
    s_nop 1
    v_mov_b32 v8, s46
    v_mov_b32 v9, s47
    v_cmp_eq_u32 vcc, s62, v2
    s_nop 1
    v_cndmask_b32 v252, v252, v8, vcc
    v_cndmask_b32 v253, v253, v9, vcc
    s_add_u32 s62, s62, 1
    s_cmp_lt_u32 s62, 32
    s_cbranch_scc1 K1_A1H_FS2
    v_mov_b32 v232, 0
    v_mov_b32 v233, 0
    v_mov_b32 v234, 0
    v_mov_b32 v235, 0
    v_mov_b32 v236, 0
    v_mov_b32 v237, 0
    v_mov_b32 v238, 0
    v_mov_b32 v239, 0
    v_mov_b32 v240, 0
    v_mov_b32 v241, 0
    v_mov_b32 v242, 0
    v_mov_b32 v243, 0
    v_mov_b32 v244, 0
    v_mov_b32 v245, 0
    v_mov_b32 v246, 0
    v_mov_b32 v247, 0
    s_lshl_b32 s46, s37, 1
    s_add_u32 s46, s46, s58
    v_add_u32 v4, s46, v3
    v_and_b32 v5, 15, v2
    v_lshlrev_b32 v5, 1, v5
    v_lshl_add_u32 v4, v4, 5, v5
    v_mov_b32 v164, s28
    v_mov_b32 v165, s29
    v_mov_b32 v6, s30
    v_mov_b32 v7, s31
    v_cmp_lt_u32 vcc, 15, v2
    s_nop 1
    v_cndmask_b32 v164, v164, v6, vcc
    v_cndmask_b32 v165, v165, v7, vcc
    v_mov_b32 v166, 2752
    s_lshl_b32 s46, s36, 6
    v_lshl_add_u32 v5, v2, 1, s46
    v_lshl_add_u32 v5, v3, 10, v5
    v_add_u32 v5, 1024, v5
    v_mov_b32 v6, s6
    v_mov_b32 v7, s7
    v_mov_b32 v8, 3072
    v_cmp_gt_u32 vcc, 64, v1
    s_nop 1
    v_cndmask_b32 v164, v164, v6, vcc
    v_cndmask_b32 v165, v165, v7, vcc
    v_cndmask_b32 v4, v4, v5, vcc
    v_cndmask_b32 v166, v166, v8, vcc
    v_mov_b32 v167, 0
    v_mov_b32 v5, 0
    v_add_co_u32 v164, vcc, v164, v4
    s_nop 1
    v_addc_co_u32 v165, vcc, v165, v5, vcc
    s_mov_b32 s62, 0
K1_A1H_FC0:
    global_load_ushort v6, v[164:165], off
    v_lshl_add_u64 v[164:165], v[166:167], 0, v[164:165]
    s_waitcnt vmcnt(0)
    v_lshlrev_b32 v6, 16, v6
    v_add_f32 v232, v232, v6
    s_add_u32 s62, s62, 1
    s_cmp_lt_u32 s62, 512
    s_cbranch_scc1 K1_A1H_FC0
    s_branch K1_A1H_HB
K1_A1H:
    s_barrier
    ds_read_b128 v[44:47], v24 offset:0
    ds_read_b64_tr_b16 v[52:53], v36 offset:0
    ds_read_b64_tr_b16 v[54:55], v36 offset:768
    ds_read_b128 v[48:51], v28 offset:0
    ds_read_b64_tr_b16 v[56:57], v38 offset:0
    ds_read_b64_tr_b16 v[58:59], v38 offset:768
    ds_read_b128 v[60:63], v32 offset:0
    s_add_u32 m0, s50, 106496
    s_nop 0
    buffer_load_dwordx4 v16, s[8:11], s40 offen offset:0 lds
    buffer_load_dwordx4 v17, s[8:11], s40 offen offset:1024 lds
    s_waitcnt lgkmcnt(0)
    v_mfma_f32_32x32x16_bf16 v[84:99], v[52:55], v[44:47], 0
    ds_read_b128 v[64:67], v25 offset:0
    ds_read_b64_tr_b16 v[72:73], v36 offset:3072
    ds_read_b64_tr_b16 v[74:75], v36 offset:3840
    ds_read_b128 v[68:71], v29 offset:0
    v_mfma_f32_32x32x16_bf16 v[100:115], v[52:55], v[48:51], 0
    ds_read_b64_tr_b16 v[76:77], v38 offset:3072
    ds_read_b64_tr_b16 v[78:79], v38 offset:3840
    ds_read_b128 v[80:83], v33 offset:0
    v_mfma_f32_32x32x16_bf16 v[116:131], v[56:59], v[44:47], 0
    buffer_load_dwordx4 v18, s[8:11], s40 offen offset:2048 lds
    buffer_load_dwordx4 v19, s[8:11], s40 offen offset:3072 lds
    s_mul_i32 s46, s38, 3072
    v_add_u32 v4, s46, v36
    ds_read_b64_tr_b16 v[164:165], v4 offset:0
    ds_read_b64_tr_b16 v[166:167], v4 offset:768
    s_mul_i32 s46, s38, 3072
    v_mfma_f32_32x32x16_bf16 v[132:147], v[56:59], v[48:51], 0
    v_add_u32 v4, s46, v38
    ds_read_b64_tr_b16 v[168:169], v4 offset:0
    ds_read_b64_tr_b16 v[170:171], v4 offset:768
    v_mov_b32 v6, 0
    v_mov_b32 v7, 0
    v_mov_b32 v8, 0
    s_mul_i32 s46, s38, 640
    v_mfma_f32_32x32x16_bf16 v[148:163], v[52:55], v[60:63], 0
    s_lshl_b32 s47, s37, 8
    s_add_u32 s47, s47, s46
    v_lshl_add_u32 v10, v1, 2, s47
    v_lshl_add_u32 v11, v2, 2, s46
    v_add_u32 v10, 159744, v10
    v_add_u32 v11, 160256, v11
    s_waitcnt lgkmcnt(0)
    v_mfma_f32_32x32x16_bf16 v[84:99], v[72:75], v[64:67], v[84:99]
    ds_read_b128 v[44:47], v26 offset:0
    ds_read_b64_tr_b16 v[52:53], v36 offset:6144
    ds_read_b64_tr_b16 v[54:55], v36 offset:6912
    ds_read_b128 v[48:51], v30 offset:0
    v_mfma_f32_32x32x16_bf16 v[100:115], v[72:75], v[68:71], v[100:115]
    ds_read_b64_tr_b16 v[56:57], v38 offset:6144
    ds_read_b64_tr_b16 v[58:59], v38 offset:6912
    ds_read_b128 v[60:63], v34 offset:0
    v_mfma_f32_32x32x16_bf16 v[116:131], v[76:79], v[64:67], v[116:131]
    s_add_u32 m0, s51, 106496
    s_nop 0
    buffer_load_dwordx4 v225, s[12:15], s41 offen lds
    s_mov_b32 exec_hi, 0
    buffer_load_dwordx4 v227, s[12:15], s41 offen offset:1024 lds
    s_mov_b32 exec_hi, -1
    v_mfma_f32_32x32x16_bf16 v[132:147], v[76:79], v[68:71], v[132:147]
    v_dot2c_f32_bf16 v6, s54, v164
    v_dot2c_f32_bf16 v7, s54, v168
    v_dot2c_f32_bf16 v6, s54, v165
    v_dot2c_f32_bf16 v7, s54, v169
    v_mfma_f32_32x32x16_bf16 v[148:163], v[72:75], v[80:83], v[148:163]
    v_dot2c_f32_bf16 v6, s54, v166
    v_dot2c_f32_bf16 v7, s54, v170
    v_dot2c_f32_bf16 v6, s54, v167
    v_dot2c_f32_bf16 v7, s54, v171
    s_waitcnt lgkmcnt(0)
    v_mfma_f32_32x32x16_bf16 v[84:99], v[52:55], v[44:47], v[84:99]
    ds_read_b128 v[64:67], v27 offset:0
    ds_read_b64_tr_b16 v[72:73], v36 offset:9216
    ds_read_b64_tr_b16 v[74:75], v36 offset:9984
    ds_read_b128 v[68:71], v31 offset:0
    v_mfma_f32_32x32x16_bf16 v[100:115], v[52:55], v[48:51], v[100:115]
    ds_read_b64_tr_b16 v[76:77], v38 offset:9216
    ds_read_b64_tr_b16 v[78:79], v38 offset:9984
    ds_read_b128 v[80:83], v35 offset:0
    v_mfma_f32_32x32x16_bf16 v[116:131], v[56:59], v[44:47], v[116:131]
    s_add_u32 m0, s52, 106496
    s_mov_b32 exec_hi, 0
    buffer_load_dwordx4 v20, s[8:11], s40 offen lds
    s_mov_b32 exec_hi, -1
    s_add_u32 m0, s53, 106496
    s_mov_b32 exec_hi, 0
    buffer_load_dwordx4 v229, s[20:23], s42 offen lds
    s_mov_b32 exec_hi, -1
    s_add_u32 s49, s49, 1
    s_and_b32 s49, s49, 7
    s_lshl_b32 s40, s49, 7
    s_mul_i32 s42, s49, 176128
    s_mul_i32 s41, s49, 196608
    v_mfma_f32_32x32x16_bf16 v[132:147], v[56:59], v[48:51], v[132:147]
    s_cmp_eq_u32 s34, 3
    s_cbranch_scc0 K1_A1H_NS
    v_swap_b32 v6, v7
K1_A1H_NS:
    v_mov_b32 v9, v8
    s_nop 1
    v_permlane32_swap_b32 v6, v7
    v_permlane32_swap_b32 v8, v9
    s_nop 1
    v_add_f32 v6, v6, v7
    v_add_f32 v8, v8, v9
    ds_write_b32 v10, v6
    ds_write_b32 v11, v8
    v_mfma_f32_32x32x16_bf16 v[148:163], v[52:55], v[60:63], v[148:163]
    s_waitcnt vmcnt(8) lgkmcnt(0)
    s_barrier
    v_mfma_f32_32x32x16_bf16 v[84:99], v[72:75], v[64:67], v[84:99]
    ds_read_b128 v[44:47], v24 offset:53248
    ds_read_b64_tr_b16 v[52:53], v36 offset:53248
    ds_read_b64_tr_b16 v[54:55], v36 offset:54016
    ds_read_b128 v[48:51], v28 offset:53248
    v_mfma_f32_32x32x16_bf16 v[100:115], v[72:75], v[68:71], v[100:115]
    ds_read_b64_tr_b16 v[56:57], v38 offset:53248
    ds_read_b64_tr_b16 v[58:59], v38 offset:54016
    ds_read_b128 v[60:63], v32 offset:53248
    v_mfma_f32_32x32x16_bf16 v[116:131], v[76:79], v[64:67], v[116:131]
    s_add_u32 m0, s50, 0
    s_nop 0
    buffer_load_dwordx4 v16, s[8:11], s40 offen offset:0 lds
    buffer_load_dwordx4 v17, s[8:11], s40 offen offset:1024 lds
    s_lshl_b32 s46, s34, 8
    v_lshl_add_u32 v4, v1, 2, s46
    v_min_u32 v5, 636, v4
    v_add_u32 v5, 159744, v5
    ds_read_b32 v6, v5 offset:0
    ds_read_b32 v7, v5 offset:640
    ds_read_b32 v8, v5 offset:1280
    v_mfma_f32_32x32x16_bf16 v[132:147], v[76:79], v[68:71], v[132:147]
    ds_read_b32 v9, v5 offset:1920
    s_lshl_b32 s46, s48, 3
    s_add_u32 s46, s46, s35
    s_mul_i32 s46, s46, 640
    s_add_u32 s46, s46, 8388608
    v_add_u32 v4, s46, v4
    v_mov_b32 v10, 0
    v_mov_b32 v11, 0
    v_dot2c_f32_bf16 v10, s54, v232
    v_dot2c_f32_bf16 v11, v232, v232
    v_mfma_f32_32x32x16_bf16 v[148:163], v[72:75], v[80:83], v[148:163]
    v_dot2c_f32_bf16 v10, s54, v233
    v_dot2c_f32_bf16 v11, v233, v233
    v_dot2c_f32_bf16 v10, s54, v234
    v_dot2c_f32_bf16 v11, v234, v234
    v_dot2c_f32_bf16 v10, s54, v235
    v_dot2c_f32_bf16 v11, v235, v235
    s_nop 2
    v_add_f32_dpp v10, v10, v10 row_shr:1 row_mask:0xf bank_mask:0xf bound_ctrl:0
    v_add_f32_dpp v11, v11, v11 row_shr:1 row_mask:0xf bank_mask:0xf bound_ctrl:0
    s_nop 0
    s_waitcnt lgkmcnt(0)
    v_mfma_f32_32x32x16_bf16 v[84:99], v[52:55], v[44:47], v[84:99]
    ds_read_b128 v[64:67], v25 offset:53248
    ds_read_b64_tr_b16 v[72:73], v36 offset:56320
    ds_read_b64_tr_b16 v[74:75], v36 offset:57088
    ds_read_b128 v[68:71], v29 offset:53248
    v_mfma_f32_32x32x16_bf16 v[100:115], v[52:55], v[48:51], v[100:115]
    ds_read_b64_tr_b16 v[76:77], v38 offset:56320
    ds_read_b64_tr_b16 v[78:79], v38 offset:57088
    ds_read_b128 v[80:83], v33 offset:53248
    v_mfma_f32_32x32x16_bf16 v[116:131], v[56:59], v[44:47], v[116:131]
    v_add_f32 v6, v6, v7
    v_add_f32 v8, v8, v9
    v_add_f32 v6, v6, v8
    s_cmp_ge_u32 s34, 3
    s_cbranch_scc1 K1_A1H_H1
    s_cmp_eq_u32 s34, 2
    s_cselect_b32 exec_hi, 0, -1
    global_store_dword v4, v6, s[32:33] sc1
    s_mov_b32 exec_hi, -1
K1_A1H_H1:
    v_add_f32_dpp v10, v10, v10 row_shr:2 row_mask:0xf bank_mask:0xf bound_ctrl:0
    v_add_f32_dpp v11, v11, v11 row_shr:2 row_mask:0xf bank_mask:0xf bound_ctrl:0
    v_mfma_f32_32x32x16_bf16 v[132:147], v[56:59], v[48:51], v[132:147]
    s_nop 0
    v_add_f32_dpp v10, v10, v10 row_shr:4 row_mask:0xf bank_mask:0xf bound_ctrl:0
    v_add_f32_dpp v11, v11, v11 row_shr:4 row_mask:0xf bank_mask:0xf bound_ctrl:0
    s_nop 0
    v_add_f32_dpp v10, v10, v10 row_shr:8 row_mask:0xf bank_mask:0xf bound_ctrl:0
    v_add_f32_dpp v11, v11, v11 row_shr:8 row_mask:0xf bank_mask:0xf bound_ctrl:0
    s_nop 0
    v_add_f32_dpp v10, v10, v10 row_bcast:15 row_mask:0xa bank_mask:0xf
    v_add_f32_dpp v11, v11, v11 row_bcast:15 row_mask:0xa bank_mask:0xf
    s_nop 0
    v_add_f32_dpp v10, v10, v10 row_bcast:31 row_mask:0xc bank_mask:0xf
    v_add_f32_dpp v11, v11, v11 row_bcast:31 row_mask:0xc bank_mask:0xf
    v_mfma_f32_32x32x16_bf16 v[148:163], v[52:55], v[60:63], v[148:163]
    s_nop 0
    v_readlane_b32 s44, v10, 63
    v_readlane_b32 s45, v11, 63
    s_nop 1
    v_mov_b32 v236, s44
    v_mov_b32 v237, s45
    v_mov_b32 v10, s60
    s_mov_b64 exec, 1
    global_store_dwordx2 v10, v[236:237], s[32:33] sc1
    s_mov_b64 exec, -1
    buffer_load_dwordx4 v18, s[8:11], s40 offen offset:2048 lds
    buffer_load_dwordx4 v19, s[8:11], s40 offen offset:3072 lds
    s_waitcnt lgkmcnt(0)
    v_mfma_f32_32x32x16_bf16 v[84:99], v[72:75], v[64:67], v[84:99]
    ds_read_b128 v[44:47], v26 offset:53248
    ds_read_b64_tr_b16 v[52:53], v36 offset:59392
    ds_read_b64_tr_b16 v[54:55], v36 offset:60160
    ds_read_b128 v[48:51], v30 offset:53248
    v_mfma_f32_32x32x16_bf16 v[100:115], v[72:75], v[68:71], v[100:115]
    ds_read_b64_tr_b16 v[56:57], v38 offset:59392
    ds_read_b64_tr_b16 v[58:59], v38 offset:60160
    ds_read_b128 v[60:63], v34 offset:53248
    v_mfma_f32_32x32x16_bf16 v[116:131], v[76:79], v[64:67], v[116:131]
    s_add_u32 m0, s51, 0
    s_nop 0
    buffer_load_dwordx4 v225, s[12:15], s41 offen lds
    v_mfma_f32_32x32x16_bf16 v[132:147], v[76:79], v[68:71], v[132:147]
    s_mov_b32 exec_hi, 0
    buffer_load_dwordx4 v227, s[12:15], s41 offen offset:1024 lds
    s_mov_b32 exec_hi, -1
    v_mfma_f32_32x32x16_bf16 v[148:163], v[72:75], v[80:83], v[148:163]
    s_waitcnt lgkmcnt(0)
    v_mfma_f32_32x32x16_bf16 v[84:99], v[52:55], v[44:47], v[84:99]
    ds_read_b128 v[64:67], v27 offset:53248
    ds_read_b64_tr_b16 v[72:73], v36 offset:62464
    ds_read_b64_tr_b16 v[74:75], v36 offset:63232
    ds_read_b128 v[68:71], v31 offset:53248
    v_mfma_f32_32x32x16_bf16 v[100:115], v[52:55], v[48:51], v[100:115]
    ds_read_b64_tr_b16 v[76:77], v38 offset:62464
    ds_read_b64_tr_b16 v[78:79], v38 offset:63232
    ds_read_b128 v[80:83], v35 offset:53248
    v_mfma_f32_32x32x16_bf16 v[116:131], v[56:59], v[44:47], v[116:131]
    s_add_u32 m0, s52, 0
    s_mov_b32 exec_hi, 0
    buffer_load_dwordx4 v20, s[8:11], s40 offen lds
    s_mov_b32 exec_hi, -1
    s_add_u32 m0, s53, 0
    s_mov_b32 exec_hi, 0
    buffer_load_dwordx4 v229, s[20:23], s42 offen lds
    s_mov_b32 exec_hi, -1
    s_add_u32 s49, s49, 1
    s_and_b32 s49, s49, 7
    s_lshl_b32 s40, s49, 7
    s_mul_i32 s42, s49, 176128
    s_mul_i32 s41, s49, 196608
    v_mfma_f32_32x32x16_bf16 v[132:147], v[56:59], v[48:51], v[132:147]
    v_add_u32 v24, 106496, v24
    v_add_u32 v25, 106496, v25
    v_add_u32 v26, 106496, v26
    v_add_u32 v27, 106496, v27
    v_add_u32 v28, 106496, v28
    v_add_u32 v29, 106496, v29
    v_add_u32 v30, 106496, v30
    v_mfma_f32_32x32x16_bf16 v[148:163], v[52:55], v[60:63], v[148:163]
    v_add_u32 v31, 106496, v31
    v_add_u32 v36, 106496, v36
    v_add_u32 v40, 106496, v40
    v_add_u32 v41, 106496, v41
    v_add_u32 v38, 106496, v38
    v_add_u32 v32, 106496, v32
    v_add_u32 v33, 106496, v33
    v_add_u32 v34, 106496, v34
    v_add_u32 v35, 106496, v35
    s_waitcnt vmcnt(6) lgkmcnt(0)
    s_barrier
    v_mfma_f32_32x32x16_bf16 v[84:99], v[72:75], v[64:67], v[84:99]
    ds_read_b128 v[44:47], v24 offset:0
    ds_read_b64_tr_b16 v[52:53], v36 offset:0
    ds_read_b64_tr_b16 v[54:55], v36 offset:768
    ds_read_b128 v[48:51], v28 offset:0
    v_mfma_f32_32x32x16_bf16 v[100:115], v[72:75], v[68:71], v[100:115]
    ds_read_b64_tr_b16 v[56:57], v38 offset:0
    ds_read_b64_tr_b16 v[58:59], v38 offset:768
    ds_read_b128 v[60:63], v32 offset:0
    v_mfma_f32_32x32x16_bf16 v[116:131], v[76:79], v[64:67], v[116:131]
    s_add_u32 m0, s50, 53248
    s_nop 0
    buffer_load_dwordx4 v16, s[8:11], s40 offen offset:0 lds
    buffer_load_dwordx4 v17, s[8:11], s40 offen offset:1024 lds
    s_cmp_lg_u32 s34, 0
    s_cbranch_scc1 K1_A1H_H2
    s_lshl_b32 s46, s35, 5
    s_add_u32 s46, s46, s48
    s_and_b32 s47, s46, 3
    s_lshl_b32 s47, s47, 3
    s_lshl_b32 s47, 1, s47
    s_and_b32 s46, s46, 252
    v_mov_b32 v4, s46
    v_mov_b32 v5, s47
    s_mov_b64 exec, 1
    global_atomic_add v4, v5, s[76:77] sc1
    s_mov_b64 exec, -1
K1_A1H_H2:
    v_mfma_f32_32x32x16_bf16 v[132:147], v[76:79], v[68:71], v[132:147]
    v_mfma_f32_32x32x16_bf16 v[148:163], v[72:75], v[80:83], v[148:163]
    s_waitcnt lgkmcnt(0)
    v_mfma_f32_32x32x16_bf16 v[84:99], v[52:55], v[44:47], v[84:99]
    ds_read_b128 v[64:67], v25 offset:0
    ds_read_b64_tr_b16 v[72:73], v36 offset:3072
    ds_read_b64_tr_b16 v[74:75], v36 offset:3840
    ds_read_b128 v[68:71], v29 offset:0
    v_mfma_f32_32x32x16_bf16 v[100:115], v[52:55], v[48:51], v[100:115]
    ds_read_b64_tr_b16 v[76:77], v38 offset:3072
    ds_read_b64_tr_b16 v[78:79], v38 offset:3840
    ds_read_b128 v[80:83], v33 offset:0
    v_mfma_f32_32x32x16_bf16 v[116:131], v[56:59], v[44:47], v[116:131]
    buffer_load_dwordx4 v18, s[8:11], s40 offen offset:2048 lds
    v_mfma_f32_32x32x16_bf16 v[132:147], v[56:59], v[48:51], v[132:147]
    buffer_load_dwordx4 v19, s[8:11], s40 offen offset:3072 lds
    v_mfma_f32_32x32x16_bf16 v[148:163], v[52:55], v[60:63], v[148:163]
    s_waitcnt lgkmcnt(0)
    v_mfma_f32_32x32x16_bf16 v[84:99], v[72:75], v[64:67], v[84:99]
    ds_read_b128 v[44:47], v26 offset:0
    ds_read_b64_tr_b16 v[52:53], v36 offset:6144
    ds_read_b64_tr_b16 v[54:55], v36 offset:6912
    ds_read_b128 v[48:51], v30 offset:0
    v_mfma_f32_32x32x16_bf16 v[100:115], v[72:75], v[68:71], v[100:115]
    ds_read_b64_tr_b16 v[56:57], v38 offset:6144
    ds_read_b64_tr_b16 v[58:59], v38 offset:6912
    ds_read_b128 v[60:63], v34 offset:0
    v_mfma_f32_32x32x16_bf16 v[116:131], v[76:79], v[64:67], v[116:131]
    s_add_u32 m0, s51, 53248
    s_nop 0
    buffer_load_dwordx4 v225, s[12:15], s41 offen lds
    v_mfma_f32_32x32x16_bf16 v[132:147], v[76:79], v[68:71], v[132:147]
    s_mov_b32 exec_hi, 0
    buffer_load_dwordx4 v227, s[12:15], s41 offen offset:1024 lds
    s_mov_b32 exec_hi, -1
    v_mfma_f32_32x32x16_bf16 v[148:163], v[72:75], v[80:83], v[148:163]
    s_waitcnt lgkmcnt(0)
    v_mfma_f32_32x32x16_bf16 v[84:99], v[52:55], v[44:47], v[84:99]
    ds_read_b128 v[64:67], v27 offset:0
    ds_read_b64_tr_b16 v[72:73], v36 offset:9216
    ds_read_b64_tr_b16 v[74:75], v36 offset:9984
    ds_read_b128 v[68:71], v31 offset:0
    v_mfma_f32_32x32x16_bf16 v[100:115], v[52:55], v[48:51], v[100:115]
    ds_read_b64_tr_b16 v[76:77], v38 offset:9216
    ds_read_b64_tr_b16 v[78:79], v38 offset:9984
    ds_read_b128 v[80:83], v35 offset:0
    v_mfma_f32_32x32x16_bf16 v[116:131], v[56:59], v[44:47], v[116:131]
    s_add_u32 m0, s52, 53248
    s_mov_b32 exec_hi, 0
    buffer_load_dwordx4 v20, s[8:11], s40 offen lds
    s_mov_b32 exec_hi, -1
    s_add_u32 m0, s53, 53248
    s_mov_b32 exec_hi, 0
    buffer_load_dwordx4 v229, s[20:23], s42 offen lds
    s_mov_b32 exec_hi, -1
    s_add_u32 s49, s49, 1
    s_and_b32 s49, s49, 7
    s_lshl_b32 s40, s49, 7
    s_mul_i32 s42, s49, 176128
    s_mul_i32 s41, s49, 196608
    v_mfma_f32_32x32x16_bf16 v[132:147], v[56:59], v[48:51], v[132:147]
    v_subrev_u32 v24, 106496, v24
    v_subrev_u32 v25, 106496, v25
    v_subrev_u32 v26, 106496, v26
    v_subrev_u32 v27, 106496, v27
    v_subrev_u32 v28, 106496, v28
    v_subrev_u32 v29, 106496, v29
    v_subrev_u32 v30, 106496, v30
    v_mfma_f32_32x32x16_bf16 v[148:163], v[52:55], v[60:63], v[148:163]
    v_subrev_u32 v31, 106496, v31
    v_subrev_u32 v36, 106496, v36
    v_subrev_u32 v40, 106496, v40
    v_subrev_u32 v41, 106496, v41
    v_subrev_u32 v38, 106496, v38
    v_subrev_u32 v32, 106496, v32
    v_subrev_u32 v33, 106496, v33
    v_subrev_u32 v34, 106496, v34
    v_subrev_u32 v35, 106496, v35
    s_waitcnt vmcnt(8) lgkmcnt(0)
    s_barrier
    v_mfma_f32_32x32x16_bf16 v[84:99], v[72:75], v[64:67], v[84:99]
    ds_read_b128 v[44:47], v24 offset:0
    ds_read_b64_tr_b16 v[52:53], v36 offset:0
    ds_read_b64_tr_b16 v[54:55], v36 offset:768
    ds_read_b128 v[48:51], v28 offset:0
    v_mfma_f32_32x32x16_bf16 v[100:115], v[72:75], v[68:71], v[100:115]
    ds_read_b64_tr_b16 v[56:57], v38 offset:0
    ds_read_b64_tr_b16 v[58:59], v38 offset:768
    ds_read_b128 v[60:63], v32 offset:0
    v_mfma_f32_32x32x16_bf16 v[116:131], v[76:79], v[64:67], v[116:131]
    s_add_u32 m0, s50, 106496
    s_nop 0
    buffer_load_dwordx4 v16, s[8:11], s40 offen offset:0 lds
    v_mfma_f32_32x32x16_bf16 v[132:147], v[76:79], v[68:71], v[132:147]
    v_mfma_f32_32x32x16_bf16 v[148:163], v[72:75], v[80:83], v[148:163]
    buffer_load_dwordx4 v17, s[8:11], s40 offen offset:1024 lds
    s_waitcnt lgkmcnt(0)
    v_mfma_f32_32x32x16_bf16 v[84:99], v[52:55], v[44:47], v[84:99]
    ds_read_b128 v[64:67], v25 offset:0
    ds_read_b64_tr_b16 v[72:73], v36 offset:3072
    ds_read_b64_tr_b16 v[74:75], v36 offset:3840
    ds_read_b128 v[68:71], v29 offset:0
    v_mfma_f32_32x32x16_bf16 v[100:115], v[52:55], v[48:51], v[100:115]
    ds_read_b64_tr_b16 v[76:77], v38 offset:3072
    ds_read_b64_tr_b16 v[78:79], v38 offset:3840
    ds_read_b128 v[80:83], v33 offset:0
    v_mfma_f32_32x32x16_bf16 v[116:131], v[56:59], v[44:47], v[116:131]
    buffer_load_dwordx4 v18, s[8:11], s40 offen offset:2048 lds
    v_mfma_f32_32x32x16_bf16 v[132:147], v[56:59], v[48:51], v[132:147]
    buffer_load_dwordx4 v19, s[8:11], s40 offen offset:3072 lds
    v_mfma_f32_32x32x16_bf16 v[148:163], v[52:55], v[60:63], v[148:163]
    s_waitcnt lgkmcnt(0)
    v_mfma_f32_32x32x16_bf16 v[84:99], v[72:75], v[64:67], v[84:99]
    ds_read_b128 v[44:47], v26 offset:0
    ds_read_b64_tr_b16 v[52:53], v36 offset:6144
    ds_read_b64_tr_b16 v[54:55], v36 offset:6912
    ds_read_b128 v[48:51], v30 offset:0
    v_mfma_f32_32x32x16_bf16 v[100:115], v[72:75], v[68:71], v[100:115]
    ds_read_b64_tr_b16 v[56:57], v38 offset:6144
    ds_read_b64_tr_b16 v[58:59], v38 offset:6912
    ds_read_b128 v[60:63], v34 offset:0
    v_mfma_f32_32x32x16_bf16 v[116:131], v[76:79], v[64:67], v[116:131]
    s_add_u32 m0, s51, 106496
    s_nop 0
    buffer_load_dwordx4 v225, s[12:15], s41 offen lds
    v_mfma_f32_32x32x16_bf16 v[132:147], v[76:79], v[68:71], v[132:147]
    s_mov_b32 exec_hi, 0
    buffer_load_dwordx4 v227, s[12:15], s41 offen offset:1024 lds
    s_mov_b32 exec_hi, -1
    v_mfma_f32_32x32x16_bf16 v[148:163], v[72:75], v[80:83], v[148:163]
    s_waitcnt lgkmcnt(0)
    v_mfma_f32_32x32x16_bf16 v[84:99], v[52:55], v[44:47], v[84:99]
    ds_read_b128 v[64:67], v27 offset:0
    ds_read_b64_tr_b16 v[72:73], v36 offset:9216
    ds_read_b64_tr_b16 v[74:75], v36 offset:9984
    ds_read_b128 v[68:71], v31 offset:0
    v_mfma_f32_32x32x16_bf16 v[100:115], v[52:55], v[48:51], v[100:115]
    ds_read_b64_tr_b16 v[76:77], v38 offset:9216
    ds_read_b64_tr_b16 v[78:79], v38 offset:9984
    ds_read_b128 v[80:83], v35 offset:0
    v_mfma_f32_32x32x16_bf16 v[116:131], v[56:59], v[44:47], v[116:131]
    s_add_u32 m0, s52, 106496
    s_mov_b32 exec_hi, 0
    buffer_load_dwordx4 v20, s[8:11], s40 offen lds
    s_mov_b32 exec_hi, -1
    s_add_u32 m0, s53, 106496
    s_mov_b32 exec_hi, 0
    buffer_load_dwordx4 v229, s[20:23], s42 offen lds
    s_mov_b32 exec_hi, -1
    s_add_u32 s49, s49, 1
    s_and_b32 s49, s49, 7
    s_lshl_b32 s40, s49, 7
    s_mul_i32 s42, s49, 176128
    s_mul_i32 s41, s49, 196608
    v_mfma_f32_32x32x16_bf16 v[132:147], v[56:59], v[48:51], v[132:147]
    v_mfma_f32_32x32x16_bf16 v[148:163], v[52:55], v[60:63], v[148:163]
    s_waitcnt vmcnt(8) lgkmcnt(0)
    s_barrier
    v_mfma_f32_32x32x16_bf16 v[84:99], v[72:75], v[64:67], v[84:99]
    ds_read_b128 v[44:47], v24 offset:53248
    ds_read_b64_tr_b16 v[52:53], v36 offset:53248
    ds_read_b64_tr_b16 v[54:55], v36 offset:54016
    ds_read_b128 v[48:51], v28 offset:53248
    v_mfma_f32_32x32x16_bf16 v[100:115], v[72:75], v[68:71], v[100:115]
    ds_read_b64_tr_b16 v[56:57], v38 offset:53248
    ds_read_b64_tr_b16 v[58:59], v38 offset:54016
    ds_read_b128 v[60:63], v32 offset:53248
    v_mfma_f32_32x32x16_bf16 v[116:131], v[76:79], v[64:67], v[116:131]
    s_add_u32 m0, s50, 0
    s_nop 0
    buffer_load_dwordx4 v16, s[8:11], s40 offen offset:0 lds
    v_mfma_f32_32x32x16_bf16 v[132:147], v[76:79], v[68:71], v[132:147]
    v_mfma_f32_32x32x16_bf16 v[148:163], v[72:75], v[80:83], v[148:163]
    buffer_load_dwordx4 v17, s[8:11], s40 offen offset:1024 lds
    s_waitcnt lgkmcnt(0)
    v_mfma_f32_32x32x16_bf16 v[84:99], v[52:55], v[44:47], v[84:99]
    ds_read_b128 v[64:67], v25 offset:53248
    ds_read_b64_tr_b16 v[72:73], v36 offset:56320
    ds_read_b64_tr_b16 v[74:75], v36 offset:57088
    ds_read_b128 v[68:71], v29 offset:53248
    v_mfma_f32_32x32x16_bf16 v[100:115], v[52:55], v[48:51], v[100:115]
    ds_read_b64_tr_b16 v[76:77], v38 offset:56320
    ds_read_b64_tr_b16 v[78:79], v38 offset:57088
    ds_read_b128 v[80:83], v33 offset:53248
    v_mfma_f32_32x32x16_bf16 v[116:131], v[56:59], v[44:47], v[116:131]
    buffer_load_dwordx4 v18, s[8:11], s40 offen offset:2048 lds
    v_mfma_f32_32x32x16_bf16 v[132:147], v[56:59], v[48:51], v[132:147]
    buffer_load_dwordx4 v19, s[8:11], s40 offen offset:3072 lds
    v_mfma_f32_32x32x16_bf16 v[148:163], v[52:55], v[60:63], v[148:163]
    s_waitcnt lgkmcnt(0)
    v_mfma_f32_32x32x16_bf16 v[84:99], v[72:75], v[64:67], v[84:99]
    ds_read_b128 v[44:47], v26 offset:53248
    ds_read_b64_tr_b16 v[52:53], v36 offset:59392
    ds_read_b64_tr_b16 v[54:55], v36 offset:60160
    ds_read_b128 v[48:51], v30 offset:53248
    v_mfma_f32_32x32x16_bf16 v[100:115], v[72:75], v[68:71], v[100:115]
    ds_read_b64_tr_b16 v[56:57], v38 offset:59392
    ds_read_b64_tr_b16 v[58:59], v38 offset:60160
    ds_read_b128 v[60:63], v34 offset:53248
    v_mfma_f32_32x32x16_bf16 v[116:131], v[76:79], v[64:67], v[116:131]
    s_add_u32 m0, s51, 0
    s_nop 0
    buffer_load_dwordx4 v225, s[12:15], s41 offen lds
    v_mfma_f32_32x32x16_bf16 v[132:147], v[76:79], v[68:71], v[132:147]
    s_mov_b32 exec_hi, 0
    buffer_load_dwordx4 v227, s[12:15], s41 offen offset:1024 lds
    s_mov_b32 exec_hi, -1
    v_mfma_f32_32x32x16_bf16 v[148:163], v[72:75], v[80:83], v[148:163]
    s_waitcnt lgkmcnt(0)
    v_mfma_f32_32x32x16_bf16 v[84:99], v[52:55], v[44:47], v[84:99]
    ds_read_b128 v[64:67], v27 offset:53248
    ds_read_b64_tr_b16 v[72:73], v36 offset:62464
    ds_read_b64_tr_b16 v[74:75], v36 offset:63232
    ds_read_b128 v[68:71], v31 offset:53248
    v_mfma_f32_32x32x16_bf16 v[100:115], v[52:55], v[48:51], v[100:115]
    ds_read_b64_tr_b16 v[76:77], v38 offset:62464
    ds_read_b64_tr_b16 v[78:79], v38 offset:63232
    ds_read_b128 v[80:83], v35 offset:53248
    v_mfma_f32_32x32x16_bf16 v[116:131], v[56:59], v[44:47], v[116:131]
    s_add_u32 m0, s52, 0
    s_mov_b32 exec_hi, 0
    buffer_load_dwordx4 v20, s[8:11], s40 offen lds
    s_mov_b32 exec_hi, -1
    s_add_u32 m0, s53, 0
    s_mov_b32 exec_hi, 0
    buffer_load_dwordx4 v229, s[20:23], s42 offen lds
    s_mov_b32 exec_hi, -1
    s_add_u32 s49, s49, 1
    s_and_b32 s49, s49, 7
    s_lshl_b32 s40, s49, 7
    s_mul_i32 s42, s49, 176128
    s_mul_i32 s41, s49, 196608
    v_mfma_f32_32x32x16_bf16 v[132:147], v[56:59], v[48:51], v[132:147]
    s_cmp_lg_u32 s34, 5
    s_cbranch_scc1 K1_A1H_P1
    v_lshlrev_b32 v4, 2, v1
    global_load_dword v223, v4, s[76:77] sc1
K1_A1H_P1:
    v_add_u32 v24, 106496, v24
    v_add_u32 v25, 106496, v25
    v_add_u32 v26, 106496, v26
    v_add_u32 v27, 106496, v27
    v_add_u32 v28, 106496, v28
    v_mfma_f32_32x32x16_bf16 v[148:163], v[52:55], v[60:63], v[148:163]
    v_add_u32 v29, 106496, v29
    v_add_u32 v30, 106496, v30
    v_add_u32 v31, 106496, v31
    v_add_u32 v36, 106496, v36
    v_add_u32 v40, 106496, v40
    v_add_u32 v41, 106496, v41
    v_add_u32 v38, 106496, v38
    v_add_u32 v32, 106496, v32
    v_add_u32 v33, 106496, v33
    v_add_u32 v34, 106496, v34
    v_add_u32 v35, 106496, v35
    s_waitcnt vmcnt(8) lgkmcnt(0)
    s_barrier
    v_mfma_f32_32x32x16_bf16 v[84:99], v[72:75], v[64:67], v[84:99]
    ds_read_b128 v[44:47], v24 offset:0
    ds_read_b64_tr_b16 v[52:53], v36 offset:0
    ds_read_b64_tr_b16 v[54:55], v36 offset:768
    ds_read_b128 v[48:51], v28 offset:0
    v_mfma_f32_32x32x16_bf16 v[100:115], v[72:75], v[68:71], v[100:115]
    ds_read_b64_tr_b16 v[56:57], v38 offset:0
    ds_read_b64_tr_b16 v[58:59], v38 offset:768
    ds_read_b128 v[60:63], v32 offset:0
    v_mfma_f32_32x32x16_bf16 v[116:131], v[76:79], v[64:67], v[116:131]
    s_add_u32 m0, s50, 53248
    s_nop 0
    buffer_load_dwordx4 v16, s[8:11], s40 offen offset:0 lds
    v_mfma_f32_32x32x16_bf16 v[132:147], v[76:79], v[68:71], v[132:147]
    v_mfma_f32_32x32x16_bf16 v[148:163], v[72:75], v[80:83], v[148:163]
    buffer_load_dwordx4 v17, s[8:11], s40 offen offset:1024 lds
    s_waitcnt lgkmcnt(0)
    v_mfma_f32_32x32x16_bf16 v[84:99], v[52:55], v[44:47], v[84:99]
    ds_read_b128 v[64:67], v25 offset:0
    ds_read_b64_tr_b16 v[72:73], v36 offset:3072
    ds_read_b64_tr_b16 v[74:75], v36 offset:3840
    ds_read_b128 v[68:71], v29 offset:0
    v_mfma_f32_32x32x16_bf16 v[100:115], v[52:55], v[48:51], v[100:115]
    ds_read_b64_tr_b16 v[76:77], v38 offset:3072
    ds_read_b64_tr_b16 v[78:79], v38 offset:3840
    ds_read_b128 v[80:83], v33 offset:0
    v_mfma_f32_32x32x16_bf16 v[116:131], v[56:59], v[44:47], v[116:131]
    buffer_load_dwordx4 v18, s[8:11], s40 offen offset:2048 lds
    v_mfma_f32_32x32x16_bf16 v[132:147], v[56:59], v[48:51], v[132:147]
    buffer_load_dwordx4 v19, s[8:11], s40 offen offset:3072 lds
    v_mfma_f32_32x32x16_bf16 v[148:163], v[52:55], v[60:63], v[148:163]
    s_waitcnt lgkmcnt(0)
    v_mfma_f32_32x32x16_bf16 v[84:99], v[72:75], v[64:67], v[84:99]
    ds_read_b128 v[44:47], v26 offset:0
    ds_read_b64_tr_b16 v[52:53], v36 offset:6144
    ds_read_b64_tr_b16 v[54:55], v36 offset:6912
    ds_read_b128 v[48:51], v30 offset:0
    v_mfma_f32_32x32x16_bf16 v[100:115], v[72:75], v[68:71], v[100:115]
    ds_read_b64_tr_b16 v[56:57], v38 offset:6144
    ds_read_b64_tr_b16 v[58:59], v38 offset:6912
    ds_read_b128 v[60:63], v34 offset:0
    v_mfma_f32_32x32x16_bf16 v[116:131], v[76:79], v[64:67], v[116:131]
    s_add_u32 m0, s51, 53248
    s_nop 0
    buffer_load_dwordx4 v225, s[12:15], s41 offen lds
    v_mfma_f32_32x32x16_bf16 v[132:147], v[76:79], v[68:71], v[132:147]
    s_mov_b32 exec_hi, 0
    buffer_load_dwordx4 v227, s[12:15], s41 offen offset:1024 lds
    s_mov_b32 exec_hi, -1
    v_mfma_f32_32x32x16_bf16 v[148:163], v[72:75], v[80:83], v[148:163]
    s_waitcnt lgkmcnt(0)
    v_mfma_f32_32x32x16_bf16 v[84:99], v[52:55], v[44:47], v[84:99]
    ds_read_b128 v[64:67], v27 offset:0
    ds_read_b64_tr_b16 v[72:73], v36 offset:9216
    ds_read_b64_tr_b16 v[74:75], v36 offset:9984
    ds_read_b128 v[68:71], v31 offset:0
    v_mfma_f32_32x32x16_bf16 v[100:115], v[52:55], v[48:51], v[100:115]
    ds_read_b64_tr_b16 v[76:77], v38 offset:9216
    ds_read_b64_tr_b16 v[78:79], v38 offset:9984
    ds_read_b128 v[80:83], v35 offset:0
    v_mfma_f32_32x32x16_bf16 v[116:131], v[56:59], v[44:47], v[116:131]
    s_add_u32 m0, s52, 53248
    s_mov_b32 exec_hi, 0
    buffer_load_dwordx4 v20, s[8:11], s40 offen lds
    s_mov_b32 exec_hi, -1
    s_add_u32 m0, s53, 53248
    s_mov_b32 exec_hi, 0
    buffer_load_dwordx4 v229, s[20:23], s42 offen lds
    s_mov_b32 exec_hi, -1
    s_cmp_lg_u32 s34, 5
    s_cbranch_scc1 K1_A1H_P2
    s_waitcnt vmcnt(8)
    v_and_b32 v11, v223, v221
    v_cmp_ne_u32 vcc, v11, v221
    v_mov_b32 v4, 162816
    v_mov_b32 v5, 0
    s_nop 2
    s_cbranch_vccnz K1_A1H_SLOW
K1_A1H_RDY:
    ds_write_b32 v4, v5
K1_A1H_P2:
    v_mfma_f32_32x32x16_bf16 v[132:147], v[56:59], v[48:51], v[132:147]
    v_subrev_u32 v24, 106496, v24
    v_subrev_u32 v25, 106496, v25
    v_subrev_u32 v26, 106496, v26
    v_subrev_u32 v27, 106496, v27
    v_mfma_f32_32x32x16_bf16 v[148:163], v[52:55], v[60:63], v[148:163]
    v_subrev_u32 v28, 106496, v28
    v_subrev_u32 v29, 106496, v29
    v_subrev_u32 v30, 106496, v30
    v_subrev_u32 v31, 106496, v31
    v_subrev_u32 v36, 106496, v36
    v_subrev_u32 v40, 106496, v40
    v_subrev_u32 v41, 106496, v41
    v_subrev_u32 v38, 106496, v38
    v_subrev_u32 v32, 106496, v32
    v_subrev_u32 v33, 106496, v33
    v_subrev_u32 v34, 106496, v34
    v_subrev_u32 v35, 106496, v35
    s_waitcnt vmcnt(8) lgkmcnt(0)
    s_barrier
    v_mfma_f32_32x32x16_bf16 v[84:99], v[72:75], v[64:67], v[84:99]
    ds_read_b128 v[44:47], v24 offset:0
    ds_read_b64_tr_b16 v[52:53], v36 offset:0
    ds_read_b64_tr_b16 v[54:55], v36 offset:768
    ds_read_b128 v[48:51], v28 offset:0
    v_mfma_f32_32x32x16_bf16 v[100:115], v[72:75], v[68:71], v[100:115]
    ds_read_b64_tr_b16 v[56:57], v38 offset:0
    ds_read_b64_tr_b16 v[58:59], v38 offset:768
    ds_read_b128 v[60:63], v32 offset:0
    v_mfma_f32_32x32x16_bf16 v[116:131], v[76:79], v[64:67], v[116:131]
    v_mov_b32 v11, 162816
    ds_read_b32 v11, v11
    s_mul_i32 s46, s48, 5120
    s_add_u32 s46, s46, 8388608
    s_lshl_b32 s47, s37, 8
    s_add_u32 s47, s47, s46
    v_lshl_add_u32 v4, v1, 2, s47
    v_add_u32 v6, 2560, v4
    v_mfma_f32_32x32x16_bf16 v[132:147], v[76:79], v[68:71], v[132:147]
    s_lshl_b32 s46, s35, 8
    s_lshl_b32 s47, s38, 6
    s_add_u32 s46, s46, s47
    s_lshl_b32 s47, s37, 5
    s_add_u32 s46, s46, s47
    v_add_u32 v8, s46, v2
    v_lshlrev_b32 v8, 3, v8
    v_add_u32 v8, 9437184, v8
    v_mfma_f32_32x32x16_bf16 v[148:163], v[72:75], v[80:83], v[148:163]
    v_xor_b32 v9, 256, v8
    s_lshl_b32 s46, s35, 8
    s_sub_u32 s46, s46, 32
    s_cmp_eq_u32 s35, 0
    s_cselect_b32 s46, 0, s46
    v_add_u32 v10, s46, v2
    v_lshlrev_b32 v10, 3, v10
    v_add_u32 v10, 9437184, v10
    s_waitcnt lgkmcnt(0)
    v_mfma_f32_32x32x16_bf16 v[84:99], v[52:55], v[44:47], v[84:99]
    ds_read_b128 v[64:67], v25 offset:0
    ds_read_b64_tr_b16 v[72:73], v36 offset:3072
    ds_read_b64_tr_b16 v[74:75], v36 offset:3840
    ds_read_b128 v[68:71], v29 offset:0
    v_mfma_f32_32x32x16_bf16 v[100:115], v[52:55], v[48:51], v[100:115]
    ds_read_b64_tr_b16 v[76:77], v38 offset:3072
    ds_read_b64_tr_b16 v[78:79], v38 offset:3840
    ds_read_b128 v[80:83], v33 offset:0
    v_mfma_f32_32x32x16_bf16 v[116:131], v[56:59], v[44:47], v[116:131]
    v_readfirstlane_b32 s46, v11
    s_nop 3
    s_cmp_lg_u32 s46, 0
    s_cbranch_scc1 K1_A1H_FB
    global_load_dword v232, v4, s[32:33] offset:0 sc1
    global_load_dword v233, v4, s[32:33] offset:640 sc1
    global_load_dword v234, v4, s[32:33] offset:1280 sc1
    global_load_dword v235, v4, s[32:33] offset:1920 sc1
    global_load_dword v236, v6, s[32:33] offset:0 sc1
    global_load_dword v237, v6, s[32:33] offset:640 sc1
    global_load_dword v238, v6, s[32:33] offset:1280 sc1
    global_load_dword v239, v6, s[32:33] offset:1920 sc1
    global_load_dwordx2 v[248:249], v8, s[32:33] sc1
    global_load_dwordx2 v[250:251], v9, s[32:33] sc1
    global_load_dwordx2 v[252:253], v10, s[32:33] sc1
K1_A1H_HB:
    v_mfma_f32_32x32x16_bf16 v[132:147], v[56:59], v[48:51], v[132:147]
    v_mfma_f32_32x32x16_bf16 v[148:163], v[52:55], v[60:63], v[148:163]
    s_waitcnt lgkmcnt(0)
    v_mfma_f32_32x32x16_bf16 v[84:99], v[72:75], v[64:67], v[84:99]
    ds_read_b128 v[44:47], v26 offset:0
    ds_read_b64_tr_b16 v[52:53], v36 offset:6144
    ds_read_b64_tr_b16 v[54:55], v36 offset:6912
    ds_read_b128 v[48:51], v30 offset:0
    v_mfma_f32_32x32x16_bf16 v[100:115], v[72:75], v[68:71], v[100:115]
    ds_read_b64_tr_b16 v[56:57], v38 offset:6144
    ds_read_b64_tr_b16 v[58:59], v38 offset:6912
    ds_read_b128 v[60:63], v34 offset:0
    v_mfma_f32_32x32x16_bf16 v[116:131], v[76:79], v[64:67], v[116:131]
    v_mfma_f32_32x32x16_bf16 v[132:147], v[76:79], v[68:71], v[132:147]
    v_mfma_f32_32x32x16_bf16 v[148:163], v[72:75], v[80:83], v[148:163]
    s_waitcnt lgkmcnt(0)
    v_mfma_f32_32x32x16_bf16 v[84:99], v[52:55], v[44:47], v[84:99]
    ds_read_b128 v[64:67], v27 offset:0
    ds_read_b64_tr_b16 v[72:73], v36 offset:9216
    ds_read_b64_tr_b16 v[74:75], v36 offset:9984
    ds_read_b128 v[68:71], v31 offset:0
    v_mfma_f32_32x32x16_bf16 v[100:115], v[52:55], v[48:51], v[100:115]
    ds_read_b64_tr_b16 v[76:77], v38 offset:9216
    ds_read_b64_tr_b16 v[78:79], v38 offset:9984
    ds_read_b128 v[80:83], v35 offset:0
    v_mfma_f32_32x32x16_bf16 v[116:131], v[56:59], v[44:47], v[116:131]
    v_mfma_f32_32x32x16_bf16 v[132:147], v[56:59], v[48:51], v[132:147]
    v_mfma_f32_32x32x16_bf16 v[148:163], v[52:55], v[60:63], v[148:163]
    s_waitcnt vmcnt(11) lgkmcnt(0)
    s_barrier
    v_mfma_f32_32x32x16_bf16 v[84:99], v[72:75], v[64:67], v[84:99]
    ds_read_b128 v[44:47], v24 offset:53248
    ds_read_b64_tr_b16 v[52:53], v36 offset:53248
    ds_read_b64_tr_b16 v[54:55], v36 offset:54016
    ds_read_b128 v[48:51], v28 offset:53248
    v_mfma_f32_32x32x16_bf16 v[100:115], v[72:75], v[68:71], v[100:115]
    ds_read_b64_tr_b16 v[56:57], v38 offset:53248
    ds_read_b64_tr_b16 v[58:59], v38 offset:54016
    ds_read_b128 v[60:63], v32 offset:53248
    v_mfma_f32_32x32x16_bf16 v[116:131], v[76:79], v[64:67], v[116:131]
    s_cmp_lt_u32 s34, 4
    s_cbranch_scc1 K1_A1H_PR
    s_setprio 1
K1_A1H_PR:
    v_mfma_f32_32x32x16_bf16 v[132:147], v[76:79], v[68:71], v[132:147]
    v_mfma_f32_32x32x16_bf16 v[148:163], v[72:75], v[80:83], v[148:163]
    s_waitcnt lgkmcnt(0)
    v_mfma_f32_32x32x16_bf16 v[84:99], v[52:55], v[44:47], v[84:99]
    ds_read_b128 v[64:67], v25 offset:53248
    ds_read_b64_tr_b16 v[72:73], v36 offset:56320
    ds_read_b64_tr_b16 v[74:75], v36 offset:57088
    ds_read_b128 v[68:71], v29 offset:53248
    v_mfma_f32_32x32x16_bf16 v[100:115], v[52:55], v[48:51], v[100:115]
    ds_read_b64_tr_b16 v[76:77], v38 offset:56320
    ds_read_b64_tr_b16 v[78:79], v38 offset:57088
    ds_read_b128 v[80:83], v33 offset:53248
    v_mfma_f32_32x32x16_bf16 v[116:131], v[56:59], v[44:47], v[116:131]
    s_waitcnt vmcnt(0)
    v_add_f32 v232, v232, v233
    v_add_f32 v234, v234, v235
    v_add_f32 v236, v236, v237
    v_mfma_f32_32x32x16_bf16 v[132:147], v[56:59], v[48:51], v[132:147]
    v_add_f32 v238, v238, v239
    v_add_f32 v232, v232, v234
    v_add_f32 v236, v236, v238
    v_add_f32 v232, v232, v236
    v_mfma_f32_32x32x16_bf16 v[148:163], v[52:55], v[60:63], v[148:163]
    s_lshl_b32 s47, s34, 9
    v_lshl_add_u32 v8, v1, 2, s47
    v_lshl_add_u32 v9, v3, 4, s47
    ds_write_b32 v8, v232
    s_waitcnt lgkmcnt(0)
    v_mfma_f32_32x32x16_bf16 v[84:99], v[72:75], v[64:67], v[84:99]
    ds_read_b128 v[44:47], v26 offset:53248
    ds_read_b64_tr_b16 v[52:53], v36 offset:59392
    ds_read_b64_tr_b16 v[54:55], v36 offset:60160
    ds_read_b128 v[48:51], v30 offset:53248
    v_mfma_f32_32x32x16_bf16 v[100:115], v[72:75], v[68:71], v[100:115]
    ds_read_b64_tr_b16 v[56:57], v38 offset:59392
    ds_read_b64_tr_b16 v[58:59], v38 offset:60160
    ds_read_b128 v[60:63], v34 offset:53248
    v_mfma_f32_32x32x16_bf16 v[116:131], v[76:79], v[64:67], v[116:131]
    ds_read_b128 v[164:167], v9 offset:0
    ds_read_b128 v[168:171], v9 offset:32
    ds_read_b128 v[172:175], v9 offset:64
    v_mfma_f32_32x32x16_bf16 v[132:147], v[76:79], v[68:71], v[132:147]
    ds_read_b128 v[176:179], v9 offset:96
    ds_read_b128 v[180:183], v9 offset:128
    ds_read_b128 v[184:187], v9 offset:160
    v_mfma_f32_32x32x16_bf16 v[148:163], v[72:75], v[80:83], v[148:163]
    ds_read_b128 v[188:191], v9 offset:192
    ds_read_b128 v[192:195], v9 offset:224
    s_waitcnt lgkmcnt(0)
    v_mfma_f32_32x32x16_bf16 v[84:99], v[52:55], v[44:47], v[84:99]
    ds_read_b128 v[64:67], v27 offset:53248
    ds_read_b64_tr_b16 v[72:73], v36 offset:62464
    ds_read_b64_tr_b16 v[74:75], v36 offset:63232
    ds_read_b128 v[68:71], v31 offset:53248
    v_mfma_f32_32x32x16_bf16 v[100:115], v[52:55], v[48:51], v[100:115]
    ds_read_b64_tr_b16 v[76:77], v38 offset:62464
    ds_read_b64_tr_b16 v[78:79], v38 offset:63232
    ds_read_b128 v[80:83], v35 offset:53248
    v_mfma_f32_32x32x16_bf16 v[116:131], v[56:59], v[44:47], v[116:131]
    s_mov_b32 s47, 0x3b000000
    v_mul_f32 v212, 0xbb000000, v248
    v_mul_f32 v12, v212, v212
    v_fma_f32 v12, v249, s47, -v12
    v_max_f32 v12, 0, v12
    v_add_f32 v213, 0x3727c5ac, v12
    v_rsq_f32 v218, v213
    s_nop 0
    v_mul_f32 v224, 0xbfb8aa3b, v218
    v_mfma_f32_32x32x16_bf16 v[132:147], v[56:59], v[48:51], v[132:147]
    v_mul_f32 v214, 0xbb000000, v250
    v_mul_f32 v12, v214, v214
    v_fma_f32 v12, v251, s47, -v12
    v_max_f32 v12, 0, v12
    v_add_f32 v215, 0x3727c5ac, v12
    v_rsq_f32 v220, v215
    s_nop 0
    v_mul_f32 v226, 0xbfb8aa3b, v220
    v_mfma_f32_32x32x16_bf16 v[148:163], v[52:55], v[60:63], v[148:163]
    v_mul_f32 v216, 0xbb000000, v252
    v_mul_f32 v12, v216, v216
    v_fma_f32 v12, v253, s47, -v12
    v_max_f32 v12, 0, v12
    v_add_f32 v217, 0x3727c5ac, v12
    v_rsq_f32 v222, v217
    s_nop 0
    v_mul_f32 v228, 0xbfb8aa3b, v222
    s_waitcnt lgkmcnt(0)
    v_mfma_f32_32x32x16_bf16 v[84:99], v[72:75], v[64:67], v[84:99]
    v_mfma_f32_32x32x16_bf16 v[100:115], v[72:75], v[68:71], v[100:115]
    v_mfma_f32_32x32x16_bf16 v[116:131], v[76:79], v[64:67], v[116:131]
    v_mfma_f32_32x32x16_bf16 v[132:147], v[76:79], v[68:71], v[132:147]
    v_mfma_f32_32x32x16_bf16 v[148:163], v[72:75], v[80:83], v[148:163]
    s_nop 7
    v_mul_u32_u24 v4, 4608, v3
    v_lshl_add_u32 v4, v2, 4, v4
    v_add_u32 v4, 106496, v4
    s_lshl_b32 s46, s38, 10
    s_lshl_b32 s47, s37, 9
    s_add_u32 s46, s46, s47
    s_xor_b32 s47, s46, 512
    v_add_u32 v5, s46, v4
    v_add_u32 v6, s47, v4
    v_mul_u32_u24 v10, 4608, v3
    v_subrev_u32 v10, 102400, v10
    v_add_u32 v7, v10, v4
    v_add_u32 v8, v10, v5
    v_add_u32 v9, v10, v6
    s_cmp_eq_u32 s34, 3
    s_cbranch_scc1 K1_A1H_V
    v_pk_fma_f32 v[148:149], v[216:217], v[164:165], v[148:149] op_sel:[0,0,0] op_sel_hi:[0,1,1]
    v_pk_fma_f32 v[150:151], v[216:217], v[166:167], v[150:151] op_sel:[0,0,0] op_sel_hi:[0,1,1]
    v_pk_fma_f32 v[152:153], v[216:217], v[168:169], v[152:153] op_sel:[0,0,0] op_sel_hi:[0,1,1]
    v_pk_fma_f32 v[154:155], v[216:217], v[170:171], v[154:155] op_sel:[0,0,0] op_sel_hi:[0,1,1]
    v_pk_fma_f32 v[156:157], v[216:217], v[172:173], v[156:157] op_sel:[0,0,0] op_sel_hi:[0,1,1]
    v_pk_fma_f32 v[158:159], v[216:217], v[174:175], v[158:159] op_sel:[0,0,0] op_sel_hi:[0,1,1]
    v_pk_fma_f32 v[160:161], v[216:217], v[176:177], v[160:161] op_sel:[0,0,0] op_sel_hi:[0,1,1]
    v_pk_fma_f32 v[162:163], v[216:217], v[178:179], v[162:163] op_sel:[0,0,0] op_sel_hi:[0,1,1]
    v_pk_mul_f32 v[148:149], v[222:223], v[148:149] op_sel:[0,0] op_sel_hi:[0,1]
    v_pk_mul_f32 v[150:151], v[222:223], v[150:151] op_sel:[0,0] op_sel_hi:[0,1]
    v_pk_mul_f32 v[152:153], v[222:223], v[152:153] op_sel:[0,0] op_sel_hi:[0,1]
    v_pk_mul_f32 v[154:155], v[222:223], v[154:155] op_sel:[0,0] op_sel_hi:[0,1]
    v_pk_mul_f32 v[156:157], v[222:223], v[156:157] op_sel:[0,0] op_sel_hi:[0,1]
    v_pk_mul_f32 v[158:159], v[222:223], v[158:159] op_sel:[0,0] op_sel_hi:[0,1]
    v_pk_mul_f32 v[160:161], v[222:223], v[160:161] op_sel:[0,0] op_sel_hi:[0,1]
    v_pk_mul_f32 v[162:163], v[222:223], v[162:163] op_sel:[0,0] op_sel_hi:[0,1]
    v_cvt_pk_bf16_f32 v148, v148, v149
    v_cvt_pk_bf16_f32 v149, v150, v151
    v_cvt_pk_bf16_f32 v150, v152, v153
    v_cvt_pk_bf16_f32 v151, v154, v155
    v_cvt_pk_bf16_f32 v152, v156, v157
    v_cvt_pk_bf16_f32 v153, v158, v159
    v_cvt_pk_bf16_f32 v154, v160, v161
    v_cvt_pk_bf16_f32 v155, v162, v163
    ds_write_b128 v4, v[148:151] offset:18432
    ds_write_b128 v4, v[152:155] offset:27648
    v_pk_fma_f32 v[84:85], v[212:213], v[164:165], v[84:85] op_sel:[0,0,0] op_sel_hi:[0,1,1]
    v_pk_fma_f32 v[86:87], v[212:213], v[166:167], v[86:87] op_sel:[0,0,0] op_sel_hi:[0,1,1]
    v_pk_fma_f32 v[88:89], v[212:213], v[168:169], v[88:89] op_sel:[0,0,0] op_sel_hi:[0,1,1]
    v_pk_fma_f32 v[90:91], v[212:213], v[170:171], v[90:91] op_sel:[0,0,0] op_sel_hi:[0,1,1]
    v_pk_fma_f32 v[92:93], v[212:213], v[172:173], v[92:93] op_sel:[0,0,0] op_sel_hi:[0,1,1]
    v_pk_fma_f32 v[94:95], v[212:213], v[174:175], v[94:95] op_sel:[0,0,0] op_sel_hi:[0,1,1]
    v_pk_fma_f32 v[96:97], v[212:213], v[176:177], v[96:97] op_sel:[0,0,0] op_sel_hi:[0,1,1]
    v_pk_fma_f32 v[98:99], v[212:213], v[178:179], v[98:99] op_sel:[0,0,0] op_sel_hi:[0,1,1]
    v_pk_mul_f32 v[84:85], v[218:219], v[84:85] op_sel:[0,0] op_sel_hi:[0,1]
    v_pk_mul_f32 v[86:87], v[218:219], v[86:87] op_sel:[0,0] op_sel_hi:[0,1]
    v_pk_mul_f32 v[88:89], v[218:219], v[88:89] op_sel:[0,0] op_sel_hi:[0,1]
    v_pk_mul_f32 v[90:91], v[218:219], v[90:91] op_sel:[0,0] op_sel_hi:[0,1]
    v_pk_mul_f32 v[92:93], v[218:219], v[92:93] op_sel:[0,0] op_sel_hi:[0,1]
    v_pk_mul_f32 v[94:95], v[218:219], v[94:95] op_sel:[0,0] op_sel_hi:[0,1]
    v_pk_mul_f32 v[96:97], v[218:219], v[96:97] op_sel:[0,0] op_sel_hi:[0,1]
    v_pk_mul_f32 v[98:99], v[218:219], v[98:99] op_sel:[0,0] op_sel_hi:[0,1]
    v_cvt_pk_bf16_f32 v84, v84, v85
    v_cvt_pk_bf16_f32 v85, v86, v87
    v_cvt_pk_bf16_f32 v86, v88, v89
    v_cvt_pk_bf16_f32 v87, v90, v91
    v_cvt_pk_bf16_f32 v88, v92, v93
    v_cvt_pk_bf16_f32 v89, v94, v95
    v_cvt_pk_bf16_f32 v90, v96, v97
    v_cvt_pk_bf16_f32 v91, v98, v99
    ds_write_b128 v5, v[84:87] offset:18944
    ds_write_b128 v5, v[88:91] offset:28160
    v_pk_fma_f32 v[100:101], v[214:215], v[164:165], v[100:101] op_sel:[0,0,0] op_sel_hi:[0,1,1]
    v_pk_fma_f32 v[102:103], v[214:215], v[166:167], v[102:103] op_sel:[0,0,0] op_sel_hi:[0,1,1]
    v_pk_fma_f32 v[104:105], v[214:215], v[168:169], v[104:105] op_sel:[0,0,0] op_sel_hi:[0,1,1]
    v_pk_fma_f32 v[106:107], v[214:215], v[170:171], v[106:107] op_sel:[0,0,0] op_sel_hi:[0,1,1]
    v_pk_fma_f32 v[108:109], v[214:215], v[172:173], v[108:109] op_sel:[0,0,0] op_sel_hi:[0,1,1]
    v_pk_fma_f32 v[110:111], v[214:215], v[174:175], v[110:111] op_sel:[0,0,0] op_sel_hi:[0,1,1]
    v_pk_fma_f32 v[112:113], v[214:215], v[176:177], v[112:113] op_sel:[0,0,0] op_sel_hi:[0,1,1]
    v_pk_fma_f32 v[114:115], v[214:215], v[178:179], v[114:115] op_sel:[0,0,0] op_sel_hi:[0,1,1]
    v_pk_mul_f32 v[100:101], v[220:221], v[100:101] op_sel:[0,0] op_sel_hi:[0,1]
    v_pk_mul_f32 v[102:103], v[220:221], v[102:103] op_sel:[0,0] op_sel_hi:[0,1]
    v_pk_mul_f32 v[104:105], v[220:221], v[104:105] op_sel:[0,0] op_sel_hi:[0,1]
    v_pk_mul_f32 v[106:107], v[220:221], v[106:107] op_sel:[0,0] op_sel_hi:[0,1]
    v_pk_mul_f32 v[108:109], v[220:221], v[108:109] op_sel:[0,0] op_sel_hi:[0,1]
    v_pk_mul_f32 v[110:111], v[220:221], v[110:111] op_sel:[0,0] op_sel_hi:[0,1]
    v_pk_mul_f32 v[112:113], v[220:221], v[112:113] op_sel:[0,0] op_sel_hi:[0,1]
    v_pk_mul_f32 v[114:115], v[220:221], v[114:115] op_sel:[0,0] op_sel_hi:[0,1]
    v_cvt_pk_bf16_f32 v100, v100, v101
    v_cvt_pk_bf16_f32 v101, v102, v103
    v_cvt_pk_bf16_f32 v102, v104, v105
    v_cvt_pk_bf16_f32 v103, v106, v107
    v_cvt_pk_bf16_f32 v104, v108, v109
    v_cvt_pk_bf16_f32 v105, v110, v111
    v_cvt_pk_bf16_f32 v106, v112, v113
    v_cvt_pk_bf16_f32 v107, v114, v115
    ds_write_b128 v6, v[100:103] offset:18944
    ds_write_b128 v6, v[104:107] offset:28160
    v_pk_fma_f32 v[116:117], v[212:213], v[180:181], v[116:117] op_sel:[0,0,0] op_sel_hi:[0,1,1]
    v_pk_fma_f32 v[118:119], v[212:213], v[182:183], v[118:119] op_sel:[0,0,0] op_sel_hi:[0,1,1]
    v_pk_fma_f32 v[120:121], v[212:213], v[184:185], v[120:121] op_sel:[0,0,0] op_sel_hi:[0,1,1]
    v_pk_fma_f32 v[122:123], v[212:213], v[186:187], v[122:123] op_sel:[0,0,0] op_sel_hi:[0,1,1]
    v_pk_fma_f32 v[124:125], v[212:213], v[188:189], v[124:125] op_sel:[0,0,0] op_sel_hi:[0,1,1]
    v_pk_fma_f32 v[126:127], v[212:213], v[190:191], v[126:127] op_sel:[0,0,0] op_sel_hi:[0,1,1]
    v_pk_fma_f32 v[128:129], v[212:213], v[192:193], v[128:129] op_sel:[0,0,0] op_sel_hi:[0,1,1]
    v_pk_fma_f32 v[130:131], v[212:213], v[194:195], v[130:131] op_sel:[0,0,0] op_sel_hi:[0,1,1]
    v_pk_mul_f32 v[116:117], v[218:219], v[116:117] op_sel:[0,0] op_sel_hi:[0,1]
    v_pk_mul_f32 v[118:119], v[218:219], v[118:119] op_sel:[0,0] op_sel_hi:[0,1]
    v_pk_mul_f32 v[120:121], v[218:219], v[120:121] op_sel:[0,0] op_sel_hi:[0,1]
    v_pk_mul_f32 v[122:123], v[218:219], v[122:123] op_sel:[0,0] op_sel_hi:[0,1]
    v_pk_mul_f32 v[124:125], v[218:219], v[124:125] op_sel:[0,0] op_sel_hi:[0,1]
    v_pk_mul_f32 v[126:127], v[218:219], v[126:127] op_sel:[0,0] op_sel_hi:[0,1]
    v_pk_mul_f32 v[128:129], v[218:219], v[128:129] op_sel:[0,0] op_sel_hi:[0,1]
    v_pk_mul_f32 v[130:131], v[218:219], v[130:131] op_sel:[0,0] op_sel_hi:[0,1]
    ds_write_b128 v8, v[116:119] offset:512
    ds_write_b128 v8, v[120:123] offset:5120
    ds_write_b128 v8, v[124:127] offset:18944
    ds_write_b128 v8, v[128:131] offset:23552
    v_pk_fma_f32 v[132:133], v[214:215], v[180:181], v[132:133] op_sel:[0,0,0] op_sel_hi:[0,1,1]
    v_pk_fma_f32 v[134:135], v[214:215], v[182:183], v[134:135] op_sel:[0,0,0] op_sel_hi:[0,1,1]
    v_pk_fma_f32 v[136:137], v[214:215], v[184:185], v[136:137] op_sel:[0,0,0] op_sel_hi:[0,1,1]
    v_pk_fma_f32 v[138:139], v[214:215], v[186:187], v[138:139] op_sel:[0,0,0] op_sel_hi:[0,1,1]
    v_pk_fma_f32 v[140:141], v[214:215], v[188:189], v[140:141] op_sel:[0,0,0] op_sel_hi:[0,1,1]
    v_pk_fma_f32 v[142:143], v[214:215], v[190:191], v[142:143] op_sel:[0,0,0] op_sel_hi:[0,1,1]
    v_pk_fma_f32 v[144:145], v[214:215], v[192:193], v[144:145] op_sel:[0,0,0] op_sel_hi:[0,1,1]
    v_pk_fma_f32 v[146:147], v[214:215], v[194:195], v[146:147] op_sel:[0,0,0] op_sel_hi:[0,1,1]
    v_pk_mul_f32 v[132:133], v[220:221], v[132:133] op_sel:[0,0] op_sel_hi:[0,1]
    v_pk_mul_f32 v[134:135], v[220:221], v[134:135] op_sel:[0,0] op_sel_hi:[0,1]
    v_pk_mul_f32 v[136:137], v[220:221], v[136:137] op_sel:[0,0] op_sel_hi:[0,1]
    v_pk_mul_f32 v[138:139], v[220:221], v[138:139] op_sel:[0,0] op_sel_hi:[0,1]
    v_pk_mul_f32 v[140:141], v[220:221], v[140:141] op_sel:[0,0] op_sel_hi:[0,1]
    v_pk_mul_f32 v[142:143], v[220:221], v[142:143] op_sel:[0,0] op_sel_hi:[0,1]
    v_pk_mul_f32 v[144:145], v[220:221], v[144:145] op_sel:[0,0] op_sel_hi:[0,1]
    v_pk_mul_f32 v[146:147], v[220:221], v[146:147] op_sel:[0,0] op_sel_hi:[0,1]
    ds_write_b128 v9, v[132:135] offset:512
    ds_write_b128 v9, v[136:139] offset:5120
    ds_write_b128 v9, v[140:143] offset:18944
    ds_write_b128 v9, v[144:147] offset:23552
    s_branch K1_ATTN
K1_A1H_V:
    v_pk_fma_f32 v[148:149], v[216:217], v[180:181], v[148:149] op_sel:[0,0,0] op_sel_hi:[0,1,1]
    v_pk_fma_f32 v[150:151], v[216:217], v[182:183], v[150:151] op_sel:[0,0,0] op_sel_hi:[0,1,1]
    v_pk_fma_f32 v[152:153], v[216:217], v[184:185], v[152:153] op_sel:[0,0,0] op_sel_hi:[0,1,1]
    v_pk_fma_f32 v[154:155], v[216:217], v[186:187], v[154:155] op_sel:[0,0,0] op_sel_hi:[0,1,1]
    v_pk_fma_f32 v[156:157], v[216:217], v[188:189], v[156:157] op_sel:[0,0,0] op_sel_hi:[0,1,1]
    v_pk_fma_f32 v[158:159], v[216:217], v[190:191], v[158:159] op_sel:[0,0,0] op_sel_hi:[0,1,1]
    v_pk_fma_f32 v[160:161], v[216:217], v[192:193], v[160:161] op_sel:[0,0,0] op_sel_hi:[0,1,1]
    v_pk_fma_f32 v[162:163], v[216:217], v[194:195], v[162:163] op_sel:[0,0,0] op_sel_hi:[0,1,1]
    v_pk_mul_f32 v[148:149], v[222:223], v[148:149] op_sel:[0,0] op_sel_hi:[0,1]
    v_pk_mul_f32 v[150:151], v[222:223], v[150:151] op_sel:[0,0] op_sel_hi:[0,1]
    v_pk_mul_f32 v[152:153], v[222:223], v[152:153] op_sel:[0,0] op_sel_hi:[0,1]
    v_pk_mul_f32 v[154:155], v[222:223], v[154:155] op_sel:[0,0] op_sel_hi:[0,1]
    v_pk_mul_f32 v[156:157], v[222:223], v[156:157] op_sel:[0,0] op_sel_hi:[0,1]
    v_pk_mul_f32 v[158:159], v[222:223], v[158:159] op_sel:[0,0] op_sel_hi:[0,1]
    v_pk_mul_f32 v[160:161], v[222:223], v[160:161] op_sel:[0,0] op_sel_hi:[0,1]
    v_pk_mul_f32 v[162:163], v[222:223], v[162:163] op_sel:[0,0] op_sel_hi:[0,1]
    ds_write_b128 v7, v[148:151] offset:0
    ds_write_b128 v7, v[152:155] offset:4608
    ds_write_b128 v7, v[156:159] offset:18432
    ds_write_b128 v7, v[160:163] offset:23040
    v_pk_fma_f32 v[84:85], v[212:213], v[180:181], v[84:85] op_sel:[0,0,0] op_sel_hi:[0,1,1]
    v_pk_fma_f32 v[86:87], v[212:213], v[182:183], v[86:87] op_sel:[0,0,0] op_sel_hi:[0,1,1]
    v_pk_fma_f32 v[88:89], v[212:213], v[184:185], v[88:89] op_sel:[0,0,0] op_sel_hi:[0,1,1]
    v_pk_fma_f32 v[90:91], v[212:213], v[186:187], v[90:91] op_sel:[0,0,0] op_sel_hi:[0,1,1]
    v_pk_fma_f32 v[92:93], v[212:213], v[188:189], v[92:93] op_sel:[0,0,0] op_sel_hi:[0,1,1]
    v_pk_fma_f32 v[94:95], v[212:213], v[190:191], v[94:95] op_sel:[0,0,0] op_sel_hi:[0,1,1]
    v_pk_fma_f32 v[96:97], v[212:213], v[192:193], v[96:97] op_sel:[0,0,0] op_sel_hi:[0,1,1]
    v_pk_fma_f32 v[98:99], v[212:213], v[194:195], v[98:99] op_sel:[0,0,0] op_sel_hi:[0,1,1]
    v_pk_mul_f32 v[84:85], v[218:219], v[84:85] op_sel:[0,0] op_sel_hi:[0,1]
    v_pk_mul_f32 v[86:87], v[218:219], v[86:87] op_sel:[0,0] op_sel_hi:[0,1]
    v_pk_mul_f32 v[88:89], v[218:219], v[88:89] op_sel:[0,0] op_sel_hi:[0,1]
    v_pk_mul_f32 v[90:91], v[218:219], v[90:91] op_sel:[0,0] op_sel_hi:[0,1]
    v_pk_mul_f32 v[92:93], v[218:219], v[92:93] op_sel:[0,0] op_sel_hi:[0,1]
    v_pk_mul_f32 v[94:95], v[218:219], v[94:95] op_sel:[0,0] op_sel_hi:[0,1]
    v_pk_mul_f32 v[96:97], v[218:219], v[96:97] op_sel:[0,0] op_sel_hi:[0,1]
    v_pk_mul_f32 v[98:99], v[218:219], v[98:99] op_sel:[0,0] op_sel_hi:[0,1]
    ds_write_b128 v8, v[84:87] offset:512
    ds_write_b128 v8, v[88:91] offset:5120
    ds_write_b128 v8, v[92:95] offset:18944
    ds_write_b128 v8, v[96:99] offset:23552
    v_pk_fma_f32 v[100:101], v[214:215], v[180:181], v[100:101] op_sel:[0,0,0] op_sel_hi:[0,1,1]
    v_pk_fma_f32 v[102:103], v[214:215], v[182:183], v[102:103] op_sel:[0,0,0] op_sel_hi:[0,1,1]
    v_pk_fma_f32 v[104:105], v[214:215], v[184:185], v[104:105] op_sel:[0,0,0] op_sel_hi:[0,1,1]
    v_pk_fma_f32 v[106:107], v[214:215], v[186:187], v[106:107] op_sel:[0,0,0] op_sel_hi:[0,1,1]
    v_pk_fma_f32 v[108:109], v[214:215], v[188:189], v[108:109] op_sel:[0,0,0] op_sel_hi:[0,1,1]
    v_pk_fma_f32 v[110:111], v[214:215], v[190:191], v[110:111] op_sel:[0,0,0] op_sel_hi:[0,1,1]
    v_pk_fma_f32 v[112:113], v[214:215], v[192:193], v[112:113] op_sel:[0,0,0] op_sel_hi:[0,1,1]
    v_pk_fma_f32 v[114:115], v[214:215], v[194:195], v[114:115] op_sel:[0,0,0] op_sel_hi:[0,1,1]
    v_pk_mul_f32 v[100:101], v[220:221], v[100:101] op_sel:[0,0] op_sel_hi:[0,1]
    v_pk_mul_f32 v[102:103], v[220:221], v[102:103] op_sel:[0,0] op_sel_hi:[0,1]
    v_pk_mul_f32 v[104:105], v[220:221], v[104:105] op_sel:[0,0] op_sel_hi:[0,1]
    v_pk_mul_f32 v[106:107], v[220:221], v[106:107] op_sel:[0,0] op_sel_hi:[0,1]
    v_pk_mul_f32 v[108:109], v[220:221], v[108:109] op_sel:[0,0] op_sel_hi:[0,1]
    v_pk_mul_f32 v[110:111], v[220:221], v[110:111] op_sel:[0,0] op_sel_hi:[0,1]
    v_pk_mul_f32 v[112:113], v[220:221], v[112:113] op_sel:[0,0] op_sel_hi:[0,1]
    v_pk_mul_f32 v[114:115], v[220:221], v[114:115] op_sel:[0,0] op_sel_hi:[0,1]
    ds_write_b128 v9, v[100:103] offset:512
    ds_write_b128 v9, v[104:107] offset:5120
    ds_write_b128 v9, v[108:111] offset:18944
    ds_write_b128 v9, v[112:115] offset:23552
    v_pk_fma_f32 v[116:117], v[212:213], v[164:165], v[116:117] op_sel:[0,0,0] op_sel_hi:[0,1,1]
    v_pk_fma_f32 v[118:119], v[212:213], v[166:167], v[118:119] op_sel:[0,0,0] op_sel_hi:[0,1,1]
    v_pk_fma_f32 v[120:121], v[212:213], v[168:169], v[120:121] op_sel:[0,0,0] op_sel_hi:[0,1,1]
    v_pk_fma_f32 v[122:123], v[212:213], v[170:171], v[122:123] op_sel:[0,0,0] op_sel_hi:[0,1,1]
    v_pk_fma_f32 v[124:125], v[212:213], v[172:173], v[124:125] op_sel:[0,0,0] op_sel_hi:[0,1,1]
    v_pk_fma_f32 v[126:127], v[212:213], v[174:175], v[126:127] op_sel:[0,0,0] op_sel_hi:[0,1,1]
    v_pk_fma_f32 v[128:129], v[212:213], v[176:177], v[128:129] op_sel:[0,0,0] op_sel_hi:[0,1,1]
    v_pk_fma_f32 v[130:131], v[212:213], v[178:179], v[130:131] op_sel:[0,0,0] op_sel_hi:[0,1,1]
    v_pk_mul_f32 v[116:117], v[218:219], v[116:117] op_sel:[0,0] op_sel_hi:[0,1]
    v_pk_mul_f32 v[118:119], v[218:219], v[118:119] op_sel:[0,0] op_sel_hi:[0,1]
    v_pk_mul_f32 v[120:121], v[218:219], v[120:121] op_sel:[0,0] op_sel_hi:[0,1]
    v_pk_mul_f32 v[122:123], v[218:219], v[122:123] op_sel:[0,0] op_sel_hi:[0,1]
    v_pk_mul_f32 v[124:125], v[218:219], v[124:125] op_sel:[0,0] op_sel_hi:[0,1]
    v_pk_mul_f32 v[126:127], v[218:219], v[126:127] op_sel:[0,0] op_sel_hi:[0,1]
    v_pk_mul_f32 v[128:129], v[218:219], v[128:129] op_sel:[0,0] op_sel_hi:[0,1]
    v_pk_mul_f32 v[130:131], v[218:219], v[130:131] op_sel:[0,0] op_sel_hi:[0,1]
    v_cvt_pk_bf16_f32 v116, v116, v117
    v_cvt_pk_bf16_f32 v117, v118, v119
    v_cvt_pk_bf16_f32 v118, v120, v121
    v_cvt_pk_bf16_f32 v119, v122, v123
    v_cvt_pk_bf16_f32 v120, v124, v125
    v_cvt_pk_bf16_f32 v121, v126, v127
    v_cvt_pk_bf16_f32 v122, v128, v129
    v_cvt_pk_bf16_f32 v123, v130, v131
    ds_write_b128 v5, v[116:119] offset:18944
    ds_write_b128 v5, v[120:123] offset:28160
    v_pk_fma_f32 v[132:133], v[214:215], v[164:165], v[132:133] op_sel:[0,0,0] op_sel_hi:[0,1,1]
    v_pk_fma_f32 v[134:135], v[214:215], v[166:167], v[134:135] op_sel:[0,0,0] op_sel_hi:[0,1,1]
    v_pk_fma_f32 v[136:137], v[214:215], v[168:169], v[136:137] op_sel:[0,0,0] op_sel_hi:[0,1,1]
    v_pk_fma_f32 v[138:139], v[214:215], v[170:171], v[138:139] op_sel:[0,0,0] op_sel_hi:[0,1,1]
    v_pk_fma_f32 v[140:141], v[214:215], v[172:173], v[140:141] op_sel:[0,0,0] op_sel_hi:[0,1,1]
    v_pk_fma_f32 v[142:143], v[214:215], v[174:175], v[142:143] op_sel:[0,0,0] op_sel_hi:[0,1,1]
    v_pk_fma_f32 v[144:145], v[214:215], v[176:177], v[144:145] op_sel:[0,0,0] op_sel_hi:[0,1,1]
    v_pk_fma_f32 v[146:147], v[214:215], v[178:179], v[146:147] op_sel:[0,0,0] op_sel_hi:[0,1,1]
    v_pk_mul_f32 v[132:133], v[220:221], v[132:133] op_sel:[0,0] op_sel_hi:[0,1]
    v_pk_mul_f32 v[134:135], v[220:221], v[134:135] op_sel:[0,0] op_sel_hi:[0,1]
    v_pk_mul_f32 v[136:137], v[220:221], v[136:137] op_sel:[0,0] op_sel_hi:[0,1]
    v_pk_mul_f32 v[138:139], v[220:221], v[138:139] op_sel:[0,0] op_sel_hi:[0,1]
    v_pk_mul_f32 v[140:141], v[220:221], v[140:141] op_sel:[0,0] op_sel_hi:[0,1]
    v_pk_mul_f32 v[142:143], v[220:221], v[142:143] op_sel:[0,0] op_sel_hi:[0,1]
    v_pk_mul_f32 v[144:145], v[220:221], v[144:145] op_sel:[0,0] op_sel_hi:[0,1]
    v_pk_mul_f32 v[146:147], v[220:221], v[146:147] op_sel:[0,0] op_sel_hi:[0,1]
    v_cvt_pk_bf16_f32 v132, v132, v133
    v_cvt_pk_bf16_f32 v133, v134, v135
    v_cvt_pk_bf16_f32 v134, v136, v137
    v_cvt_pk_bf16_f32 v135, v138, v139
    v_cvt_pk_bf16_f32 v136, v140, v141
    v_cvt_pk_bf16_f32 v137, v142, v143
    v_cvt_pk_bf16_f32 v138, v144, v145
    v_cvt_pk_bf16_f32 v139, v146, v147
    ds_write_b128 v6, v[132:135] offset:18944
    ds_write_b128 v6, v[136:139] offset:28160
    s_branch K1_ATTN
K1_A0_SLOW:
    s_mov_b32 s62, 0
K1_A0_SPIN:
    s_add_u32 s62, s62, 1
    s_cmp_ge_u32 s62, 4000
    s_cbranch_scc1 K1_A0_FB1
    s_sleep 4
    v_lshlrev_b32 v11, 2, v1
    global_load_dword v223, v11, s[76:77] sc1
    s_waitcnt vmcnt(0)
    v_and_b32 v11, v223, v221
    v_cmp_ne_u32 vcc, v11, v221
    s_nop 4
    s_cbranch_vccz K1_A0_RDY
    s_branch K1_A0_SPIN
K1_A0_FB1:
    v_mov_b32 v5, 1
    s_branch K1_A0_RDY
K1_A0_FB:
    s_lshl_b32 s63, s35, 8
    s_lshl_b32 s47, s38, 6
    s_add_u32 s63, s63, s47
    s_lshl_b32 s47, s37, 5
    s_add_u32 s63, s63, s47
    s_mov_b32 s62, 0
K1_A0_FS0:
    s_add_u32 s64, s63, s62
    s_lshl_b32 s64, s64, 10
    buffer_load_dwordx4 v[164:167], v219, s[8:11], s64 offen
    s_waitcnt vmcnt(0)
    v_mov_b32 v8, 0
    v_mov_b32 v9, 0
    v_dot2c_f32_bf16 v8, s54, v164
    v_dot2c_f32_bf16 v9, v164, v164
    v_dot2c_f32_bf16 v8, s54, v165
    v_dot2c_f32_bf16 v9, v165, v165
    v_dot2c_f32_bf16 v8, s54, v166
    v_dot2c_f32_bf16 v9, v166, v166
    v_dot2c_f32_bf16 v8, s54, v167
    v_dot2c_f32_bf16 v9, v167, v167
    s_nop 2
    v_add_f32_dpp v8, v8, v8 row_shr:1 row_mask:0xf bank_mask:0xf bound_ctrl:0
    v_add_f32_dpp v9, v9, v9 row_shr:1 row_mask:0xf bank_mask:0xf bound_ctrl:0
    s_nop 0
    v_add_f32_dpp v8, v8, v8 row_shr:2 row_mask:0xf bank_mask:0xf bound_ctrl:0
    v_add_f32_dpp v9, v9, v9 row_shr:2 row_mask:0xf bank_mask:0xf bound_ctrl:0
    s_nop 0
    v_add_f32_dpp v8, v8, v8 row_shr:4 row_mask:0xf bank_mask:0xf bound_ctrl:0
    v_add_f32_dpp v9, v9, v9 row_shr:4 row_mask:0xf bank_mask:0xf bound_ctrl:0
    s_nop 0
    v_add_f32_dpp v8, v8, v8 row_shr:8 row_mask:0xf bank_mask:0xf bound_ctrl:0
    v_add_f32_dpp v9, v9, v9 row_shr:8 row_mask:0xf bank_mask:0xf bound_ctrl:0
    s_nop 0
    v_add_f32_dpp v8, v8, v8 row_bcast:15 row_mask:0xa bank_mask:0xf
    v_add_f32_dpp v9, v9, v9 row_bcast:15 row_mask:0xa bank_mask:0xf
    s_nop 0
    v_add_f32_dpp v8, v8, v8 row_bcast:31 row_mask:0xc bank_mask:0xf
    v_add_f32_dpp v9, v9, v9 row_bcast:31 row_mask:0xc bank_mask:0xf
    s_nop 0
    v_readlane_b32 s46, v8, 63
    v_readlane_b32 s47, v9, 63
    s_nop 1
    v_mov_b32 v8, s46
    v_mov_b32 v9, s47
    v_cmp_eq_u32 vcc, s62, v2
    s_nop 1
    v_cndmask_b32 v248, v248, v8, vcc
    v_cndmask_b32 v249, v249, v9, vcc
    s_add_u32 s62, s62, 1
    s_cmp_lt_u32 s62, 32
    s_cbranch_scc1 K1_A0_FS0
    s_xor_b32 s63, s63, 32
    s_mov_b32 s62, 0
K1_A0_FS1:
    s_add_u32 s64, s63, s62
    s_lshl_b32 s64, s64, 10
    buffer_load_dwordx4 v[164:167], v219, s[8:11], s64 offen
    s_waitcnt vmcnt(0)
    v_mov_b32 v8, 0
    v_mov_b32 v9, 0
    v_dot2c_f32_bf16 v8, s54, v164
    v_dot2c_f32_bf16 v9, v164, v164
    v_dot2c_f32_bf16 v8, s54, v165
    v_dot2c_f32_bf16 v9, v165, v165
    v_dot2c_f32_bf16 v8, s54, v166
    v_dot2c_f32_bf16 v9, v166, v166
    v_dot2c_f32_bf16 v8, s54, v167
    v_dot2c_f32_bf16 v9, v167, v167
    s_nop 2
    v_add_f32_dpp v8, v8, v8 row_shr:1 row_mask:0xf bank_mask:0xf bound_ctrl:0
    v_add_f32_dpp v9, v9, v9 row_shr:1 row_mask:0xf bank_mask:0xf bound_ctrl:0
    s_nop 0
    v_add_f32_dpp v8, v8, v8 row_shr:2 row_mask:0xf bank_mask:0xf bound_ctrl:0
    v_add_f32_dpp v9, v9, v9 row_shr:2 row_mask:0xf bank_mask:0xf bound_ctrl:0
    s_nop 0
    v_add_f32_dpp v8, v8, v8 row_shr:4 row_mask:0xf bank_mask:0xf bound_ctrl:0
    v_add_f32_dpp v9, v9, v9 row_shr:4 row_mask:0xf bank_mask:0xf bound_ctrl:0
    s_nop 0
    v_add_f32_dpp v8, v8, v8 row_shr:8 row_mask:0xf bank_mask:0xf bound_ctrl:0
    v_add_f32_dpp v9, v9, v9 row_shr:8 row_mask:0xf bank_mask:0xf bound_ctrl:0
    s_nop 0
    v_add_f32_dpp v8, v8, v8 row_bcast:15 row_mask:0xa bank_mask:0xf
    v_add_f32_dpp v9, v9, v9 row_bcast:15 row_mask:0xa bank_mask:0xf
    s_nop 0
    v_add_f32_dpp v8, v8, v8 row_bcast:31 row_mask:0xc bank_mask:0xf
    v_add_f32_dpp v9, v9, v9 row_bcast:31 row_mask:0xc bank_mask:0xf
    s_nop 0
    v_readlane_b32 s46, v8, 63
    v_readlane_b32 s47, v9, 63
    s_nop 1
    v_mov_b32 v8, s46
    v_mov_b32 v9, s47
    v_cmp_eq_u32 vcc, s62, v2
    s_nop 1
    v_cndmask_b32 v250, v250, v8, vcc
    v_cndmask_b32 v251, v251, v9, vcc
    s_add_u32 s62, s62, 1
    s_cmp_lt_u32 s62, 32
    s_cbranch_scc1 K1_A0_FS1
    v_mov_b32 v232, 0
    v_mov_b32 v233, 0
    v_mov_b32 v234, 0
    v_mov_b32 v235, 0
    v_mov_b32 v236, 0
    v_mov_b32 v237, 0
    v_mov_b32 v238, 0
    v_mov_b32 v239, 0
    v_mov_b32 v240, 0
    v_mov_b32 v241, 0
    v_mov_b32 v242, 0
    v_mov_b32 v243, 0
    v_mov_b32 v244, 0
    v_mov_b32 v245, 0
    v_mov_b32 v246, 0
    v_mov_b32 v247, 0
    v_mov_b32 v4, s57
    v_and_b32 v5, 15, v2
    v_lshlrev_b32 v5, 1, v5
    v_lshl_add_u32 v4, v4, 5, v5
    v_mov_b32 v164, s28
    v_mov_b32 v165, s29
    v_mov_b32 v6, s30
    v_mov_b32 v7, s31
    v_cmp_lt_u32 vcc, 15, v2
    s_nop 1
    v_cndmask_b32 v164, v164, v6, vcc
    v_cndmask_b32 v165, v165, v7, vcc
    v_mov_b32 v166, 2752
    s_lshl_b32 s46, s36, 6
    v_lshl_add_u32 v5, v2, 1, s46
    v_mov_b32 v6, s6
    v_mov_b32 v7, s7
    v_mov_b32 v8, 3072
    v_cmp_gt_u32 vcc, 32, v1
    s_nop 1
    v_cndmask_b32 v164, v164, v6, vcc
    v_cndmask_b32 v165, v165, v7, vcc
    v_cndmask_b32 v4, v4, v5, vcc
    v_cndmask_b32 v166, v166, v8, vcc
    v_mov_b32 v167, 0
    v_mov_b32 v5, 0
    v_add_co_u32 v164, vcc, v164, v4
    s_nop 1
    v_addc_co_u32 v165, vcc, v165, v5, vcc
    s_mov_b32 s62, 0
K1_A0_FC0:
    global_load_ushort v6, v[164:165], off
    v_lshl_add_u64 v[164:165], v[166:167], 0, v[164:165]
    s_waitcnt vmcnt(0)
    v_lshlrev_b32 v6, 16, v6
    v_add_f32 v232, v232, v6
    s_add_u32 s62, s62, 1
    s_cmp_lt_u32 s62, 512
    s_cbranch_scc1 K1_A0_FC0
    s_branch K1_A0_HB
K1_A0:
    s_barrier
    ds_read_b128 v[44:47], v24 offset:0
    ds_read_b64_tr_b16 v[52:53], v36 offset:0
    ds_read_b64_tr_b16 v[54:55], v36 offset:768
    ds_read_b128 v[48:51], v28 offset:0
    ds_read_b64_tr_b16 v[56:57], v40 offset:0
    ds_read_b64_tr_b16 v[58:59], v41 offset:0
    s_add_u32 m0, s50, 106496
    s_nop 0
    buffer_load_dwordx4 v16, s[8:11], s40 offen offset:0 lds
    buffer_load_dwordx4 v17, s[8:11], s40 offen offset:1024 lds
    s_waitcnt lgkmcnt(0)
    v_mfma_f32_32x32x16_bf16 v[84:99], v[52:55], v[44:47], 0
    ds_read_b128 v[64:67], v25 offset:0
    ds_read_b64_tr_b16 v[72:73], v36 offset:3072
    ds_read_b64_tr_b16 v[74:75], v36 offset:3840
    ds_read_b128 v[68:71], v29 offset:0
    v_mfma_f32_32x32x16_bf16 v[100:115], v[52:55], v[48:51], 0
    ds_read_b64_tr_b16 v[76:77], v40 offset:512
    ds_read_b64_tr_b16 v[78:79], v41 offset:512
    v_mfma_f32_32x32x16_bf16 v[116:131], v[56:59], v[44:47], 0
    buffer_load_dwordx4 v18, s[8:11], s40 offen offset:2048 lds
    buffer_load_dwordx4 v19, s[8:11], s40 offen offset:3072 lds
    s_mul_i32 s46, s38, 3072
    v_add_u32 v4, s46, v36
    ds_read_b64_tr_b16 v[164:165], v4 offset:0
    ds_read_b64_tr_b16 v[166:167], v4 offset:768
    s_lshl_b32 s46, s38, 9
    v_add_u32 v4, s46, v40
    v_add_u32 v5, s46, v41
    ds_read_b64_tr_b16 v[168:169], v4 offset:0
    ds_read_b64_tr_b16 v[170:171], v5 offset:0
    v_mfma_f32_32x32x16_bf16 v[132:147], v[56:59], v[48:51], 0
    v_mov_b32 v6, 0
    v_mov_b32 v7, 0
    v_mov_b32 v8, 0
    s_mul_i32 s46, s38, 640
    s_lshl_b32 s47, s37, 8
    s_add_u32 s47, s47, s46
    v_lshl_add_u32 v10, v1, 2, s47
    v_lshl_add_u32 v11, v2, 2, s46
    v_add_u32 v10, 159744, v10
    v_add_u32 v11, 160256, v11
    s_waitcnt lgkmcnt(0)
    v_mfma_f32_32x32x16_bf16 v[84:99], v[72:75], v[64:67], v[84:99]
    ds_read_b128 v[44:47], v26 offset:0
    ds_read_b64_tr_b16 v[52:53], v36 offset:6144
    ds_read_b64_tr_b16 v[54:55], v36 offset:6912
    ds_read_b128 v[48:51], v30 offset:0
    v_mfma_f32_32x32x16_bf16 v[100:115], v[72:75], v[68:71], v[100:115]
    ds_read_b64_tr_b16 v[56:57], v40 offset:1024
    ds_read_b64_tr_b16 v[58:59], v41 offset:1024
    v_mfma_f32_32x32x16_bf16 v[116:131], v[76:79], v[64:67], v[116:131]
    s_add_u32 m0, s51, 106496
    s_nop 0
    buffer_load_dwordx4 v225, s[12:15], s41 offen lds
    s_mov_b32 exec_hi, 0
    buffer_load_dwordx4 v227, s[12:15], s41 offen offset:1024 lds
    s_mov_b32 exec_hi, -1
    v_dot2c_f32_bf16 v6, s54, v164
    v_mfma_f32_32x32x16_bf16 v[132:147], v[76:79], v[68:71], v[132:147]
    v_dot2c_f32_bf16 v7, s54, v168
    v_dot2c_f32_bf16 v6, s54, v165
    v_dot2c_f32_bf16 v7, s54, v169
    v_dot2c_f32_bf16 v6, s54, v166
    v_dot2c_f32_bf16 v7, s54, v170
    v_dot2c_f32_bf16 v6, s54, v167
    v_dot2c_f32_bf16 v7, s54, v171
    s_waitcnt lgkmcnt(0)
    v_mfma_f32_32x32x16_bf16 v[84:99], v[52:55], v[44:47], v[84:99]
    ds_read_b128 v[64:67], v27 offset:0
    ds_read_b64_tr_b16 v[72:73], v36 offset:9216
    ds_read_b64_tr_b16 v[74:75], v36 offset:9984
    ds_read_b128 v[68:71], v31 offset:0
    v_mfma_f32_32x32x16_bf16 v[100:115], v[52:55], v[48:51], v[100:115]
    ds_read_b64_tr_b16 v[76:77], v40 offset:1536
    ds_read_b64_tr_b16 v[78:79], v41 offset:1536
    v_mfma_f32_32x32x16_bf16 v[116:131], v[56:59], v[44:47], v[116:131]
    s_add_u32 m0, s52, 106496
    s_mov_b32 exec_hi, 0
    buffer_load_dwordx4 v20, s[8:11], s40 offen lds
    s_mov_b32 exec_hi, -1
    s_add_u32 m0, s53, 106496
    s_mov_b32 exec_hi, 0
    buffer_load_dwordx4 v229, s[20:23], s42 offen lds
    s_mov_b32 exec_hi, -1
    s_add_u32 s49, s49, 1
    s_and_b32 s49, s49, 7
    s_lshl_b32 s40, s49, 7
    s_mul_i32 s42, s49, 176128
    s_mul_i32 s41, s49, 196608
    v_mfma_f32_32x32x16_bf16 v[132:147], v[56:59], v[48:51], v[132:147]
    v_mov_b32 v9, v8
    s_nop 1
    v_permlane32_swap_b32 v6, v7
    v_permlane32_swap_b32 v8, v9
    s_nop 1
    v_add_f32 v6, v6, v7
    v_add_f32 v8, v8, v9
    ds_write_b32 v10, v6
    ds_write_b32 v11, v8
    s_waitcnt vmcnt(8) lgkmcnt(0)
    s_barrier
    v_mfma_f32_32x32x16_bf16 v[84:99], v[72:75], v[64:67], v[84:99]
    ds_read_b128 v[44:47], v24 offset:53248
    ds_read_b64_tr_b16 v[52:53], v36 offset:53248
    ds_read_b64_tr_b16 v[54:55], v36 offset:54016
    ds_read_b128 v[48:51], v28 offset:53248
    v_mfma_f32_32x32x16_bf16 v[100:115], v[72:75], v[68:71], v[100:115]
    ds_read_b64_tr_b16 v[56:57], v40 offset:53248
    ds_read_b64_tr_b16 v[58:59], v41 offset:53248
    v_mfma_f32_32x32x16_bf16 v[116:131], v[76:79], v[64:67], v[116:131]
    s_add_u32 m0, s50, 0
    s_nop 0
    buffer_load_dwordx4 v16, s[8:11], s40 offen offset:0 lds
    buffer_load_dwordx4 v17, s[8:11], s40 offen offset:1024 lds
    s_lshl_b32 s46, s34, 8
    v_lshl_add_u32 v4, v1, 2, s46
    v_min_u32 v5, 636, v4
    v_add_u32 v5, 159744, v5
    ds_read_b32 v6, v5 offset:0
    ds_read_b32 v7, v5 offset:640
    ds_read_b32 v8, v5 offset:1280
    ds_read_b32 v9, v5 offset:1920
    s_lshl_b32 s46, s48, 3
    s_add_u32 s46, s46, s35
    s_mul_i32 s46, s46, 640
    s_add_u32 s46, s46, 8388608
    v_mfma_f32_32x32x16_bf16 v[132:147], v[76:79], v[68:71], v[132:147]
    v_add_u32 v4, s46, v4
    v_mov_b32 v10, 0
    v_mov_b32 v11, 0
    v_dot2c_f32_bf16 v10, s54, v232
    v_dot2c_f32_bf16 v11, v232, v232
    v_dot2c_f32_bf16 v10, s54, v233
    v_dot2c_f32_bf16 v11, v233, v233
    v_dot2c_f32_bf16 v10, s54, v234
    v_dot2c_f32_bf16 v11, v234, v234
    v_dot2c_f32_bf16 v10, s54, v235
    v_dot2c_f32_bf16 v11, v235, v235
    s_nop 2
    v_add_f32_dpp v10, v10, v10 row_shr:1 row_mask:0xf bank_mask:0xf bound_ctrl:0
    v_add_f32_dpp v11, v11, v11 row_shr:1 row_mask:0xf bank_mask:0xf bound_ctrl:0
    s_nop 0
    s_waitcnt lgkmcnt(0)
    v_mfma_f32_32x32x16_bf16 v[84:99], v[52:55], v[44:47], v[84:99]
    ds_read_b128 v[64:67], v25 offset:53248
    ds_read_b64_tr_b16 v[72:73], v36 offset:56320
    ds_read_b64_tr_b16 v[74:75], v36 offset:57088
    ds_read_b128 v[68:71], v29 offset:53248
    v_mfma_f32_32x32x16_bf16 v[100:115], v[52:55], v[48:51], v[100:115]
    ds_read_b64_tr_b16 v[76:77], v40 offset:53760
    ds_read_b64_tr_b16 v[78:79], v41 offset:53760
    v_mfma_f32_32x32x16_bf16 v[116:131], v[56:59], v[44:47], v[116:131]
    v_add_f32 v6, v6, v7
    v_add_f32 v8, v8, v9
    v_add_f32 v6, v6, v8
    s_cmp_ge_u32 s34, 3
    s_cbranch_scc1 K1_A0_H1
    s_cmp_eq_u32 s34, 2
    s_cselect_b32 exec_hi, 0, -1
    global_store_dword v4, v6, s[32:33] sc1
    s_mov_b32 exec_hi, -1
K1_A0_H1:
    v_add_f32_dpp v10, v10, v10 row_shr:2 row_mask:0xf bank_mask:0xf bound_ctrl:0
    v_add_f32_dpp v11, v11, v11 row_shr:2 row_mask:0xf bank_mask:0xf bound_ctrl:0
    s_nop 0
    v_add_f32_dpp v10, v10, v10 row_shr:4 row_mask:0xf bank_mask:0xf bound_ctrl:0
    v_add_f32_dpp v11, v11, v11 row_shr:4 row_mask:0xf bank_mask:0xf bound_ctrl:0
    s_nop 0
    v_add_f32_dpp v10, v10, v10 row_shr:8 row_mask:0xf bank_mask:0xf bound_ctrl:0
    v_add_f32_dpp v11, v11, v11 row_shr:8 row_mask:0xf bank_mask:0xf bound_ctrl:0
    v_mfma_f32_32x32x16_bf16 v[132:147], v[56:59], v[48:51], v[132:147]
    s_nop 0
    v_add_f32_dpp v10, v10, v10 row_bcast:15 row_mask:0xa bank_mask:0xf
    v_add_f32_dpp v11, v11, v11 row_bcast:15 row_mask:0xa bank_mask:0xf
    s_nop 0
    v_add_f32_dpp v10, v10, v10 row_bcast:31 row_mask:0xc bank_mask:0xf
    v_add_f32_dpp v11, v11, v11 row_bcast:31 row_mask:0xc bank_mask:0xf
    s_nop 0
    v_readlane_b32 s44, v10, 63
    v_readlane_b32 s45, v11, 63
    s_nop 1
    v_mov_b32 v236, s44
    v_mov_b32 v237, s45
    v_mov_b32 v10, s60
    s_mov_b64 exec, 1
    global_store_dwordx2 v10, v[236:237], s[32:33] sc1
    s_mov_b64 exec, -1
    buffer_load_dwordx4 v18, s[8:11], s40 offen offset:2048 lds
    buffer_load_dwordx4 v19, s[8:11], s40 offen offset:3072 lds
    s_waitcnt lgkmcnt(0)
    v_mfma_f32_32x32x16_bf16 v[84:99], v[72:75], v[64:67], v[84:99]
    ds_read_b128 v[44:47], v26 offset:53248
    ds_read_b64_tr_b16 v[52:53], v36 offset:59392
    ds_read_b64_tr_b16 v[54:55], v36 offset:60160
    ds_read_b128 v[48:51], v30 offset:53248
    v_mfma_f32_32x32x16_bf16 v[100:115], v[72:75], v[68:71], v[100:115]
    ds_read_b64_tr_b16 v[56:57], v40 offset:54272
    ds_read_b64_tr_b16 v[58:59], v41 offset:54272
    v_mfma_f32_32x32x16_bf16 v[116:131], v[76:79], v[64:67], v[116:131]
    s_add_u32 m0, s51, 0
    s_nop 0
    buffer_load_dwordx4 v225, s[12:15], s41 offen lds
    v_mfma_f32_32x32x16_bf16 v[132:147], v[76:79], v[68:71], v[132:147]
    s_mov_b32 exec_hi, 0
    buffer_load_dwordx4 v227, s[12:15], s41 offen offset:1024 lds
    s_mov_b32 exec_hi, -1
    s_waitcnt lgkmcnt(0)
    v_mfma_f32_32x32x16_bf16 v[84:99], v[52:55], v[44:47], v[84:99]
    ds_read_b128 v[64:67], v27 offset:53248
    ds_read_b64_tr_b16 v[72:73], v36 offset:62464
    ds_read_b64_tr_b16 v[74:75], v36 offset:63232
    ds_read_b128 v[68:71], v31 offset:53248
    v_mfma_f32_32x32x16_bf16 v[100:115], v[52:55], v[48:51], v[100:115]
    ds_read_b64_tr_b16 v[76:77], v40 offset:54784
    ds_read_b64_tr_b16 v[78:79], v41 offset:54784
    v_mfma_f32_32x32x16_bf16 v[116:131], v[56:59], v[44:47], v[116:131]
    s_add_u32 m0, s52, 0
    s_mov_b32 exec_hi, 0
    buffer_load_dwordx4 v20, s[8:11], s40 offen lds
    s_mov_b32 exec_hi, -1
    s_add_u32 m0, s53, 0
    s_mov_b32 exec_hi, 0
    buffer_load_dwordx4 v229, s[20:23], s42 offen lds
    s_mov_b32 exec_hi, -1
    s_add_u32 s49, s49, 1
    s_and_b32 s49, s49, 7
    s_lshl_b32 s40, s49, 7
    s_mul_i32 s42, s49, 176128
    s_mul_i32 s41, s49, 196608
    v_mfma_f32_32x32x16_bf16 v[132:147], v[56:59], v[48:51], v[132:147]
    v_add_u32 v24, 106496, v24
    v_add_u32 v25, 106496, v25
    v_add_u32 v26, 106496, v26
    v_add_u32 v27, 106496, v27
    v_add_u32 v28, 106496, v28
    v_add_u32 v29, 106496, v29
    v_add_u32 v30, 106496, v30
    v_add_u32 v31, 106496, v31
    v_add_u32 v36, 106496, v36
    v_add_u32 v40, 106496, v40
    v_add_u32 v41, 106496, v41
    s_waitcnt vmcnt(6) lgkmcnt(0)
    s_barrier
    v_mfma_f32_32x32x16_bf16 v[84:99], v[72:75], v[64:67], v[84:99]
    ds_read_b128 v[44:47], v24 offset:0
    ds_read_b64_tr_b16 v[52:53], v36 offset:0
    ds_read_b64_tr_b16 v[54:55], v36 offset:768
    ds_read_b128 v[48:51], v28 offset:0
    v_mfma_f32_32x32x16_bf16 v[100:115], v[72:75], v[68:71], v[100:115]
    ds_read_b64_tr_b16 v[56:57], v40 offset:0
    ds_read_b64_tr_b16 v[58:59], v41 offset:0
    v_mfma_f32_32x32x16_bf16 v[116:131], v[76:79], v[64:67], v[116:131]
    s_add_u32 m0, s50, 53248
    s_nop 0
    buffer_load_dwordx4 v16, s[8:11], s40 offen offset:0 lds
    buffer_load_dwordx4 v17, s[8:11], s40 offen offset:1024 lds
    s_cmp_lg_u32 s34, 0
    s_cbranch_scc1 K1_A0_H2
    s_lshl_b32 s46, s35, 5
    s_add_u32 s46, s46, s48
    s_and_b32 s47, s46, 3
    s_lshl_b32 s47, s47, 3
    s_lshl_b32 s47, 1, s47
    s_and_b32 s46, s46, 252
    v_mov_b32 v4, s46
    v_mov_b32 v5, s47
    s_mov_b64 exec, 1
    global_atomic_add v4, v5, s[76:77] sc1
    s_mov_b64 exec, -1
K1_A0_H2:
    v_mfma_f32_32x32x16_bf16 v[132:147], v[76:79], v[68:71], v[132:147]
    s_waitcnt lgkmcnt(0)
    v_mfma_f32_32x32x16_bf16 v[84:99], v[52:55], v[44:47], v[84:99]
    ds_read_b128 v[64:67], v25 offset:0
    ds_read_b64_tr_b16 v[72:73], v36 offset:3072
    ds_read_b64_tr_b16 v[74:75], v36 offset:3840
    ds_read_b128 v[68:71], v29 offset:0
    v_mfma_f32_32x32x16_bf16 v[100:115], v[52:55], v[48:51], v[100:115]
    ds_read_b64_tr_b16 v[76:77], v40 offset:512
    ds_read_b64_tr_b16 v[78:79], v41 offset:512
    v_mfma_f32_32x32x16_bf16 v[116:131], v[56:59], v[44:47], v[116:131]
    buffer_load_dwordx4 v18, s[8:11], s40 offen offset:2048 lds
    v_mfma_f32_32x32x16_bf16 v[132:147], v[56:59], v[48:51], v[132:147]
    buffer_load_dwordx4 v19, s[8:11], s40 offen offset:3072 lds
    s_waitcnt lgkmcnt(0)
    v_mfma_f32_32x32x16_bf16 v[84:99], v[72:75], v[64:67], v[84:99]
    ds_read_b128 v[44:47], v26 offset:0
    ds_read_b64_tr_b16 v[52:53], v36 offset:6144
    ds_read_b64_tr_b16 v[54:55], v36 offset:6912
    ds_read_b128 v[48:51], v30 offset:0
    v_mfma_f32_32x32x16_bf16 v[100:115], v[72:75], v[68:71], v[100:115]
    ds_read_b64_tr_b16 v[56:57], v40 offset:1024
    ds_read_b64_tr_b16 v[58:59], v41 offset:1024
    v_mfma_f32_32x32x16_bf16 v[116:131], v[76:79], v[64:67], v[116:131]
    s_add_u32 m0, s51, 53248
    s_nop 0
    buffer_load_dwordx4 v225, s[12:15], s41 offen lds
    v_mfma_f32_32x32x16_bf16 v[132:147], v[76:79], v[68:71], v[132:147]
    s_mov_b32 exec_hi, 0
    buffer_load_dwordx4 v227, s[12:15], s41 offen offset:1024 lds
    s_mov_b32 exec_hi, -1
    s_waitcnt lgkmcnt(0)
    v_mfma_f32_32x32x16_bf16 v[84:99], v[52:55], v[44:47], v[84:99]
    ds_read_b128 v[64:67], v27 offset:0
    ds_read_b64_tr_b16 v[72:73], v36 offset:9216
    ds_read_b64_tr_b16 v[74:75], v36 offset:9984
    ds_read_b128 v[68:71], v31 offset:0
    v_mfma_f32_32x32x16_bf16 v[100:115], v[52:55], v[48:51], v[100:115]
    ds_read_b64_tr_b16 v[76:77], v40 offset:1536
    ds_read_b64_tr_b16 v[78:79], v41 offset:1536
    v_mfma_f32_32x32x16_bf16 v[116:131], v[56:59], v[44:47], v[116:131]
    s_add_u32 m0, s52, 53248
    s_mov_b32 exec_hi, 0
    buffer_load_dwordx4 v20, s[8:11], s40 offen lds
    s_mov_b32 exec_hi, -1
    s_add_u32 m0, s53, 53248
    s_mov_b32 exec_hi, 0
    buffer_load_dwordx4 v229, s[20:23], s42 offen lds
    s_mov_b32 exec_hi, -1
    s_add_u32 s49, s49, 1
    s_and_b32 s49, s49, 7
    s_lshl_b32 s40, s49, 7
    s_mul_i32 s42, s49, 176128
    s_mul_i32 s41, s49, 196608
    v_mfma_f32_32x32x16_bf16 v[132:147], v[56:59], v[48:51], v[132:147]
    v_subrev_u32 v24, 106496, v24
    v_subrev_u32 v25, 106496, v25
    v_subrev_u32 v26, 106496, v26
    v_subrev_u32 v27, 106496, v27
    v_subrev_u32 v28, 106496, v28
    v_subrev_u32 v29, 106496, v29
    v_subrev_u32 v30, 106496, v30
    v_subrev_u32 v31, 106496, v31
    v_subrev_u32 v36, 106496, v36
    v_subrev_u32 v40, 106496, v40
    v_subrev_u32 v41, 106496, v41
    s_waitcnt vmcnt(8) lgkmcnt(0)
    s_barrier
    v_mfma_f32_32x32x16_bf16 v[84:99], v[72:75], v[64:67], v[84:99]
    ds_read_b128 v[44:47], v24 offset:0
    ds_read_b64_tr_b16 v[52:53], v36 offset:0
    ds_read_b64_tr_b16 v[54:55], v36 offset:768
    ds_read_b128 v[48:51], v28 offset:0
    v_mfma_f32_32x32x16_bf16 v[100:115], v[72:75], v[68:71], v[100:115]
    ds_read_b64_tr_b16 v[56:57], v40 offset:0
    ds_read_b64_tr_b16 v[58:59], v41 offset:0
    v_mfma_f32_32x32x16_bf16 v[116:131], v[76:79], v[64:67], v[116:131]
    s_add_u32 m0, s50, 106496
    s_nop 0
    buffer_load_dwordx4 v16, s[8:11], s40 offen offset:0 lds
    v_mfma_f32_32x32x16_bf16 v[132:147], v[76:79], v[68:71], v[132:147]
    buffer_load_dwordx4 v17, s[8:11], s40 offen offset:1024 lds
    s_waitcnt lgkmcnt(0)
    v_mfma_f32_32x32x16_bf16 v[84:99], v[52:55], v[44:47], v[84:99]
    ds_read_b128 v[64:67], v25 offset:0
    ds_read_b64_tr_b16 v[72:73], v36 offset:3072
    ds_read_b64_tr_b16 v[74:75], v36 offset:3840
    ds_read_b128 v[68:71], v29 offset:0
    v_mfma_f32_32x32x16_bf16 v[100:115], v[52:55], v[48:51], v[100:115]
    ds_read_b64_tr_b16 v[76:77], v40 offset:512
    ds_read_b64_tr_b16 v[78:79], v41 offset:512
    v_mfma_f32_32x32x16_bf16 v[116:131], v[56:59], v[44:47], v[116:131]
    buffer_load_dwordx4 v18, s[8:11], s40 offen offset:2048 lds
    v_mfma_f32_32x32x16_bf16 v[132:147], v[56:59], v[48:51], v[132:147]
    buffer_load_dwordx4 v19, s[8:11], s40 offen offset:3072 lds
    s_waitcnt lgkmcnt(0)
    v_mfma_f32_32x32x16_bf16 v[84:99], v[72:75], v[64:67], v[84:99]
    ds_read_b128 v[44:47], v26 offset:0
    ds_read_b64_tr_b16 v[52:53], v36 offset:6144
    ds_read_b64_tr_b16 v[54:55], v36 offset:6912
    ds_read_b128 v[48:51], v30 offset:0
    v_mfma_f32_32x32x16_bf16 v[100:115], v[72:75], v[68:71], v[100:115]
    ds_read_b64_tr_b16 v[56:57], v40 offset:1024
    ds_read_b64_tr_b16 v[58:59], v41 offset:1024
    v_mfma_f32_32x32x16_bf16 v[116:131], v[76:79], v[64:67], v[116:131]
    s_add_u32 m0, s51, 106496
    s_nop 0
    buffer_load_dwordx4 v225, s[12:15], s41 offen lds
    v_mfma_f32_32x32x16_bf16 v[132:147], v[76:79], v[68:71], v[132:147]
    s_mov_b32 exec_hi, 0
    buffer_load_dwordx4 v227, s[12:15], s41 offen offset:1024 lds
    s_mov_b32 exec_hi, -1
    s_waitcnt lgkmcnt(0)
    v_mfma_f32_32x32x16_bf16 v[84:99], v[52:55], v[44:47], v[84:99]
    ds_read_b128 v[64:67], v27 offset:0
    ds_read_b64_tr_b16 v[72:73], v36 offset:9216
    ds_read_b64_tr_b16 v[74:75], v36 offset:9984
    ds_read_b128 v[68:71], v31 offset:0
    v_mfma_f32_32x32x16_bf16 v[100:115], v[52:55], v[48:51], v[100:115]
    ds_read_b64_tr_b16 v[76:77], v40 offset:1536
    ds_read_b64_tr_b16 v[78:79], v41 offset:1536
    v_mfma_f32_32x32x16_bf16 v[116:131], v[56:59], v[44:47], v[116:131]
    s_add_u32 m0, s52, 106496
    s_mov_b32 exec_hi, 0
    buffer_load_dwordx4 v20, s[8:11], s40 offen lds
    s_mov_b32 exec_hi, -1
    s_add_u32 m0, s53, 106496
    s_mov_b32 exec_hi, 0
    buffer_load_dwordx4 v229, s[20:23], s42 offen lds
    s_mov_b32 exec_hi, -1
    s_add_u32 s49, s49, 1
    s_and_b32 s49, s49, 7
    s_lshl_b32 s40, s49, 7
    s_mul_i32 s42, s49, 176128
    s_mul_i32 s41, s49, 196608
    v_mfma_f32_32x32x16_bf16 v[132:147], v[56:59], v[48:51], v[132:147]
    s_waitcnt vmcnt(8) lgkmcnt(0)
    s_barrier
    v_mfma_f32_32x32x16_bf16 v[84:99], v[72:75], v[64:67], v[84:99]
    ds_read_b128 v[44:47], v24 offset:53248
    ds_read_b64_tr_b16 v[52:53], v36 offset:53248
    ds_read_b64_tr_b16 v[54:55], v36 offset:54016
    ds_read_b128 v[48:51], v28 offset:53248
    v_mfma_f32_32x32x16_bf16 v[100:115], v[72:75], v[68:71], v[100:115]
    ds_read_b64_tr_b16 v[56:57], v40 offset:53248
    ds_read_b64_tr_b16 v[58:59], v41 offset:53248
    v_mfma_f32_32x32x16_bf16 v[116:131], v[76:79], v[64:67], v[116:131]
    s_add_u32 m0, s50, 0
    s_nop 0
    buffer_load_dwordx4 v16, s[8:11], s40 offen offset:0 lds
    v_mfma_f32_32x32x16_bf16 v[132:147], v[76:79], v[68:71], v[132:147]
    buffer_load_dwordx4 v17, s[8:11], s40 offen offset:1024 lds
    s_waitcnt lgkmcnt(0)
    v_mfma_f32_32x32x16_bf16 v[84:99], v[52:55], v[44:47], v[84:99]
    ds_read_b128 v[64:67], v25 offset:53248
    ds_read_b64_tr_b16 v[72:73], v36 offset:56320
    ds_read_b64_tr_b16 v[74:75], v36 offset:57088
    ds_read_b128 v[68:71], v29 offset:53248
    v_mfma_f32_32x32x16_bf16 v[100:115], v[52:55], v[48:51], v[100:115]
    ds_read_b64_tr_b16 v[76:77], v40 offset:53760
    ds_read_b64_tr_b16 v[78:79], v41 offset:53760
    v_mfma_f32_32x32x16_bf16 v[116:131], v[56:59], v[44:47], v[116:131]
    buffer_load_dwordx4 v18, s[8:11], s40 offen offset:2048 lds
    v_mfma_f32_32x32x16_bf16 v[132:147], v[56:59], v[48:51], v[132:147]
    buffer_load_dwordx4 v19, s[8:11], s40 offen offset:3072 lds
    s_waitcnt lgkmcnt(0)
    v_mfma_f32_32x32x16_bf16 v[84:99], v[72:75], v[64:67], v[84:99]
    ds_read_b128 v[44:47], v26 offset:53248
    ds_read_b64_tr_b16 v[52:53], v36 offset:59392
    ds_read_b64_tr_b16 v[54:55], v36 offset:60160
    ds_read_b128 v[48:51], v30 offset:53248
    v_mfma_f32_32x32x16_bf16 v[100:115], v[72:75], v[68:71], v[100:115]
    ds_read_b64_tr_b16 v[56:57], v40 offset:54272
    ds_read_b64_tr_b16 v[58:59], v41 offset:54272
    v_mfma_f32_32x32x16_bf16 v[116:131], v[76:79], v[64:67], v[116:131]
    s_add_u32 m0, s51, 0
    s_nop 0
    buffer_load_dwordx4 v225, s[12:15], s41 offen lds
    v_mfma_f32_32x32x16_bf16 v[132:147], v[76:79], v[68:71], v[132:147]
    s_mov_b32 exec_hi, 0
    buffer_load_dwordx4 v227, s[12:15], s41 offen offset:1024 lds
    s_mov_b32 exec_hi, -1
    s_waitcnt lgkmcnt(0)
    v_mfma_f32_32x32x16_bf16 v[84:99], v[52:55], v[44:47], v[84:99]
    ds_read_b128 v[64:67], v27 offset:53248
    ds_read_b64_tr_b16 v[72:73], v36 offset:62464
    ds_read_b64_tr_b16 v[74:75], v36 offset:63232
    ds_read_b128 v[68:71], v31 offset:53248
    v_mfma_f32_32x32x16_bf16 v[100:115], v[52:55], v[48:51], v[100:115]
    ds_read_b64_tr_b16 v[76:77], v40 offset:54784
    ds_read_b64_tr_b16 v[78:79], v41 offset:54784
    v_mfma_f32_32x32x16_bf16 v[116:131], v[56:59], v[44:47], v[116:131]
    s_add_u32 m0, s52, 0
    s_mov_b32 exec_hi, 0
    buffer_load_dwordx4 v20, s[8:11], s40 offen lds
    s_mov_b32 exec_hi, -1
    s_add_u32 m0, s53, 0
    s_mov_b32 exec_hi, 0
    buffer_load_dwordx4 v229, s[20:23], s42 offen lds
    s_mov_b32 exec_hi, -1
    s_add_u32 s49, s49, 1
    s_and_b32 s49, s49, 7
    s_lshl_b32 s40, s49, 7
    s_mul_i32 s42, s49, 176128
    s_mul_i32 s41, s49, 196608
    s_cmp_lg_u32 s34, 5
    s_cbranch_scc1 K1_A0_P1
    v_lshlrev_b32 v4, 2, v1
    global_load_dword v223, v4, s[76:77] sc1
K1_A0_P1:
    v_mfma_f32_32x32x16_bf16 v[132:147], v[56:59], v[48:51], v[132:147]
    v_add_u32 v24, 106496, v24
    v_add_u32 v25, 106496, v25
    v_add_u32 v26, 106496, v26
    v_add_u32 v27, 106496, v27
    v_add_u32 v28, 106496, v28
    v_add_u32 v29, 106496, v29
    v_add_u32 v30, 106496, v30
    v_add_u32 v31, 106496, v31
    v_add_u32 v36, 106496, v36
    v_add_u32 v40, 106496, v40
    v_add_u32 v41, 106496, v41
    s_waitcnt vmcnt(8) lgkmcnt(0)
    s_barrier
    v_mfma_f32_32x32x16_bf16 v[84:99], v[72:75], v[64:67], v[84:99]
    ds_read_b128 v[44:47], v24 offset:0
    ds_read_b64_tr_b16 v[52:53], v36 offset:0
    ds_read_b64_tr_b16 v[54:55], v36 offset:768
    ds_read_b128 v[48:51], v28 offset:0
    v_mfma_f32_32x32x16_bf16 v[100:115], v[72:75], v[68:71], v[100:115]
    ds_read_b64_tr_b16 v[56:57], v40 offset:0
    ds_read_b64_tr_b16 v[58:59], v41 offset:0
    v_mfma_f32_32x32x16_bf16 v[116:131], v[76:79], v[64:67], v[116:131]
    s_add_u32 m0, s50, 53248
    s_nop 0
    buffer_load_dwordx4 v16, s[8:11], s40 offen offset:0 lds
    v_mfma_f32_32x32x16_bf16 v[132:147], v[76:79], v[68:71], v[132:147]
    buffer_load_dwordx4 v17, s[8:11], s40 offen offset:1024 lds
    s_waitcnt lgkmcnt(0)
    v_mfma_f32_32x32x16_bf16 v[84:99], v[52:55], v[44:47], v[84:99]
    ds_read_b128 v[64:67], v25 offset:0
    ds_read_b64_tr_b16 v[72:73], v36 offset:3072
    ds_read_b64_tr_b16 v[74:75], v36 offset:3840
    ds_read_b128 v[68:71], v29 offset:0
    v_mfma_f32_32x32x16_bf16 v[100:115], v[52:55], v[48:51], v[100:115]
    ds_read_b64_tr_b16 v[76:77], v40 offset:512
    ds_read_b64_tr_b16 v[78:79], v41 offset:512
    v_mfma_f32_32x32x16_bf16 v[116:131], v[56:59], v[44:47], v[116:131]
    buffer_load_dwordx4 v18, s[8:11], s40 offen offset:2048 lds
    v_mfma_f32_32x32x16_bf16 v[132:147], v[56:59], v[48:51], v[132:147]
    buffer_load_dwordx4 v19, s[8:11], s40 offen offset:3072 lds
    s_waitcnt lgkmcnt(0)
    v_mfma_f32_32x32x16_bf16 v[84:99], v[72:75], v[64:67], v[84:99]
    ds_read_b128 v[44:47], v26 offset:0
    ds_read_b64_tr_b16 v[52:53], v36 offset:6144
    ds_read_b64_tr_b16 v[54:55], v36 offset:6912
    ds_read_b128 v[48:51], v30 offset:0
    v_mfma_f32_32x32x16_bf16 v[100:115], v[72:75], v[68:71], v[100:115]
    ds_read_b64_tr_b16 v[56:57], v40 offset:1024
    ds_read_b64_tr_b16 v[58:59], v41 offset:1024
    v_mfma_f32_32x32x16_bf16 v[116:131], v[76:79], v[64:67], v[116:131]
    s_add_u32 m0, s51, 53248
    s_nop 0
    buffer_load_dwordx4 v225, s[12:15], s41 offen lds
    v_mfma_f32_32x32x16_bf16 v[132:147], v[76:79], v[68:71], v[132:147]
    s_mov_b32 exec_hi, 0
    buffer_load_dwordx4 v227, s[12:15], s41 offen offset:1024 lds
    s_mov_b32 exec_hi, -1
    s_waitcnt lgkmcnt(0)
    v_mfma_f32_32x32x16_bf16 v[84:99], v[52:55], v[44:47], v[84:99]
    ds_read_b128 v[64:67], v27 offset:0
    ds_read_b64_tr_b16 v[72:73], v36 offset:9216
    ds_read_b64_tr_b16 v[74:75], v36 offset:9984
    ds_read_b128 v[68:71], v31 offset:0
    v_mfma_f32_32x32x16_bf16 v[100:115], v[52:55], v[48:51], v[100:115]
    ds_read_b64_tr_b16 v[76:77], v40 offset:1536
    ds_read_b64_tr_b16 v[78:79], v41 offset:1536
    v_mfma_f32_32x32x16_bf16 v[116:131], v[56:59], v[44:47], v[116:131]
    s_add_u32 m0, s52, 53248
    s_mov_b32 exec_hi, 0
    buffer_load_dwordx4 v20, s[8:11], s40 offen lds
    s_mov_b32 exec_hi, -1
    s_add_u32 m0, s53, 53248
    s_mov_b32 exec_hi, 0
    buffer_load_dwordx4 v229, s[20:23], s42 offen lds
    s_mov_b32 exec_hi, -1
    s_cmp_lg_u32 s34, 5
    s_cbranch_scc1 K1_A0_P2
    s_waitcnt vmcnt(8)
    v_and_b32 v11, v223, v221
    v_cmp_ne_u32 vcc, v11, v221
    v_mov_b32 v4, 162816
    v_mov_b32 v5, 0
    s_nop 2
    s_cbranch_vccnz K1_A0_SLOW
K1_A0_RDY:
    ds_write_b32 v4, v5
K1_A0_P2:
    v_mfma_f32_32x32x16_bf16 v[132:147], v[56:59], v[48:51], v[132:147]
    v_subrev_u32 v24, 106496, v24
    v_subrev_u32 v25, 106496, v25
    v_subrev_u32 v26, 106496, v26
    v_subrev_u32 v27, 106496, v27
    v_subrev_u32 v28, 106496, v28
    v_subrev_u32 v29, 106496, v29
    v_subrev_u32 v30, 106496, v30
    v_subrev_u32 v31, 106496, v31
    v_subrev_u32 v36, 106496, v36
    v_subrev_u32 v40, 106496, v40
    v_subrev_u32 v41, 106496, v41
    s_waitcnt vmcnt(8) lgkmcnt(0)
    s_barrier
    v_mfma_f32_32x32x16_bf16 v[84:99], v[72:75], v[64:67], v[84:99]
    ds_read_b128 v[44:47], v24 offset:0
    ds_read_b64_tr_b16 v[52:53], v36 offset:0
    ds_read_b64_tr_b16 v[54:55], v36 offset:768
    ds_read_b128 v[48:51], v28 offset:0
    v_mfma_f32_32x32x16_bf16 v[100:115], v[72:75], v[68:71], v[100:115]
    ds_read_b64_tr_b16 v[56:57], v40 offset:0
    ds_read_b64_tr_b16 v[58:59], v41 offset:0
    v_mfma_f32_32x32x16_bf16 v[116:131], v[76:79], v[64:67], v[116:131]
    v_mov_b32 v11, 162816
    ds_read_b32 v11, v11
    s_mul_i32 s46, s48, 5120
    s_add_u32 s46, s46, 8388608
    s_lshl_b32 s47, s37, 8
    s_add_u32 s47, s47, s46
    v_lshl_add_u32 v4, v1, 2, s47
    v_add_u32 v6, 2560, v4
    s_lshl_b32 s46, s35, 8
    v_mfma_f32_32x32x16_bf16 v[132:147], v[76:79], v[68:71], v[132:147]
    s_lshl_b32 s47, s38, 6
    s_add_u32 s46, s46, s47
    s_lshl_b32 s47, s37, 5
    s_add_u32 s46, s46, s47
    v_add_u32 v8, s46, v2
    v_lshlrev_b32 v8, 3, v8
    v_add_u32 v8, 9437184, v8
    v_xor_b32 v9, 256, v8
    s_waitcnt lgkmcnt(0)
    v_mfma_f32_32x32x16_bf16 v[84:99], v[52:55], v[44:47], v[84:99]
    ds_read_b128 v[64:67], v25 offset:0
    ds_read_b64_tr_b16 v[72:73], v36 offset:3072
    ds_read_b64_tr_b16 v[74:75], v36 offset:3840
    ds_read_b128 v[68:71], v29 offset:0
    v_mfma_f32_32x32x16_bf16 v[100:115], v[52:55], v[48:51], v[100:115]
    ds_read_b64_tr_b16 v[76:77], v40 offset:512
    ds_read_b64_tr_b16 v[78:79], v41 offset:512
    v_mfma_f32_32x32x16_bf16 v[116:131], v[56:59], v[44:47], v[116:131]
    v_readfirstlane_b32 s46, v11
    s_nop 3
    s_cmp_lg_u32 s46, 0
    s_cbranch_scc1 K1_A0_FB
    global_load_dword v232, v4, s[32:33] offset:0 sc1
    global_load_dword v233, v4, s[32:33] offset:640 sc1
    global_load_dword v234, v4, s[32:33] offset:1280 sc1
    global_load_dword v235, v4, s[32:33] offset:1920 sc1
    global_load_dword v236, v6, s[32:33] offset:0 sc1
    global_load_dword v237, v6, s[32:33] offset:640 sc1
    global_load_dword v238, v6, s[32:33] offset:1280 sc1
    global_load_dword v239, v6, s[32:33] offset:1920 sc1
    global_load_dwordx2 v[248:249], v8, s[32:33] sc1
    global_load_dwordx2 v[250:251], v9, s[32:33] sc1
K1_A0_HB:
    v_mfma_f32_32x32x16_bf16 v[132:147], v[56:59], v[48:51], v[132:147]
    s_waitcnt lgkmcnt(0)
    v_mfma_f32_32x32x16_bf16 v[84:99], v[72:75], v[64:67], v[84:99]
    ds_read_b128 v[44:47], v26 offset:0
    ds_read_b64_tr_b16 v[52:53], v36 offset:6144
    ds_read_b64_tr_b16 v[54:55], v36 offset:6912
    ds_read_b128 v[48:51], v30 offset:0
    v_mfma_f32_32x32x16_bf16 v[100:115], v[72:75], v[68:71], v[100:115]
    ds_read_b64_tr_b16 v[56:57], v40 offset:1024
    ds_read_b64_tr_b16 v[58:59], v41 offset:1024
    v_mfma_f32_32x32x16_bf16 v[116:131], v[76:79], v[64:67], v[116:131]
    v_mfma_f32_32x32x16_bf16 v[132:147], v[76:79], v[68:71], v[132:147]
    s_waitcnt lgkmcnt(0)
    v_mfma_f32_32x32x16_bf16 v[84:99], v[52:55], v[44:47], v[84:99]
    ds_read_b128 v[64:67], v27 offset:0
    ds_read_b64_tr_b16 v[72:73], v36 offset:9216
    ds_read_b64_tr_b16 v[74:75], v36 offset:9984
    ds_read_b128 v[68:71], v31 offset:0
    v_mfma_f32_32x32x16_bf16 v[100:115], v[52:55], v[48:51], v[100:115]
    ds_read_b64_tr_b16 v[76:77], v40 offset:1536
    ds_read_b64_tr_b16 v[78:79], v41 offset:1536
    v_mfma_f32_32x32x16_bf16 v[116:131], v[56:59], v[44:47], v[116:131]
    v_mfma_f32_32x32x16_bf16 v[132:147], v[56:59], v[48:51], v[132:147]
    s_waitcnt vmcnt(10) lgkmcnt(0)
    s_barrier
    v_mfma_f32_32x32x16_bf16 v[84:99], v[72:75], v[64:67], v[84:99]
    ds_read_b128 v[44:47], v24 offset:53248
    ds_read_b64_tr_b16 v[52:53], v36 offset:53248
    ds_read_b64_tr_b16 v[54:55], v36 offset:54016
    ds_read_b128 v[48:51], v28 offset:53248
    v_mfma_f32_32x32x16_bf16 v[100:115], v[72:75], v[68:71], v[100:115]
    ds_read_b64_tr_b16 v[56:57], v40 offset:53248
    ds_read_b64_tr_b16 v[58:59], v41 offset:53248
    v_mfma_f32_32x32x16_bf16 v[116:131], v[76:79], v[64:67], v[116:131]
    s_cmp_lt_u32 s34, 4
    s_cbranch_scc1 K1_A0_PR
    s_setprio 1
K1_A0_PR:
    v_mfma_f32_32x32x16_bf16 v[132:147], v[76:79], v[68:71], v[132:147]
    s_waitcnt lgkmcnt(0)
    v_mfma_f32_32x32x16_bf16 v[84:99], v[52:55], v[44:47], v[84:99]
    ds_read_b128 v[64:67], v25 offset:53248
    ds_read_b64_tr_b16 v[72:73], v36 offset:56320
    ds_read_b64_tr_b16 v[74:75], v36 offset:57088
    ds_read_b128 v[68:71], v29 offset:53248
    v_mfma_f32_32x32x16_bf16 v[100:115], v[52:55], v[48:51], v[100:115]
    ds_read_b64_tr_b16 v[76:77], v40 offset:53760
    ds_read_b64_tr_b16 v[78:79], v41 offset:53760
    v_mfma_f32_32x32x16_bf16 v[116:131], v[56:59], v[44:47], v[116:131]
    s_waitcnt vmcnt(0)
    v_add_f32 v232, v232, v233
    v_add_f32 v234, v234, v235
    v_add_f32 v236, v236, v237
    v_add_f32 v238, v238, v239
    v_add_f32 v232, v232, v234
    v_mfma_f32_32x32x16_bf16 v[132:147], v[56:59], v[48:51], v[132:147]
    v_add_f32 v236, v236, v238
    v_add_f32 v232, v232, v236
    s_lshl_b32 s47, s34, 9
    v_lshl_add_u32 v8, v1, 2, s47
    v_lshl_add_u32 v9, v3, 4, s47
    ds_write_b32 v8, v232
    s_waitcnt lgkmcnt(0)
    v_mfma_f32_32x32x16_bf16 v[84:99], v[72:75], v[64:67], v[84:99]
    ds_read_b128 v[44:47], v26 offset:53248
    ds_read_b64_tr_b16 v[52:53], v36 offset:59392
    ds_read_b64_tr_b16 v[54:55], v36 offset:60160
    ds_read_b128 v[48:51], v30 offset:53248
    v_mfma_f32_32x32x16_bf16 v[100:115], v[72:75], v[68:71], v[100:115]
    ds_read_b64_tr_b16 v[56:57], v40 offset:54272
    ds_read_b64_tr_b16 v[58:59], v41 offset:54272
    v_mfma_f32_32x32x16_bf16 v[116:131], v[76:79], v[64:67], v[116:131]
    ds_read_b128 v[164:167], v9 offset:0
    ds_read_b128 v[168:171], v9 offset:32
    ds_read_b128 v[172:175], v9 offset:64
    ds_read_b128 v[176:179], v9 offset:96
    v_mfma_f32_32x32x16_bf16 v[132:147], v[76:79], v[68:71], v[132:147]
    ds_read_b128 v[180:183], v9 offset:128
    ds_read_b128 v[184:187], v9 offset:160
    ds_read_b128 v[188:191], v9 offset:192
    ds_read_b128 v[192:195], v9 offset:224
    s_waitcnt lgkmcnt(0)
    v_mfma_f32_32x32x16_bf16 v[84:99], v[52:55], v[44:47], v[84:99]
    ds_read_b128 v[64:67], v27 offset:53248
    ds_read_b64_tr_b16 v[72:73], v36 offset:62464
    ds_read_b64_tr_b16 v[74:75], v36 offset:63232
    ds_read_b128 v[68:71], v31 offset:53248
    v_mfma_f32_32x32x16_bf16 v[100:115], v[52:55], v[48:51], v[100:115]
    ds_read_b64_tr_b16 v[76:77], v40 offset:54784
    ds_read_b64_tr_b16 v[78:79], v41 offset:54784
    v_mfma_f32_32x32x16_bf16 v[116:131], v[56:59], v[44:47], v[116:131]
    s_mov_b32 s47, 0x3b000000
    v_mul_f32 v212, 0xbb000000, v248
    v_mul_f32 v12, v212, v212
    v_fma_f32 v12, v249, s47, -v12
    v_max_f32 v12, 0, v12
    v_add_f32 v213, 0x3727c5ac, v12
    v_rsq_f32 v218, v213
    s_nop 0
    v_mul_f32 v224, 0xbfb8aa3b, v218
    v_mfma_f32_32x32x16_bf16 v[132:147], v[56:59], v[48:51], v[132:147]
    v_mul_f32 v214, 0xbb000000, v250
    v_mul_f32 v12, v214, v214
    v_fma_f32 v12, v251, s47, -v12
    v_max_f32 v12, 0, v12
    v_add_f32 v215, 0x3727c5ac, v12
    v_rsq_f32 v220, v215
    s_nop 0
    v_mul_f32 v226, 0xbfb8aa3b, v220
    s_waitcnt lgkmcnt(0)
    v_mfma_f32_32x32x16_bf16 v[84:99], v[72:75], v[64:67], v[84:99]
    v_mfma_f32_32x32x16_bf16 v[100:115], v[72:75], v[68:71], v[100:115]
    v_mfma_f32_32x32x16_bf16 v[116:131], v[76:79], v[64:67], v[116:131]
    v_mfma_f32_32x32x16_bf16 v[132:147], v[76:79], v[68:71], v[132:147]
    s_nop 7
    v_mul_u32_u24 v4, 4608, v3
    v_lshl_add_u32 v4, v2, 4, v4
    v_add_u32 v4, 106496, v4
    s_lshl_b32 s46, s38, 10
    s_lshl_b32 s47, s37, 9
    s_add_u32 s46, s46, s47
    s_xor_b32 s47, s46, 512
    v_add_u32 v5, s46, v4
    v_add_u32 v6, s47, v4
    s_lshl_b32 s60, s35, 2
    s_add_u32 s60, s60, s38
    s_mul_i32 s60, s60, 241664
    s_lshl_b32 s47, s37, 10
    s_add_u32 s60, s60, s47
    s_xor_b32 s61, s60, 1024
    s_add_u32 s46, s57, 32
    s_lshl_b32 s46, s46, 11
    s_add_u32 s62, s60, s46
    s_add_u32 s63, s61, s46
    v_pk_fma_f32 v[84:85], v[212:213], v[164:165], v[84:85] op_sel:[0,0,0] op_sel_hi:[0,1,1]
    v_pk_fma_f32 v[86:87], v[212:213], v[166:167], v[86:87] op_sel:[0,0,0] op_sel_hi:[0,1,1]
    v_pk_fma_f32 v[88:89], v[212:213], v[168:169], v[88:89] op_sel:[0,0,0] op_sel_hi:[0,1,1]
    v_pk_fma_f32 v[90:91], v[212:213], v[170:171], v[90:91] op_sel:[0,0,0] op_sel_hi:[0,1,1]
    v_pk_fma_f32 v[92:93], v[212:213], v[172:173], v[92:93] op_sel:[0,0,0] op_sel_hi:[0,1,1]
    v_pk_fma_f32 v[94:95], v[212:213], v[174:175], v[94:95] op_sel:[0,0,0] op_sel_hi:[0,1,1]
    v_pk_fma_f32 v[96:97], v[212:213], v[176:177], v[96:97] op_sel:[0,0,0] op_sel_hi:[0,1,1]
    v_pk_fma_f32 v[98:99], v[212:213], v[178:179], v[98:99] op_sel:[0,0,0] op_sel_hi:[0,1,1]
    v_pk_mul_f32 v[84:85], v[218:219], v[84:85] op_sel:[0,0] op_sel_hi:[0,1]
    v_pk_mul_f32 v[86:87], v[218:219], v[86:87] op_sel:[0,0] op_sel_hi:[0,1]
    v_pk_mul_f32 v[88:89], v[218:219], v[88:89] op_sel:[0,0] op_sel_hi:[0,1]
    v_pk_mul_f32 v[90:91], v[218:219], v[90:91] op_sel:[0,0] op_sel_hi:[0,1]
    v_pk_mul_f32 v[92:93], v[218:219], v[92:93] op_sel:[0,0] op_sel_hi:[0,1]
    v_pk_mul_f32 v[94:95], v[218:219], v[94:95] op_sel:[0,0] op_sel_hi:[0,1]
    v_pk_mul_f32 v[96:97], v[218:219], v[96:97] op_sel:[0,0] op_sel_hi:[0,1]
    v_pk_mul_f32 v[98:99], v[218:219], v[98:99] op_sel:[0,0] op_sel_hi:[0,1]
    v_cvt_pk_bf16_f32 v84, v84, v85
    v_cvt_pk_bf16_f32 v85, v86, v87
    v_cvt_pk_bf16_f32 v86, v88, v89
    v_cvt_pk_bf16_f32 v87, v90, v91
    v_cvt_pk_bf16_f32 v88, v92, v93
    v_cvt_pk_bf16_f32 v89, v94, v95
    v_cvt_pk_bf16_f32 v90, v96, v97
    v_cvt_pk_bf16_f32 v91, v98, v99
    ds_write_b128 v5, v[84:87] offset:512
    ds_write_b128 v5, v[88:91] offset:9728
    v_pk_fma_f32 v[100:101], v[214:215], v[164:165], v[100:101] op_sel:[0,0,0] op_sel_hi:[0,1,1]
    v_pk_fma_f32 v[102:103], v[214:215], v[166:167], v[102:103] op_sel:[0,0,0] op_sel_hi:[0,1,1]
    v_pk_fma_f32 v[104:105], v[214:215], v[168:169], v[104:105] op_sel:[0,0,0] op_sel_hi:[0,1,1]
    v_pk_fma_f32 v[106:107], v[214:215], v[170:171], v[106:107] op_sel:[0,0,0] op_sel_hi:[0,1,1]
    v_pk_fma_f32 v[108:109], v[214:215], v[172:173], v[108:109] op_sel:[0,0,0] op_sel_hi:[0,1,1]
    v_pk_fma_f32 v[110:111], v[214:215], v[174:175], v[110:111] op_sel:[0,0,0] op_sel_hi:[0,1,1]
    v_pk_fma_f32 v[112:113], v[214:215], v[176:177], v[112:113] op_sel:[0,0,0] op_sel_hi:[0,1,1]
    v_pk_fma_f32 v[114:115], v[214:215], v[178:179], v[114:115] op_sel:[0,0,0] op_sel_hi:[0,1,1]
    v_pk_mul_f32 v[100:101], v[220:221], v[100:101] op_sel:[0,0] op_sel_hi:[0,1]
    v_pk_mul_f32 v[102:103], v[220:221], v[102:103] op_sel:[0,0] op_sel_hi:[0,1]
    v_pk_mul_f32 v[104:105], v[220:221], v[104:105] op_sel:[0,0] op_sel_hi:[0,1]
    v_pk_mul_f32 v[106:107], v[220:221], v[106:107] op_sel:[0,0] op_sel_hi:[0,1]
    v_pk_mul_f32 v[108:109], v[220:221], v[108:109] op_sel:[0,0] op_sel_hi:[0,1]
    v_pk_mul_f32 v[110:111], v[220:221], v[110:111] op_sel:[0,0] op_sel_hi:[0,1]
    v_pk_mul_f32 v[112:113], v[220:221], v[112:113] op_sel:[0,0] op_sel_hi:[0,1]
    v_pk_mul_f32 v[114:115], v[220:221], v[114:115] op_sel:[0,0] op_sel_hi:[0,1]
    v_cvt_pk_bf16_f32 v100, v100, v101
    v_cvt_pk_bf16_f32 v101, v102, v103
    v_cvt_pk_bf16_f32 v102, v104, v105
    v_cvt_pk_bf16_f32 v103, v106, v107
    v_cvt_pk_bf16_f32 v104, v108, v109
    v_cvt_pk_bf16_f32 v105, v110, v111
    v_cvt_pk_bf16_f32 v106, v112, v113
    v_cvt_pk_bf16_f32 v107, v114, v115
    ds_write_b128 v6, v[100:103] offset:512
    ds_write_b128 v6, v[104:107] offset:9728
    s_waitcnt lgkmcnt(0)
    s_barrier
    v_pk_fma_f32 v[116:117], v[212:213], v[180:181], v[116:117] op_sel:[0,0,0] op_sel_hi:[0,1,1]
    v_pk_fma_f32 v[118:119], v[212:213], v[182:183], v[118:119] op_sel:[0,0,0] op_sel_hi:[0,1,1]
    v_pk_fma_f32 v[120:121], v[212:213], v[184:185], v[120:121] op_sel:[0,0,0] op_sel_hi:[0,1,1]
    v_pk_fma_f32 v[122:123], v[212:213], v[186:187], v[122:123] op_sel:[0,0,0] op_sel_hi:[0,1,1]
    v_pk_fma_f32 v[124:125], v[212:213], v[188:189], v[124:125] op_sel:[0,0,0] op_sel_hi:[0,1,1]
    v_pk_fma_f32 v[126:127], v[212:213], v[190:191], v[126:127] op_sel:[0,0,0] op_sel_hi:[0,1,1]
    v_pk_fma_f32 v[128:129], v[212:213], v[192:193], v[128:129] op_sel:[0,0,0] op_sel_hi:[0,1,1]
    v_pk_fma_f32 v[130:131], v[212:213], v[194:195], v[130:131] op_sel:[0,0,0] op_sel_hi:[0,1,1]
    v_pk_mul_f32 v[232:233], v[224:225], v[116:117] op_sel:[0,0] op_sel_hi:[0,1]
    v_pk_mul_f32 v[234:235], v[224:225], v[118:119] op_sel:[0,0] op_sel_hi:[0,1]
    v_pk_mul_f32 v[236:237], v[224:225], v[120:121] op_sel:[0,0] op_sel_hi:[0,1]
    v_pk_mul_f32 v[238:239], v[224:225], v[122:123] op_sel:[0,0] op_sel_hi:[0,1]
    v_exp_f32 v232, v232
    v_exp_f32 v233, v233
    v_exp_f32 v234, v234
    v_exp_f32 v235, v235
    v_exp_f32 v236, v236
    v_exp_f32 v237, v237
    v_exp_f32 v238, v238
    v_exp_f32 v239, v239
    v_pk_mul_f32 v[116:117], v[116:117], v[124:125] op_sel:[0,0] op_sel_hi:[1,1]
    v_pk_mul_f32 v[118:119], v[118:119], v[126:127] op_sel:[0,0] op_sel_hi:[1,1]
    v_pk_mul_f32 v[120:121], v[120:121], v[128:129] op_sel:[0,0] op_sel_hi:[1,1]
    v_pk_mul_f32 v[122:123], v[122:123], v[130:131] op_sel:[0,0] op_sel_hi:[1,1]
    v_fma_f32 v232, v232, v213, v213
    v_fma_f32 v233, v233, v213, v213
    v_fma_f32 v234, v234, v213, v213
    v_fma_f32 v235, v235, v213, v213
    v_fma_f32 v236, v236, v213, v213
    v_fma_f32 v237, v237, v213, v213
    v_fma_f32 v238, v238, v213, v213
    v_fma_f32 v239, v239, v213, v213
    v_rcp_f32 v232, v232
    v_rcp_f32 v233, v233
    v_rcp_f32 v234, v234
    v_rcp_f32 v235, v235
    v_rcp_f32 v236, v236
    v_rcp_f32 v237, v237
    v_rcp_f32 v238, v238
    v_rcp_f32 v239, v239
    s_nop 0
    v_pk_mul_f32 v[116:117], v[116:117], v[232:233] op_sel:[0,0] op_sel_hi:[1,1]
    v_pk_mul_f32 v[118:119], v[118:119], v[234:235] op_sel:[0,0] op_sel_hi:[1,1]
    v_pk_mul_f32 v[120:121], v[120:121], v[236:237] op_sel:[0,0] op_sel_hi:[1,1]
    v_pk_mul_f32 v[122:123], v[122:123], v[238:239] op_sel:[0,0] op_sel_hi:[1,1]
    v_cvt_pk_bf16_f32 v24, v116, v117
    v_cvt_pk_bf16_f32 v25, v118, v119
    v_cvt_pk_bf16_f32 v26, v120, v121
    v_cvt_pk_bf16_f32 v27, v122, v123
    buffer_store_dwordx4 v[24:27], v219, s[24:27], s62 offen sc0 sc1
    v_pk_fma_f32 v[132:133], v[214:215], v[180:181], v[132:133] op_sel:[0,0,0] op_sel_hi:[0,1,1]
    v_pk_fma_f32 v[134:135], v[214:215], v[182:183], v[134:135] op_sel:[0,0,0] op_sel_hi:[0,1,1]
    v_pk_fma_f32 v[136:137], v[214:215], v[184:185], v[136:137] op_sel:[0,0,0] op_sel_hi:[0,1,1]
    v_pk_fma_f32 v[138:139], v[214:215], v[186:187], v[138:139] op_sel:[0,0,0] op_sel_hi:[0,1,1]
    v_pk_fma_f32 v[140:141], v[214:215], v[188:189], v[140:141] op_sel:[0,0,0] op_sel_hi:[0,1,1]
    v_pk_fma_f32 v[142:143], v[214:215], v[190:191], v[142:143] op_sel:[0,0,0] op_sel_hi:[0,1,1]
    v_pk_fma_f32 v[144:145], v[214:215], v[192:193], v[144:145] op_sel:[0,0,0] op_sel_hi:[0,1,1]
    v_pk_fma_f32 v[146:147], v[214:215], v[194:195], v[146:147] op_sel:[0,0,0] op_sel_hi:[0,1,1]
    v_pk_mul_f32 v[232:233], v[226:227], v[132:133] op_sel:[0,0] op_sel_hi:[0,1]
    v_pk_mul_f32 v[234:235], v[226:227], v[134:135] op_sel:[0,0] op_sel_hi:[0,1]
    v_pk_mul_f32 v[236:237], v[226:227], v[136:137] op_sel:[0,0] op_sel_hi:[0,1]
    v_pk_mul_f32 v[238:239], v[226:227], v[138:139] op_sel:[0,0] op_sel_hi:[0,1]
    v_exp_f32 v232, v232
    v_exp_f32 v233, v233
    v_exp_f32 v234, v234
    v_exp_f32 v235, v235
    v_exp_f32 v236, v236
    v_exp_f32 v237, v237
    v_exp_f32 v238, v238
    v_exp_f32 v239, v239
    v_pk_mul_f32 v[132:133], v[132:133], v[140:141] op_sel:[0,0] op_sel_hi:[1,1]
    v_pk_mul_f32 v[134:135], v[134:135], v[142:143] op_sel:[0,0] op_sel_hi:[1,1]
    v_pk_mul_f32 v[136:137], v[136:137], v[144:145] op_sel:[0,0] op_sel_hi:[1,1]
    v_pk_mul_f32 v[138:139], v[138:139], v[146:147] op_sel:[0,0] op_sel_hi:[1,1]
    v_fma_f32 v232, v232, v215, v215
    v_fma_f32 v233, v233, v215, v215
    v_fma_f32 v234, v234, v215, v215
    v_fma_f32 v235, v235, v215, v215
    v_fma_f32 v236, v236, v215, v215
    v_fma_f32 v237, v237, v215, v215
    v_fma_f32 v238, v238, v215, v215
    v_fma_f32 v239, v239, v215, v215
    v_rcp_f32 v232, v232
    v_rcp_f32 v233, v233
    v_rcp_f32 v234, v234
    v_rcp_f32 v235, v235
    v_rcp_f32 v236, v236
    v_rcp_f32 v237, v237
    v_rcp_f32 v238, v238
    v_rcp_f32 v239, v239
    s_nop 0
    v_pk_mul_f32 v[132:133], v[132:133], v[232:233] op_sel:[0,0] op_sel_hi:[1,1]
    v_pk_mul_f32 v[134:135], v[134:135], v[234:235] op_sel:[0,0] op_sel_hi:[1,1]
    v_pk_mul_f32 v[136:137], v[136:137], v[236:237] op_sel:[0,0] op_sel_hi:[1,1]
    v_pk_mul_f32 v[138:139], v[138:139], v[238:239] op_sel:[0,0] op_sel_hi:[1,1]
    v_cvt_pk_bf16_f32 v28, v132, v133
    v_cvt_pk_bf16_f32 v29, v134, v135
    v_cvt_pk_bf16_f32 v30, v136, v137
    v_cvt_pk_bf16_f32 v31, v138, v139
    buffer_store_dwordx4 v[28:31], v219, s[24:27], s63 offen sc0 sc1
    s_branch K1_ATTN2
K1_ATTN:
    s_waitcnt lgkmcnt(0)
    s_barrier
K1_ATTN2:
    v_mul_u32_u24 v4, 9216, v3
    v_lshl_add_u32 v9, v2, 4, v4
    s_lshl_b32 s46, s34, 9
    s_add_u32 s47, s46, 4384
    s_add_u32 s46, s46, 106784
    v_add3_u32 v10, v9, v4, s47
    v_add_u32 v4, s46, v9
    ds_read_b128 v[164:167], v4 offset:224
    ds_read_b128 v[168:171], v4 offset:4832
    ds_read_b128 v[44:47], v4 offset:18656
    ds_read_b128 v[48:51], v4 offset:23264
    ds_read_b128 v[52:55], v4 offset:18624
    ds_read_b128 v[56:59], v4 offset:23232
    ds_read_b128 v[60:63], v4 offset:18592
    ds_read_b128 v[64:67], v4 offset:23200
    ds_read_b128 v[68:71], v4 offset:18560
    ds_read_b128 v[72:75], v4 offset:23168
    ds_read_b128 v[76:79], v4 offset:18528
    ds_read_b128 v[80:83], v4 offset:23136
    ds_read_b128 v[84:87], v4 offset:18496
    ds_read_b128 v[88:91], v4 offset:23104
    v_mov_b32 v232, 0
    v_mov_b32 v233, 0
    v_mov_b32 v234, 0
    v_mov_b32 v235, 0
    v_mov_b32 v236, 0
    v_mov_b32 v237, 0
    v_mov_b32 v238, 0
    v_mov_b32 v239, 0
    s_waitcnt lgkmcnt(10)
    v_dot2c_f32_bf16 v232, v164, v44
    v_dot2c_f32_bf16 v232, v165, v45
    v_dot2c_f32_bf16 v232, v166, v46
    v_dot2c_f32_bf16 v232, v167, v47
    v_dot2c_f32_bf16 v232, v168, v48
    v_dot2c_f32_bf16 v232, v169, v49
    v_dot2c_f32_bf16 v232, v170, v50
    v_dot2c_f32_bf16 v232, v171, v51
    ds_read_b128 v[92:95], v4 offset:18464
    ds_read_b128 v[96:99], v4 offset:23072
    s_waitcnt lgkmcnt(10)
    v_dot2c_f32_bf16 v233, v164, v52
    v_dot2c_f32_bf16 v233, v165, v53
    v_dot2c_f32_bf16 v233, v166, v54
    v_dot2c_f32_bf16 v233, v167, v55
    v_dot2c_f32_bf16 v233, v168, v56
    v_dot2c_f32_bf16 v233, v169, v57
    v_dot2c_f32_bf16 v233, v170, v58
    v_dot2c_f32_bf16 v233, v171, v59
    ds_read_b128 v[100:103], v4 offset:18432
    ds_read_b128 v[104:107], v4 offset:23040
    s_waitcnt lgkmcnt(10)
    v_dot2c_f32_bf16 v234, v164, v60
    v_dot2c_f32_bf16 v234, v165, v61
    v_dot2c_f32_bf16 v234, v166, v62
    v_dot2c_f32_bf16 v234, v167, v63
    v_dot2c_f32_bf16 v234, v168, v64
    v_dot2c_f32_bf16 v234, v169, v65
    v_dot2c_f32_bf16 v234, v170, v66
    v_dot2c_f32_bf16 v234, v171, v67
    ds_read_b128 v[108:111], v10 offset:224
    ds_read_b128 v[112:115], v10 offset:4832
    s_waitcnt lgkmcnt(10)
    v_dot2c_f32_bf16 v235, v164, v68
    v_dot2c_f32_bf16 v235, v165, v69
    v_dot2c_f32_bf16 v235, v166, v70
    v_dot2c_f32_bf16 v235, v167, v71
    v_dot2c_f32_bf16 v235, v168, v72
    v_dot2c_f32_bf16 v235, v169, v73
    v_dot2c_f32_bf16 v235, v170, v74
    v_dot2c_f32_bf16 v235, v171, v75
    ds_read_b128 v[116:119], v10 offset:9440
    ds_read_b128 v[120:123], v10 offset:14048
    s_waitcnt lgkmcnt(10)
    v_dot2c_f32_bf16 v236, v164, v76
    v_dot2c_f32_bf16 v236, v165, v77
    v_dot2c_f32_bf16 v236, v166, v78
    v_dot2c_f32_bf16 v236, v167, v79
    v_dot2c_f32_bf16 v236, v168, v80
    v_dot2c_f32_bf16 v236, v169, v81
    v_dot2c_f32_bf16 v236, v170, v82
    v_dot2c_f32_bf16 v236, v171, v83
    ds_read_b128 v[124:127], v10 offset:192
    ds_read_b128 v[128:131], v10 offset:4800
    s_waitcnt lgkmcnt(10)
    v_dot2c_f32_bf16 v237, v164, v84
    v_dot2c_f32_bf16 v237, v165, v85
    v_dot2c_f32_bf16 v237, v166, v86
    v_dot2c_f32_bf16 v237, v167, v87
    v_dot2c_f32_bf16 v237, v168, v88
    v_dot2c_f32_bf16 v237, v169, v89
    v_dot2c_f32_bf16 v237, v170, v90
    v_dot2c_f32_bf16 v237, v171, v91
    ds_read_b128 v[132:135], v10 offset:9408
    ds_read_b128 v[136:139], v10 offset:14016
    s_waitcnt lgkmcnt(10)
    v_dot2c_f32_bf16 v238, v164, v92
    v_dot2c_f32_bf16 v238, v165, v93
    v_dot2c_f32_bf16 v238, v166, v94
    v_dot2c_f32_bf16 v238, v167, v95
    v_dot2c_f32_bf16 v238, v168, v96
    v_dot2c_f32_bf16 v238, v169, v97
    v_dot2c_f32_bf16 v238, v170, v98
    v_dot2c_f32_bf16 v238, v171, v99
    ds_read_b128 v[140:143], v10 offset:160
    ds_read_b128 v[144:147], v10 offset:4768
    s_waitcnt lgkmcnt(10)
    v_dot2c_f32_bf16 v239, v164, v100
    v_dot2c_f32_bf16 v239, v165, v101
    v_dot2c_f32_bf16 v239, v166, v102
    v_dot2c_f32_bf16 v239, v167, v103
    v_dot2c_f32_bf16 v239, v168, v104
    v_dot2c_f32_bf16 v239, v169, v105
    v_dot2c_f32_bf16 v239, v170, v106
    v_dot2c_f32_bf16 v239, v171, v107
    ds_read_b128 v[148:151], v10 offset:9376
    ds_read_b128 v[152:155], v10 offset:13984
    s_waitcnt lgkmcnt(4)
    ds_read_b128 v[196:199], v10 offset:128
    ds_read_b128 v[200:203], v10 offset:4736
    ds_read_b128 v[204:207], v10 offset:9344
    ds_read_b128 v[208:211], v10 offset:13952
    ds_read_b128 v[44:47], v10 offset:96
    ds_read_b128 v[48:51], v10 offset:4704
    ds_read_b128 v[52:55], v10 offset:9312
    ds_read_b128 v[56:59], v10 offset:13920
    s_nop 2
    s_lshl_b32 s46, s35, 3
    s_add_u32 s46, s46, s34
    s_cmp_eq_u32 s46, 0
    s_cbranch_scc0 K1_NOMASK
    v_mov_b32 v5, 0xf149f2ca
    v_cmp_gt_u32 vcc, 2, v2
    s_nop 1
    v_cndmask_b32 v233, v233, v5, vcc
    v_cmp_gt_u32 vcc, 4, v2
    s_nop 1
    v_cndmask_b32 v234, v234, v5, vcc
    v_cmp_gt_u32 vcc, 6, v2
    s_nop 1
    v_cndmask_b32 v235, v235, v5, vcc
    v_cmp_gt_u32 vcc, 8, v2
    s_nop 1
    v_cndmask_b32 v236, v236, v5, vcc
    v_cmp_gt_u32 vcc, 10, v2
    s_nop 1
    v_cndmask_b32 v237, v237, v5, vcc
    v_cmp_gt_u32 vcc, 12, v2
    s_nop 1
    v_cndmask_b32 v238, v238, v5, vcc
    v_cmp_gt_u32 vcc, 14, v2
    s_nop 1
    v_cndmask_b32 v239, v239, v5, vcc
K1_NOMASK:
    v_max3_f32 v5, v232, v233, v234
    v_max3_f32 v6, v235, v236, v237
    v_max3_f32 v5, v5, v238, v239
    v_max_f32 v5, v5, v6
    s_mov_b32 s46, 0x3eb8aa3b
    v_sub_f32 v232, v232, v5
    v_sub_f32 v233, v233, v5
    v_sub_f32 v234, v234, v5
    v_sub_f32 v235, v235, v5
    v_sub_f32 v236, v236, v5
    v_sub_f32 v237, v237, v5
    v_sub_f32 v238, v238, v5
    v_sub_f32 v239, v239, v5
    v_mul_f32 v232, s46, v232
    v_mul_f32 v233, s46, v233
    v_mul_f32 v234, s46, v234
    v_mul_f32 v235, s46, v235
    v_mul_f32 v236, s46, v236
    v_mul_f32 v237, s46, v237
    v_mul_f32 v238, s46, v238
    v_mul_f32 v239, s46, v239
    v_exp_f32 v232, v232
    v_exp_f32 v233, v233
    v_exp_f32 v234, v234
    v_exp_f32 v235, v235
    v_exp_f32 v236, v236
    v_exp_f32 v237, v237
    v_exp_f32 v238, v238
    v_exp_f32 v239, v239
    s_nop 0
    v_add_f32 v5, v232, v233
    v_add_f32 v6, v234, v235
    v_add_f32 v7, v236, v237
    v_add_f32 v8, v238, v239
    v_add_f32 v5, v5, v6
    v_add_f32 v7, v7, v8
    v_add_f32 v5, v5, v7
    v_rcp_f32 v5, v5
    s_nop 0
    v_mul_f32 v240, v232, v5
    v_mul_f32 v242, v233, v5
    v_mul_f32 v244, v234, v5
    v_mul_f32 v246, v235, v5
    v_mul_f32 v248, v236, v5
    v_mul_f32 v250, v237, v5
    v_mul_f32 v252, v238, v5
    v_mul_f32 v254, v239, v5
    s_waitcnt lgkmcnt(8)
    v_pk_mul_f32 v[180:181], v[240:241], v[108:109] op_sel:[0,0] op_sel_hi:[0,1]
    v_pk_mul_f32 v[182:183], v[240:241], v[110:111] op_sel:[0,0] op_sel_hi:[0,1]
    v_pk_mul_f32 v[184:185], v[240:241], v[112:113] op_sel:[0,0] op_sel_hi:[0,1]
    v_pk_mul_f32 v[186:187], v[240:241], v[114:115] op_sel:[0,0] op_sel_hi:[0,1]
    v_pk_mul_f32 v[188:189], v[240:241], v[116:117] op_sel:[0,0] op_sel_hi:[0,1]
    v_pk_mul_f32 v[190:191], v[240:241], v[118:119] op_sel:[0,0] op_sel_hi:[0,1]
    v_pk_mul_f32 v[192:193], v[240:241], v[120:121] op_sel:[0,0] op_sel_hi:[0,1]
    v_pk_mul_f32 v[194:195], v[240:241], v[122:123] op_sel:[0,0] op_sel_hi:[0,1]
    s_waitcnt lgkmcnt(8)
    ds_read_b128 v[60:63], v10 offset:64
    ds_read_b128 v[64:67], v10 offset:4672
    ds_read_b128 v[68:71], v10 offset:9280
    ds_read_b128 v[72:75], v10 offset:13888
    v_pk_fma_f32 v[180:181], v[242:243], v[124:125], v[180:181] op_sel:[0,0,0] op_sel_hi:[0,1,1]
    v_pk_fma_f32 v[182:183], v[242:243], v[126:127], v[182:183] op_sel:[0,0,0] op_sel_hi:[0,1,1]
    v_pk_fma_f32 v[184:185], v[242:243], v[128:129], v[184:185] op_sel:[0,0,0] op_sel_hi:[0,1,1]
    v_pk_fma_f32 v[186:187], v[242:243], v[130:131], v[186:187] op_sel:[0,0,0] op_sel_hi:[0,1,1]
    v_pk_fma_f32 v[188:189], v[242:243], v[132:133], v[188:189] op_sel:[0,0,0] op_sel_hi:[0,1,1]
    v_pk_fma_f32 v[190:191], v[242:243], v[134:135], v[190:191] op_sel:[0,0,0] op_sel_hi:[0,1,1]
    v_pk_fma_f32 v[192:193], v[242:243], v[136:137], v[192:193] op_sel:[0,0,0] op_sel_hi:[0,1,1]
    v_pk_fma_f32 v[194:195], v[242:243], v[138:139], v[194:195] op_sel:[0,0,0] op_sel_hi:[0,1,1]
    s_waitcnt lgkmcnt(8)
    ds_read_b128 v[76:79], v10 offset:32
    ds_read_b128 v[80:83], v10 offset:4640
    ds_read_b128 v[84:87], v10 offset:9248
    ds_read_b128 v[88:91], v10 offset:13856
    v_pk_fma_f32 v[180:181], v[244:245], v[140:141], v[180:181] op_sel:[0,0,0] op_sel_hi:[0,1,1]
    v_pk_fma_f32 v[182:183], v[244:245], v[142:143], v[182:183] op_sel:[0,0,0] op_sel_hi:[0,1,1]
    v_pk_fma_f32 v[184:185], v[244:245], v[144:145], v[184:185] op_sel:[0,0,0] op_sel_hi:[0,1,1]
    v_pk_fma_f32 v[186:187], v[244:245], v[146:147], v[186:187] op_sel:[0,0,0] op_sel_hi:[0,1,1]
    v_pk_fma_f32 v[188:189], v[244:245], v[148:149], v[188:189] op_sel:[0,0,0] op_sel_hi:[0,1,1]
    v_pk_fma_f32 v[190:191], v[244:245], v[150:151], v[190:191] op_sel:[0,0,0] op_sel_hi:[0,1,1]
    v_pk_fma_f32 v[192:193], v[244:245], v[152:153], v[192:193] op_sel:[0,0,0] op_sel_hi:[0,1,1]
    v_pk_fma_f32 v[194:195], v[244:245], v[154:155], v[194:195] op_sel:[0,0,0] op_sel_hi:[0,1,1]
    s_waitcnt lgkmcnt(8)
    ds_read_b128 v[92:95], v10 offset:0
    ds_read_b128 v[96:99], v10 offset:4608
    ds_read_b128 v[100:103], v10 offset:9216
    ds_read_b128 v[104:107], v10 offset:13824
    v_pk_fma_f32 v[180:181], v[246:247], v[196:197], v[180:181] op_sel:[0,0,0] op_sel_hi:[0,1,1]
    v_pk_fma_f32 v[182:183], v[246:247], v[198:199], v[182:183] op_sel:[0,0,0] op_sel_hi:[0,1,1]
    v_pk_fma_f32 v[184:185], v[246:247], v[200:201], v[184:185] op_sel:[0,0,0] op_sel_hi:[0,1,1]
    v_pk_fma_f32 v[186:187], v[246:247], v[202:203], v[186:187] op_sel:[0,0,0] op_sel_hi:[0,1,1]
    v_pk_fma_f32 v[188:189], v[246:247], v[204:205], v[188:189] op_sel:[0,0,0] op_sel_hi:[0,1,1]
    v_pk_fma_f32 v[190:191], v[246:247], v[206:207], v[190:191] op_sel:[0,0,0] op_sel_hi:[0,1,1]
    v_pk_fma_f32 v[192:193], v[246:247], v[208:209], v[192:193] op_sel:[0,0,0] op_sel_hi:[0,1,1]
    v_pk_fma_f32 v[194:195], v[246:247], v[210:211], v[194:195] op_sel:[0,0,0] op_sel_hi:[0,1,1]
    s_waitcnt lgkmcnt(8)
    v_pk_fma_f32 v[180:181], v[248:249], v[44:45], v[180:181] op_sel:[0,0,0] op_sel_hi:[0,1,1]
    v_pk_fma_f32 v[182:183], v[248:249], v[46:47], v[182:183] op_sel:[0,0,0] op_sel_hi:[0,1,1]
    v_pk_fma_f32 v[184:185], v[248:249], v[48:49], v[184:185] op_sel:[0,0,0] op_sel_hi:[0,1,1]
    v_pk_fma_f32 v[186:187], v[248:249], v[50:51], v[186:187] op_sel:[0,0,0] op_sel_hi:[0,1,1]
    v_pk_fma_f32 v[188:189], v[248:249], v[52:53], v[188:189] op_sel:[0,0,0] op_sel_hi:[0,1,1]
    v_pk_fma_f32 v[190:191], v[248:249], v[54:55], v[190:191] op_sel:[0,0,0] op_sel_hi:[0,1,1]
    v_pk_fma_f32 v[192:193], v[248:249], v[56:57], v[192:193] op_sel:[0,0,0] op_sel_hi:[0,1,1]
    v_pk_fma_f32 v[194:195], v[248:249], v[58:59], v[194:195] op_sel:[0,0,0] op_sel_hi:[0,1,1]
    s_waitcnt lgkmcnt(8)
    v_pk_fma_f32 v[180:181], v[250:251], v[60:61], v[180:181] op_sel:[0,0,0] op_sel_hi:[0,1,1]
    v_pk_fma_f32 v[182:183], v[250:251], v[62:63], v[182:183] op_sel:[0,0,0] op_sel_hi:[0,1,1]
    v_pk_fma_f32 v[184:185], v[250:251], v[64:65], v[184:185] op_sel:[0,0,0] op_sel_hi:[0,1,1]
    v_pk_fma_f32 v[186:187], v[250:251], v[66:67], v[186:187] op_sel:[0,0,0] op_sel_hi:[0,1,1]
    v_pk_fma_f32 v[188:189], v[250:251], v[68:69], v[188:189] op_sel:[0,0,0] op_sel_hi:[0,1,1]
    v_pk_fma_f32 v[190:191], v[250:251], v[70:71], v[190:191] op_sel:[0,0,0] op_sel_hi:[0,1,1]
    v_pk_fma_f32 v[192:193], v[250:251], v[72:73], v[192:193] op_sel:[0,0,0] op_sel_hi:[0,1,1]
    v_pk_fma_f32 v[194:195], v[250:251], v[74:75], v[194:195] op_sel:[0,0,0] op_sel_hi:[0,1,1]
    s_waitcnt lgkmcnt(4)
    v_pk_fma_f32 v[180:181], v[252:253], v[76:77], v[180:181] op_sel:[0,0,0] op_sel_hi:[0,1,1]
    v_pk_fma_f32 v[182:183], v[252:253], v[78:79], v[182:183] op_sel:[0,0,0] op_sel_hi:[0,1,1]
    v_pk_fma_f32 v[184:185], v[252:253], v[80:81], v[184:185] op_sel:[0,0,0] op_sel_hi:[0,1,1]
    v_pk_fma_f32 v[186:187], v[252:253], v[82:83], v[186:187] op_sel:[0,0,0] op_sel_hi:[0,1,1]
    v_pk_fma_f32 v[188:189], v[252:253], v[84:85], v[188:189] op_sel:[0,0,0] op_sel_hi:[0,1,1]
    v_pk_fma_f32 v[190:191], v[252:253], v[86:87], v[190:191] op_sel:[0,0,0] op_sel_hi:[0,1,1]
    v_pk_fma_f32 v[192:193], v[252:253], v[88:89], v[192:193] op_sel:[0,0,0] op_sel_hi:[0,1,1]
    v_pk_fma_f32 v[194:195], v[252:253], v[90:91], v[194:195] op_sel:[0,0,0] op_sel_hi:[0,1,1]
    s_waitcnt lgkmcnt(0)
    v_pk_fma_f32 v[180:181], v[254:255], v[92:93], v[180:181] op_sel:[0,0,0] op_sel_hi:[0,1,1]
    v_pk_fma_f32 v[182:183], v[254:255], v[94:95], v[182:183] op_sel:[0,0,0] op_sel_hi:[0,1,1]
    v_pk_fma_f32 v[184:185], v[254:255], v[96:97], v[184:185] op_sel:[0,0,0] op_sel_hi:[0,1,1]
    v_pk_fma_f32 v[186:187], v[254:255], v[98:99], v[186:187] op_sel:[0,0,0] op_sel_hi:[0,1,1]
    v_pk_fma_f32 v[188:189], v[254:255], v[100:101], v[188:189] op_sel:[0,0,0] op_sel_hi:[0,1,1]
    v_pk_fma_f32 v[190:191], v[254:255], v[102:103], v[190:191] op_sel:[0,0,0] op_sel_hi:[0,1,1]
    v_pk_fma_f32 v[192:193], v[254:255], v[104:105], v[192:193] op_sel:[0,0,0] op_sel_hi:[0,1,1]
    v_pk_fma_f32 v[194:195], v[254:255], v[106:107], v[194:195] op_sel:[0,0,0] op_sel_hi:[0,1,1]
    s_lshl_b32 s60, s35, 2
    s_add_u32 s60, s60, s38
    s_mul_i32 s60, s60, 241664
    s_and_b32 s47, s34, 1
    s_lshl_b32 s47, s47, 10
    s_add_u32 s60, s60, s47
    s_lshl_b32 s47, s36, 12
    s_add_u32 s60, s60, s47
    v_lshlrev_b32 v4, 11, v3
    v_lshl_add_u32 v4, v2, 4, v4
    v_cvt_pk_bf16_f32 v164, v180, v181
    v_cvt_pk_bf16_f32 v165, v182, v183
    v_cvt_pk_bf16_f32 v166, v184, v185
    v_cvt_pk_bf16_f32 v167, v186, v187
    v_cvt_pk_bf16_f32 v168, v188, v189
    v_cvt_pk_bf16_f32 v169, v190, v191
    v_cvt_pk_bf16_f32 v170, v192, v193
    v_cvt_pk_bf16_f32 v171, v194, v195
    buffer_store_dwordx4 v[164:167], v4, s[24:27], s60 offen sc0 sc1
    buffer_store_dwordx4 v[168:171], v4, s[24:27], s60 offen offset:512 sc0 sc1
K1_END:
    s_endpgm
.globl k2_kernel
.p2align 8
.type k2_kernel,@function
k2_kernel:
    s_cmp_ge_u32 s2, 256
    s_cbranch_scc1 K2_END
    s_load_dwordx2 s[4:5], s[0:1], 0
    s_load_dwordx2 s[6:7], s[0:1], 16
    s_load_dwordx4 s[28:31], s[0:1], 48
    s_load_dwordx2 s[32:33], s[0:1], 72
    s_getpc_b64 s[70:71]
K2_PC:
    s_lshr_b32 s46, s2, 3
    s_lshl_b32 s46, s46, 8
    v_lshl_add_u32 v5, v0, 7, s46
    v_min_u32 v5, K2_END-K2_PC, v5
    v_cmp_gt_u32 vcc, 2, v0
    s_and_saveexec_b64 s[62:63], vcc
    s_cbranch_execz K2_NCP
    global_load_dword v228, v5, s[70:71]
K2_NCP:
    s_mov_b64 exec, -1
    v_lshrrev_b32 v4, 6, v0
    v_and_b32 v1, 63, v0
    v_readfirstlane_b32 s34, v4
    v_and_b32 v2, 31, v1
    v_lshrrev_b32 v3, 5, v1
    s_and_b32 s35, s2, 1
    s_lshl_b32 s35, s35, 2
    s_bfe_u32 s46, s2, 0x20001
    s_add_u32 s35, s35, s46
    s_lshl_b32 s35, s35, 2
    s_lshr_b32 s46, s2, 3
    s_and_b32 s46, s46, 3
    s_add_u32 s35, s35, s46
    s_lshr_b32 s36, s2, 5
    s_mul_i32 s39, s34, 30
    s_cmp_eq_u32 s34, 3
    s_cselect_b32 s39, 89, s39
    s_cmp_lt_u32 s34, 2
    s_cselect_b32 s38, 30, 29
    s_sub_u32 s37, s39, 30
    s_cmp_eq_u32 s34, 0
    s_cselect_b32 s37, 0, s37
    v_lshlrev_b32 v12, 4, v1
    v_lshrrev_b32 v5, 3, v1
    v_and_b32 v6, 7, v1
    v_bfe_u32 v7, v1, 4, 1
    v_lshlrev_b32 v7, 2, v7
    v_xor_b32 v6, v6, v7
    v_lshlrev_b32 v5, 10, v5
    v_lshl_add_u32 v13, v6, 4, v5
    v_add_u32 v14, 7168, v13
    s_lshl_b32 s50, s34, 15
    s_waitcnt lgkmcnt(0)
    s_mul_i32 s46, s35, 241664
    s_lshl_b32 s47, s39, 11
    s_add_u32 s46, s46, s47
    s_add_u32 s8, s32, s46
    s_addc_u32 s9, s33, 0
    s_lshl_b32 s10, s38, 11
    s_mov_b32 s11, 0x20000
    s_sub_u32 s12, s28, 32768
    s_subb_u32 s13, s29, 0
    s_cmp_eq_u32 s34, 0
    s_cselect_b32 s12, s6, s12
    s_cselect_b32 s13, s7, s13
    s_lshl_b32 s46, s37, 14
    s_lshl_b32 s47, s36, 7
    s_add_u32 s46, s46, s47
    s_add_u32 s12, s12, s46
    s_addc_u32 s13, s13, 0
    s_lshl_b32 s14, s38, 14
    s_sub_u32 s14, s14, s47
    s_mov_b32 s15, 0x20000
    s_add_u32 s46, s47, 491520
    s_add_u32 s24, s6, s46
    s_addc_u32 s25, s7, 0
    s_sub_u32 s26, 32768, s47
    s_mov_b32 s27, 0x20000
    s_cmp_eq_u32 s34, 1
    s_cselect_b32 s24, s24, s12
    s_cselect_b32 s25, s25, s13
    s_cselect_b32 s26, s26, s14
    s_lshr_b32 s46, s2, 3
    s_and_b32 s46, s46, 3
    s_lshl_b32 s46, s46, 1
    s_add_u32 s46, s46, s36
    s_and_b32 s46, s46, 7
    s_mul_i32 s46, s46, s38
    s_lshr_b32 s46, s46, 3
    s_mov_b32 s46, 0
    s_lshl_b32 s40, s46, 11
    s_lshl_b32 s41, s46, 14
    s_lshl_b32 s52, s38, 11
    s_add_u32 m0, s50, 0
    buffer_load_dwordx4 v[20:23], v12, s[8:11], s40 offen
    buffer_load_dwordx4 v13, s[24:27], s41 offen lds
    buffer_load_dwordx4 v[24:27], v12, s[8:11], s40 offen offset:1024
    buffer_load_dwordx4 v14, s[24:27], s41 offen offset:1024 lds
    s_add_u32 s40, s40, 2048
    s_cmp_eq_u32 s40, s52
    s_cselect_b32 s40, 0, s40
    s_lshl_b32 s41, s40, 3
    s_add_u32 m0, s50, 2048
    buffer_load_dwordx4 v[28:31], v12, s[8:11], s40 offen
    buffer_load_dwordx4 v13, s[24:27], s41 offen lds
    buffer_load_dwordx4 v[32:35], v12, s[8:11], s40 offen offset:1024
    buffer_load_dwordx4 v14, s[24:27], s41 offen offset:1024 lds
    s_add_u32 s40, s40, 2048
    s_cmp_eq_u32 s40, s52
    s_cselect_b32 s40, 0, s40
    s_lshl_b32 s41, s40, 3
    v_bfe_u32 v5, v1, 2, 2
    v_and_b32 v6, 3, v1
    v_bfe_u32 v7, v1, 4, 1
    v_lshl_add_u32 v8, v3, 2, v5
    v_lshlrev_b32 v8, 7, v8
    v_lshl_add_u32 v8, v6, 3, v8
    v_lshl_add_u32 v8, v7, 5, v8
    v_lshrrev_b32 v5, 1, v5
    v_lshl_add_u32 v8, v5, 6, v8
    v_add_u32 v15, s50, v8
    v_xor_b32 v16, 64, v15
    s_add_u32 m0, s50, 4096
    buffer_load_dwordx4 v[36:39], v12, s[8:11], s40 offen
    buffer_load_dwordx4 v13, s[12:15], s41 offen lds
    buffer_load_dwordx4 v[40:43], v12, s[8:11], s40 offen offset:1024
    buffer_load_dwordx4 v14, s[12:15], s41 offen offset:1024 lds
    s_add_u32 s40, s40, 2048
    s_cmp_eq_u32 s40, s52
    s_cselect_b32 s40, 0, s40
    s_lshl_b32 s41, s40, 3
    s_add_u32 m0, s50, 6144
    buffer_load_dwordx4 v[44:47], v12, s[8:11], s40 offen
    buffer_load_dwordx4 v13, s[12:15], s41 offen lds
    buffer_load_dwordx4 v[48:51], v12, s[8:11], s40 offen offset:1024
    buffer_load_dwordx4 v14, s[12:15], s41 offen offset:1024 lds
    s_add_u32 s40, s40, 2048
    s_cmp_eq_u32 s40, s52
    s_cselect_b32 s40, 0, s40
    s_lshl_b32 s41, s40, 3
    s_waitcnt vmcnt(12)
    ds_read_b64_tr_b16 v[148:149], v15 offset:0
    ds_read_b64_tr_b16 v[150:151], v15 offset:1024
    ds_read_b64_tr_b16 v[152:153], v16 offset:0
    ds_read_b64_tr_b16 v[154:155], v16 offset:1024
    s_waitcnt vmcnt(8) lgkmcnt(0)
    ds_read_b64_tr_b16 v[156:157], v15 offset:2048
    ds_read_b64_tr_b16 v[158:159], v15 offset:3072
    ds_read_b64_tr_b16 v[160:161], v16 offset:2048
    ds_read_b64_tr_b16 v[162:163], v16 offset:3072
    v_mfma_f32_32x32x16_bf16 v[164:179], v[148:151], v[20:23], 0
    s_add_u32 m0, s50, 8192
    buffer_load_dwordx4 v[52:55], v12, s[8:11], s40 offen
    buffer_load_dwordx4 v13, s[12:15], s41 offen lds
    v_mfma_f32_32x32x16_bf16 v[180:195], v[148:151], v[24:27], 0
    buffer_load_dwordx4 v[56:59], v12, s[8:11], s40 offen offset:1024
    buffer_load_dwordx4 v14, s[12:15], s41 offen offset:1024 lds
    s_add_u32 s40, s40, 2048
    v_mfma_f32_32x32x16_bf16 v[196:211], v[152:155], v[20:23], 0
    s_cmp_eq_u32 s40, s52
    s_cselect_b32 s40, 0, s40
    s_lshl_b32 s41, s40, 3
    v_mfma_f32_32x32x16_bf16 v[212:227], v[152:155], v[24:27], 0
    s_waitcnt vmcnt(8) lgkmcnt(0)
    ds_read_b64_tr_b16 v[148:149], v15 offset:4096
    ds_read_b64_tr_b16 v[150:151], v15 offset:5120
    ds_read_b64_tr_b16 v[152:153], v16 offset:4096
    ds_read_b64_tr_b16 v[154:155], v16 offset:5120
    v_mfma_f32_32x32x16_bf16 v[164:179], v[156:159], v[28:31], v[164:179]
    s_add_u32 m0, s50, 10240
    buffer_load_dwordx4 v[60:63], v12, s[8:11], s40 offen
    buffer_load_dwordx4 v13, s[12:15], s41 offen lds
    v_mfma_f32_32x32x16_bf16 v[180:195], v[156:159], v[32:35], v[180:195]
    buffer_load_dwordx4 v[64:67], v12, s[8:11], s40 offen offset:1024
    buffer_load_dwordx4 v14, s[12:15], s41 offen offset:1024 lds
    s_add_u32 s40, s40, 2048
    v_mfma_f32_32x32x16_bf16 v[196:211], v[160:163], v[28:31], v[196:211]
    s_cmp_eq_u32 s40, s52
    s_cselect_b32 s40, 0, s40
    s_lshl_b32 s41, s40, 3
    v_mfma_f32_32x32x16_bf16 v[212:227], v[160:163], v[32:35], v[212:227]
    s_waitcnt vmcnt(8) lgkmcnt(0)
    ds_read_b64_tr_b16 v[156:157], v15 offset:6144
    ds_read_b64_tr_b16 v[158:159], v15 offset:7168
    ds_read_b64_tr_b16 v[160:161], v16 offset:6144
    ds_read_b64_tr_b16 v[162:163], v16 offset:7168
    v_mfma_f32_32x32x16_bf16 v[164:179], v[148:151], v[36:39], v[164:179]
    s_add_u32 m0, s50, 12288
    buffer_load_dwordx4 v[68:71], v12, s[8:11], s40 offen
    buffer_load_dwordx4 v13, s[12:15], s41 offen lds
    v_mfma_f32_32x32x16_bf16 v[180:195], v[148:151], v[40:43], v[180:195]
    buffer_load_dwordx4 v[72:75], v12, s[8:11], s40 offen offset:1024
    buffer_load_dwordx4 v14, s[12:15], s41 offen offset:1024 lds
    s_add_u32 s40, s40, 2048
    v_mfma_f32_32x32x16_bf16 v[196:211], v[152:155], v[36:39], v[196:211]
    s_cmp_eq_u32 s40, s52
    s_cselect_b32 s40, 0, s40
    s_lshl_b32 s41, s40, 3
    v_mfma_f32_32x32x16_bf16 v[212:227], v[152:155], v[40:43], v[212:227]
    s_waitcnt vmcnt(8) lgkmcnt(0)
    ds_read_b64_tr_b16 v[148:149], v15 offset:8192
    ds_read_b64_tr_b16 v[150:151], v15 offset:9216
    ds_read_b64_tr_b16 v[152:153], v16 offset:8192
    ds_read_b64_tr_b16 v[154:155], v16 offset:9216
    v_mfma_f32_32x32x16_bf16 v[164:179], v[156:159], v[44:47], v[164:179]
    s_add_u32 m0, s50, 14336
    buffer_load_dwordx4 v[76:79], v12, s[8:11], s40 offen
    buffer_load_dwordx4 v13, s[12:15], s41 offen lds
    v_mfma_f32_32x32x16_bf16 v[180:195], v[156:159], v[48:51], v[180:195]
    buffer_load_dwordx4 v[80:83], v12, s[8:11], s40 offen offset:1024
    buffer_load_dwordx4 v14, s[12:15], s41 offen offset:1024 lds
    s_add_u32 s40, s40, 2048
    v_mfma_f32_32x32x16_bf16 v[196:211], v[160:163], v[44:47], v[196:211]
    s_cmp_eq_u32 s40, s52
    s_cselect_b32 s40, 0, s40
    s_lshl_b32 s41, s40, 3
    v_mfma_f32_32x32x16_bf16 v[212:227], v[160:163], v[48:51], v[212:227]
    s_waitcnt vmcnt(8) lgkmcnt(0)
    ds_read_b64_tr_b16 v[156:157], v15 offset:10240
    ds_read_b64_tr_b16 v[158:159], v15 offset:11264
    ds_read_b64_tr_b16 v[160:161], v16 offset:10240
    ds_read_b64_tr_b16 v[162:163], v16 offset:11264
    v_mfma_f32_32x32x16_bf16 v[164:179], v[148:151], v[52:55], v[164:179]
    s_add_u32 m0, s50, 16384
    buffer_load_dwordx4 v[84:87], v12, s[8:11], s40 offen
    buffer_load_dwordx4 v13, s[12:15], s41 offen lds
    v_mfma_f32_32x32x16_bf16 v[180:195], v[148:151], v[56:59], v[180:195]
    buffer_load_dwordx4 v[88:91], v12, s[8:11], s40 offen offset:1024
    buffer_load_dwordx4 v14, s[12:15], s41 offen offset:1024 lds
    s_add_u32 s40, s40, 2048
    v_mfma_f32_32x32x16_bf16 v[196:211], v[152:155], v[52:55], v[196:211]
    s_cmp_eq_u32 s40, s52
    s_cselect_b32 s40, 0, s40
    s_lshl_b32 s41, s40, 3
    v_mfma_f32_32x32x16_bf16 v[212:227], v[152:155], v[56:59], v[212:227]
    s_waitcnt vmcnt(8) lgkmcnt(0)
    ds_read_b64_tr_b16 v[148:149], v15 offset:12288
    ds_read_b64_tr_b16 v[150:151], v15 offset:13312
    ds_read_b64_tr_b16 v[152:153], v16 offset:12288
    ds_read_b64_tr_b16 v[154:155], v16 offset:13312
    v_mfma_f32_32x32x16_bf16 v[164:179], v[156:159], v[60:63], v[164:179]
    s_add_u32 m0, s50, 18432
    buffer_load_dwordx4 v[92:95], v12, s[8:11], s40 offen
    buffer_load_dwordx4 v13, s[12:15], s41 offen lds
    v_mfma_f32_32x32x16_bf16 v[180:195], v[156:159], v[64:67], v[180:195]
    buffer_load_dwordx4 v[96:99], v12, s[8:11], s40 offen offset:1024
    buffer_load_dwordx4 v14, s[12:15], s41 offen offset:1024 lds
    s_add_u32 s40, s40, 2048
    v_mfma_f32_32x32x16_bf16 v[196:211], v[160:163], v[60:63], v[196:211]
    s_cmp_eq_u32 s40, s52
    s_cselect_b32 s40, 0, s40
    s_lshl_b32 s41, s40, 3
    v_mfma_f32_32x32x16_bf16 v[212:227], v[160:163], v[64:67], v[212:227]
    s_waitcnt vmcnt(8) lgkmcnt(0)
    ds_read_b64_tr_b16 v[156:157], v15 offset:14336
    ds_read_b64_tr_b16 v[158:159], v15 offset:15360
    ds_read_b64_tr_b16 v[160:161], v16 offset:14336
    ds_read_b64_tr_b16 v[162:163], v16 offset:15360
    v_mfma_f32_32x32x16_bf16 v[164:179], v[148:151], v[68:71], v[164:179]
    s_add_u32 m0, s50, 20480
    buffer_load_dwordx4 v[100:103], v12, s[8:11], s40 offen
    buffer_load_dwordx4 v13, s[12:15], s41 offen lds
    v_mfma_f32_32x32x16_bf16 v[180:195], v[148:151], v[72:75], v[180:195]
    buffer_load_dwordx4 v[104:107], v12, s[8:11], s40 offen offset:1024
    buffer_load_dwordx4 v14, s[12:15], s41 offen offset:1024 lds
    s_add_u32 s40, s40, 2048
    v_mfma_f32_32x32x16_bf16 v[196:211], v[152:155], v[68:71], v[196:211]
    s_cmp_eq_u32 s40, s52
    s_cselect_b32 s40, 0, s40
    s_lshl_b32 s41, s40, 3
    v_mfma_f32_32x32x16_bf16 v[212:227], v[152:155], v[72:75], v[212:227]
    s_waitcnt vmcnt(8) lgkmcnt(0)
    ds_read_b64_tr_b16 v[148:149], v15 offset:16384
    ds_read_b64_tr_b16 v[150:151], v15 offset:17408
    ds_read_b64_tr_b16 v[152:153], v16 offset:16384
    ds_read_b64_tr_b16 v[154:155], v16 offset:17408
    v_mfma_f32_32x32x16_bf16 v[164:179], v[156:159], v[76:79], v[164:179]
    s_add_u32 m0, s50, 22528
    buffer_load_dwordx4 v[108:111], v12, s[8:11], s40 offen
    buffer_load_dwordx4 v13, s[12:15], s41 offen lds
    v_mfma_f32_32x32x16_bf16 v[180:195], v[156:159], v[80:83], v[180:195]
    buffer_load_dwordx4 v[112:115], v12, s[8:11], s40 offen offset:1024
    buffer_load_dwordx4 v14, s[12:15], s41 offen offset:1024 lds
    s_add_u32 s40, s40, 2048
    v_mfma_f32_32x32x16_bf16 v[196:211], v[160:163], v[76:79], v[196:211]
    s_cmp_eq_u32 s40, s52
    s_cselect_b32 s40, 0, s40
    s_lshl_b32 s41, s40, 3
    v_mfma_f32_32x32x16_bf16 v[212:227], v[160:163], v[80:83], v[212:227]
    s_waitcnt vmcnt(8) lgkmcnt(0)
    ds_read_b64_tr_b16 v[156:157], v15 offset:18432
    ds_read_b64_tr_b16 v[158:159], v15 offset:19456
    ds_read_b64_tr_b16 v[160:161], v16 offset:18432
    ds_read_b64_tr_b16 v[162:163], v16 offset:19456
    v_mfma_f32_32x32x16_bf16 v[164:179], v[148:151], v[84:87], v[164:179]
    s_add_u32 m0, s50, 24576
    buffer_load_dwordx4 v[116:119], v12, s[8:11], s40 offen
    buffer_load_dwordx4 v13, s[12:15], s41 offen lds
    v_mfma_f32_32x32x16_bf16 v[180:195], v[148:151], v[88:91], v[180:195]
    buffer_load_dwordx4 v[120:123], v12, s[8:11], s40 offen offset:1024
    buffer_load_dwordx4 v14, s[12:15], s41 offen offset:1024 lds
    s_add_u32 s40, s40, 2048
    v_mfma_f32_32x32x16_bf16 v[196:211], v[152:155], v[84:87], v[196:211]
    s_cmp_eq_u32 s40, s52
    s_cselect_b32 s40, 0, s40
    s_lshl_b32 s41, s40, 3
    v_mfma_f32_32x32x16_bf16 v[212:227], v[152:155], v[88:91], v[212:227]
    s_waitcnt vmcnt(8) lgkmcnt(0)
    ds_read_b64_tr_b16 v[148:149], v15 offset:20480
    ds_read_b64_tr_b16 v[150:151], v15 offset:21504
    ds_read_b64_tr_b16 v[152:153], v16 offset:20480
    ds_read_b64_tr_b16 v[154:155], v16 offset:21504
    v_mfma_f32_32x32x16_bf16 v[164:179], v[156:159], v[92:95], v[164:179]
    s_add_u32 m0, s50, 26624
    buffer_load_dwordx4 v[124:127], v12, s[8:11], s40 offen
    buffer_load_dwordx4 v13, s[12:15], s41 offen lds
    v_mfma_f32_32x32x16_bf16 v[180:195], v[156:159], v[96:99], v[180:195]
    buffer_load_dwordx4 v[128:131], v12, s[8:11], s40 offen offset:1024
    buffer_load_dwordx4 v14, s[12:15], s41 offen offset:1024 lds
    s_add_u32 s40, s40, 2048
    v_mfma_f32_32x32x16_bf16 v[196:211], v[160:163], v[92:95], v[196:211]
    s_cmp_eq_u32 s40, s52
    s_cselect_b32 s40, 0, s40
    s_lshl_b32 s41, s40, 3
    v_mfma_f32_32x32x16_bf16 v[212:227], v[160:163], v[96:99], v[212:227]
    s_waitcnt vmcnt(8) lgkmcnt(0)
    ds_read_b64_tr_b16 v[156:157], v15 offset:22528
    ds_read_b64_tr_b16 v[158:159], v15 offset:23552
    ds_read_b64_tr_b16 v[160:161], v16 offset:22528
    ds_read_b64_tr_b16 v[162:163], v16 offset:23552
    v_mfma_f32_32x32x16_bf16 v[164:179], v[148:151], v[100:103], v[164:179]
    s_add_u32 m0, s50, 28672
    buffer_load_dwordx4 v[132:135], v12, s[8:11], s40 offen
    buffer_load_dwordx4 v13, s[12:15], s41 offen lds
    v_mfma_f32_32x32x16_bf16 v[180:195], v[148:151], v[104:107], v[180:195]
    buffer_load_dwordx4 v[136:139], v12, s[8:11], s40 offen offset:1024
    buffer_load_dwordx4 v14, s[12:15], s41 offen offset:1024 lds
    s_add_u32 s40, s40, 2048
    v_mfma_f32_32x32x16_bf16 v[196:211], v[152:155], v[100:103], v[196:211]
    s_cmp_eq_u32 s40, s52
    s_cselect_b32 s40, 0, s40
    s_lshl_b32 s41, s40, 3
    v_mfma_f32_32x32x16_bf16 v[212:227], v[152:155], v[104:107], v[212:227]
    s_waitcnt vmcnt(8) lgkmcnt(0)
    ds_read_b64_tr_b16 v[148:149], v15 offset:24576
    ds_read_b64_tr_b16 v[150:151], v15 offset:25600
    ds_read_b64_tr_b16 v[152:153], v16 offset:24576
    ds_read_b64_tr_b16 v[154:155], v16 offset:25600
    v_mfma_f32_32x32x16_bf16 v[164:179], v[156:159], v[108:111], v[164:179]
    s_add_u32 m0, s50, 30720
    buffer_load_dwordx4 v[140:143], v12, s[8:11], s40 offen
    buffer_load_dwordx4 v13, s[12:15], s41 offen lds
    v_mfma_f32_32x32x16_bf16 v[180:195], v[156:159], v[112:115], v[180:195]
    buffer_load_dwordx4 v[144:147], v12, s[8:11], s40 offen offset:1024
    buffer_load_dwordx4 v14, s[12:15], s41 offen offset:1024 lds
    s_add_u32 s40, s40, 2048
    v_mfma_f32_32x32x16_bf16 v[196:211], v[160:163], v[108:111], v[196:211]
    s_cmp_eq_u32 s40, s52
    s_cselect_b32 s40, 0, s40
    s_lshl_b32 s41, s40, 3
    v_mfma_f32_32x32x16_bf16 v[212:227], v[160:163], v[112:115], v[212:227]
    s_waitcnt vmcnt(8) lgkmcnt(0)
    ds_read_b64_tr_b16 v[156:157], v15 offset:26624
    ds_read_b64_tr_b16 v[158:159], v15 offset:27648
    ds_read_b64_tr_b16 v[160:161], v16 offset:26624
    ds_read_b64_tr_b16 v[162:163], v16 offset:27648
    v_mfma_f32_32x32x16_bf16 v[164:179], v[148:151], v[116:119], v[164:179]
    s_add_u32 m0, s50, 0
    buffer_load_dwordx4 v[20:23], v12, s[8:11], s40 offen
    buffer_load_dwordx4 v13, s[12:15], s41 offen lds
    v_mfma_f32_32x32x16_bf16 v[180:195], v[148:151], v[120:123], v[180:195]
    buffer_load_dwordx4 v[24:27], v12, s[8:11], s40 offen offset:1024
    buffer_load_dwordx4 v14, s[12:15], s41 offen offset:1024 lds
    s_add_u32 s40, s40, 2048
    v_mfma_f32_32x32x16_bf16 v[196:211], v[152:155], v[116:119], v[196:211]
    s_cmp_eq_u32 s40, s52
    s_cselect_b32 s40, 0, s40
    s_lshl_b32 s41, s40, 3
    v_mfma_f32_32x32x16_bf16 v[212:227], v[152:155], v[120:123], v[212:227]
    s_waitcnt vmcnt(8) lgkmcnt(0)
    ds_read_b64_tr_b16 v[148:149], v15 offset:28672
    ds_read_b64_tr_b16 v[150:151], v15 offset:29696
    ds_read_b64_tr_b16 v[152:153], v16 offset:28672
    ds_read_b64_tr_b16 v[154:155], v16 offset:29696
    v_mfma_f32_32x32x16_bf16 v[164:179], v[156:159], v[124:127], v[164:179]
    s_add_u32 m0, s50, 2048
    buffer_load_dwordx4 v[28:31], v12, s[8:11], s40 offen
    buffer_load_dwordx4 v13, s[12:15], s41 offen lds
    v_mfma_f32_32x32x16_bf16 v[180:195], v[156:159], v[128:131], v[180:195]
    buffer_load_dwordx4 v[32:35], v12, s[8:11], s40 offen offset:1024
    buffer_load_dwordx4 v14, s[12:15], s41 offen offset:1024 lds
    s_add_u32 s40, s40, 2048
    v_mfma_f32_32x32x16_bf16 v[196:211], v[160:163], v[124:127], v[196:211]
    s_cmp_eq_u32 s40, s52
    s_cselect_b32 s40, 0, s40
    s_lshl_b32 s41, s40, 3
    v_mfma_f32_32x32x16_bf16 v[212:227], v[160:163], v[128:131], v[212:227]
    s_waitcnt vmcnt(8) lgkmcnt(0)
    ds_read_b64_tr_b16 v[156:157], v15 offset:30720
    ds_read_b64_tr_b16 v[158:159], v15 offset:31744
    ds_read_b64_tr_b16 v[160:161], v16 offset:30720
    ds_read_b64_tr_b16 v[162:163], v16 offset:31744
    v_mfma_f32_32x32x16_bf16 v[164:179], v[148:151], v[132:135], v[164:179]
    s_add_u32 m0, s50, 4096
    buffer_load_dwordx4 v[36:39], v12, s[8:11], s40 offen
    buffer_load_dwordx4 v13, s[12:15], s41 offen lds
    v_mfma_f32_32x32x16_bf16 v[180:195], v[148:151], v[136:139], v[180:195]
    buffer_load_dwordx4 v[40:43], v12, s[8:11], s40 offen offset:1024
    buffer_load_dwordx4 v14, s[12:15], s41 offen offset:1024 lds
    s_add_u32 s40, s40, 2048
    v_mfma_f32_32x32x16_bf16 v[196:211], v[152:155], v[132:135], v[196:211]
    s_cmp_eq_u32 s40, s52
    s_cselect_b32 s40, 0, s40
    s_lshl_b32 s41, s40, 3
    v_mfma_f32_32x32x16_bf16 v[212:227], v[152:155], v[136:139], v[212:227]
    s_waitcnt vmcnt(8) lgkmcnt(0)
    ds_read_b64_tr_b16 v[148:149], v15 offset:0
    ds_read_b64_tr_b16 v[150:151], v15 offset:1024
    ds_read_b64_tr_b16 v[152:153], v16 offset:0
    ds_read_b64_tr_b16 v[154:155], v16 offset:1024
    v_mfma_f32_32x32x16_bf16 v[164:179], v[156:159], v[140:143], v[164:179]
    s_add_u32 m0, s50, 6144
    buffer_load_dwordx4 v[44:47], v12, s[8:11], s40 offen
    buffer_load_dwordx4 v13, s[12:15], s41 offen lds
    v_mfma_f32_32x32x16_bf16 v[180:195], v[156:159], v[144:147], v[180:195]
    buffer_load_dwordx4 v[48:51], v12, s[8:11], s40 offen offset:1024
    buffer_load_dwordx4 v14, s[12:15], s41 offen offset:1024 lds
    s_add_u32 s40, s40, 2048
    v_mfma_f32_32x32x16_bf16 v[196:211], v[160:163], v[140:143], v[196:211]
    s_cmp_eq_u32 s40, s52
    s_cselect_b32 s40, 0, s40
    s_lshl_b32 s41, s40, 3
    v_mfma_f32_32x32x16_bf16 v[212:227], v[160:163], v[144:147], v[212:227]
    s_waitcnt vmcnt(8) lgkmcnt(0)
    ds_read_b64_tr_b16 v[156:157], v15 offset:2048
    ds_read_b64_tr_b16 v[158:159], v15 offset:3072
    ds_read_b64_tr_b16 v[160:161], v16 offset:2048
    ds_read_b64_tr_b16 v[162:163], v16 offset:3072
    v_mfma_f32_32x32x16_bf16 v[164:179], v[148:151], v[20:23], v[164:179]
    s_add_u32 m0, s50, 8192
    buffer_load_dwordx4 v[52:55], v12, s[8:11], s40 offen
    buffer_load_dwordx4 v13, s[12:15], s41 offen lds
    v_mfma_f32_32x32x16_bf16 v[180:195], v[148:151], v[24:27], v[180:195]
    buffer_load_dwordx4 v[56:59], v12, s[8:11], s40 offen offset:1024
    buffer_load_dwordx4 v14, s[12:15], s41 offen offset:1024 lds
    s_add_u32 s40, s40, 2048
    v_mfma_f32_32x32x16_bf16 v[196:211], v[152:155], v[20:23], v[196:211]
    s_cmp_eq_u32 s40, s52
    s_cselect_b32 s40, 0, s40
    s_lshl_b32 s41, s40, 3
    v_mfma_f32_32x32x16_bf16 v[212:227], v[152:155], v[24:27], v[212:227]
    s_waitcnt vmcnt(8) lgkmcnt(0)
    ds_read_b64_tr_b16 v[148:149], v15 offset:4096
    ds_read_b64_tr_b16 v[150:151], v15 offset:5120
    ds_read_b64_tr_b16 v[152:153], v16 offset:4096
    ds_read_b64_tr_b16 v[154:155], v16 offset:5120
    v_mfma_f32_32x32x16_bf16 v[164:179], v[156:159], v[28:31], v[164:179]
    s_add_u32 m0, s50, 10240
    buffer_load_dwordx4 v[60:63], v12, s[8:11], s40 offen
    buffer_load_dwordx4 v13, s[12:15], s41 offen lds
    v_mfma_f32_32x32x16_bf16 v[180:195], v[156:159], v[32:35], v[180:195]
    buffer_load_dwordx4 v[64:67], v12, s[8:11], s40 offen offset:1024
    buffer_load_dwordx4 v14, s[12:15], s41 offen offset:1024 lds
    s_add_u32 s40, s40, 2048
    v_mfma_f32_32x32x16_bf16 v[196:211], v[160:163], v[28:31], v[196:211]
    s_cmp_eq_u32 s40, s52
    s_cselect_b32 s40, 0, s40
    s_lshl_b32 s41, s40, 3
    v_mfma_f32_32x32x16_bf16 v[212:227], v[160:163], v[32:35], v[212:227]
    s_waitcnt vmcnt(8) lgkmcnt(0)
    ds_read_b64_tr_b16 v[156:157], v15 offset:6144
    ds_read_b64_tr_b16 v[158:159], v15 offset:7168
    ds_read_b64_tr_b16 v[160:161], v16 offset:6144
    ds_read_b64_tr_b16 v[162:163], v16 offset:7168
    v_mfma_f32_32x32x16_bf16 v[164:179], v[148:151], v[36:39], v[164:179]
    s_add_u32 m0, s50, 12288
    buffer_load_dwordx4 v[68:71], v12, s[8:11], s40 offen
    buffer_load_dwordx4 v13, s[12:15], s41 offen lds
    v_mfma_f32_32x32x16_bf16 v[180:195], v[148:151], v[40:43], v[180:195]
    buffer_load_dwordx4 v[72:75], v12, s[8:11], s40 offen offset:1024
    buffer_load_dwordx4 v14, s[12:15], s41 offen offset:1024 lds
    s_add_u32 s40, s40, 2048
    v_mfma_f32_32x32x16_bf16 v[196:211], v[152:155], v[36:39], v[196:211]
    s_cmp_eq_u32 s40, s52
    s_cselect_b32 s40, 0, s40
    s_lshl_b32 s41, s40, 3
    v_mfma_f32_32x32x16_bf16 v[212:227], v[152:155], v[40:43], v[212:227]
    s_waitcnt vmcnt(8) lgkmcnt(0)
    ds_read_b64_tr_b16 v[148:149], v15 offset:8192
    ds_read_b64_tr_b16 v[150:151], v15 offset:9216
    ds_read_b64_tr_b16 v[152:153], v16 offset:8192
    ds_read_b64_tr_b16 v[154:155], v16 offset:9216
    v_mfma_f32_32x32x16_bf16 v[164:179], v[156:159], v[44:47], v[164:179]
    s_add_u32 m0, s50, 14336
    buffer_load_dwordx4 v[76:79], v12, s[8:11], s40 offen
    buffer_load_dwordx4 v13, s[12:15], s41 offen lds
    v_mfma_f32_32x32x16_bf16 v[180:195], v[156:159], v[48:51], v[180:195]
    buffer_load_dwordx4 v[80:83], v12, s[8:11], s40 offen offset:1024
    buffer_load_dwordx4 v14, s[12:15], s41 offen offset:1024 lds
    s_add_u32 s40, s40, 2048
    v_mfma_f32_32x32x16_bf16 v[196:211], v[160:163], v[44:47], v[196:211]
    s_cmp_eq_u32 s40, s52
    s_cselect_b32 s40, 0, s40
    s_lshl_b32 s41, s40, 3
    v_mfma_f32_32x32x16_bf16 v[212:227], v[160:163], v[48:51], v[212:227]
    s_waitcnt vmcnt(8) lgkmcnt(0)
    ds_read_b64_tr_b16 v[156:157], v15 offset:10240
    ds_read_b64_tr_b16 v[158:159], v15 offset:11264
    ds_read_b64_tr_b16 v[160:161], v16 offset:10240
    ds_read_b64_tr_b16 v[162:163], v16 offset:11264
    v_mfma_f32_32x32x16_bf16 v[164:179], v[148:151], v[52:55], v[164:179]
    s_add_u32 m0, s50, 16384
    buffer_load_dwordx4 v[84:87], v12, s[8:11], s40 offen
    buffer_load_dwordx4 v13, s[12:15], s41 offen lds
    v_mfma_f32_32x32x16_bf16 v[180:195], v[148:151], v[56:59], v[180:195]
    buffer_load_dwordx4 v[88:91], v12, s[8:11], s40 offen offset:1024
    buffer_load_dwordx4 v14, s[12:15], s41 offen offset:1024 lds
    s_add_u32 s40, s40, 2048
    v_mfma_f32_32x32x16_bf16 v[196:211], v[152:155], v[52:55], v[196:211]
    s_cmp_eq_u32 s40, s52
    s_cselect_b32 s40, 0, s40
    s_lshl_b32 s41, s40, 3
    v_mfma_f32_32x32x16_bf16 v[212:227], v[152:155], v[56:59], v[212:227]
    s_waitcnt vmcnt(8) lgkmcnt(0)
    ds_read_b64_tr_b16 v[148:149], v15 offset:12288
    ds_read_b64_tr_b16 v[150:151], v15 offset:13312
    ds_read_b64_tr_b16 v[152:153], v16 offset:12288
    ds_read_b64_tr_b16 v[154:155], v16 offset:13312
    v_mfma_f32_32x32x16_bf16 v[164:179], v[156:159], v[60:63], v[164:179]
    s_add_u32 m0, s50, 18432
    buffer_load_dwordx4 v[92:95], v12, s[8:11], s40 offen
    buffer_load_dwordx4 v13, s[12:15], s41 offen lds
    v_mfma_f32_32x32x16_bf16 v[180:195], v[156:159], v[64:67], v[180:195]
    buffer_load_dwordx4 v[96:99], v12, s[8:11], s40 offen offset:1024
    buffer_load_dwordx4 v14, s[12:15], s41 offen offset:1024 lds
    s_add_u32 s40, s40, 2048
    v_mfma_f32_32x32x16_bf16 v[196:211], v[160:163], v[60:63], v[196:211]
    s_cmp_eq_u32 s40, s52
    s_cselect_b32 s40, 0, s40
    s_lshl_b32 s41, s40, 3
    v_mfma_f32_32x32x16_bf16 v[212:227], v[160:163], v[64:67], v[212:227]
    s_waitcnt vmcnt(8) lgkmcnt(0)
    ds_read_b64_tr_b16 v[156:157], v15 offset:14336
    ds_read_b64_tr_b16 v[158:159], v15 offset:15360
    ds_read_b64_tr_b16 v[160:161], v16 offset:14336
    ds_read_b64_tr_b16 v[162:163], v16 offset:15360
    v_mfma_f32_32x32x16_bf16 v[164:179], v[148:151], v[68:71], v[164:179]
    s_add_u32 m0, s50, 20480
    buffer_load_dwordx4 v[100:103], v12, s[8:11], s40 offen
    buffer_load_dwordx4 v13, s[12:15], s41 offen lds
    v_mfma_f32_32x32x16_bf16 v[180:195], v[148:151], v[72:75], v[180:195]
    buffer_load_dwordx4 v[104:107], v12, s[8:11], s40 offen offset:1024
    buffer_load_dwordx4 v14, s[12:15], s41 offen offset:1024 lds
    s_add_u32 s40, s40, 2048
    v_mfma_f32_32x32x16_bf16 v[196:211], v[152:155], v[68:71], v[196:211]
    s_cmp_eq_u32 s40, s52
    s_cselect_b32 s40, 0, s40
    s_lshl_b32 s41, s40, 3
    v_mfma_f32_32x32x16_bf16 v[212:227], v[152:155], v[72:75], v[212:227]
    s_waitcnt vmcnt(8) lgkmcnt(0)
    ds_read_b64_tr_b16 v[148:149], v15 offset:16384
    ds_read_b64_tr_b16 v[150:151], v15 offset:17408
    ds_read_b64_tr_b16 v[152:153], v16 offset:16384
    ds_read_b64_tr_b16 v[154:155], v16 offset:17408
    v_mfma_f32_32x32x16_bf16 v[164:179], v[156:159], v[76:79], v[164:179]
    s_add_u32 m0, s50, 22528
    buffer_load_dwordx4 v[108:111], v12, s[8:11], s40 offen
    buffer_load_dwordx4 v13, s[12:15], s41 offen lds
    v_mfma_f32_32x32x16_bf16 v[180:195], v[156:159], v[80:83], v[180:195]
    buffer_load_dwordx4 v[112:115], v12, s[8:11], s40 offen offset:1024
    buffer_load_dwordx4 v14, s[12:15], s41 offen offset:1024 lds
    s_add_u32 s40, s40, 2048
    v_mfma_f32_32x32x16_bf16 v[196:211], v[160:163], v[76:79], v[196:211]
    s_cmp_eq_u32 s40, s52
    s_cselect_b32 s40, 0, s40
    s_lshl_b32 s41, s40, 3
    v_mfma_f32_32x32x16_bf16 v[212:227], v[160:163], v[80:83], v[212:227]
    s_waitcnt vmcnt(8) lgkmcnt(0)
    ds_read_b64_tr_b16 v[156:157], v15 offset:18432
    ds_read_b64_tr_b16 v[158:159], v15 offset:19456
    ds_read_b64_tr_b16 v[160:161], v16 offset:18432
    ds_read_b64_tr_b16 v[162:163], v16 offset:19456
    v_mfma_f32_32x32x16_bf16 v[164:179], v[148:151], v[84:87], v[164:179]
    s_add_u32 m0, s50, 24576
    buffer_load_dwordx4 v[116:119], v12, s[8:11], s40 offen
    buffer_load_dwordx4 v13, s[12:15], s41 offen lds
    v_mfma_f32_32x32x16_bf16 v[180:195], v[148:151], v[88:91], v[180:195]
    buffer_load_dwordx4 v[120:123], v12, s[8:11], s40 offen offset:1024
    buffer_load_dwordx4 v14, s[12:15], s41 offen offset:1024 lds
    s_add_u32 s40, s40, 2048
    v_mfma_f32_32x32x16_bf16 v[196:211], v[152:155], v[84:87], v[196:211]
    s_cmp_eq_u32 s40, s52
    s_cselect_b32 s40, 0, s40
    s_lshl_b32 s41, s40, 3
    v_mfma_f32_32x32x16_bf16 v[212:227], v[152:155], v[88:91], v[212:227]
    s_mov_b32 s16, s4
    s_mov_b32 s17, s5
    s_mov_b32 s18, 2097152
    s_mov_b32 s19, 0x20000
    s_mov_b32 s20, s30
    s_mov_b32 s21, s31
    s_mov_b32 s22, 2097152
    s_mov_b32 s23, 0x20000
    v_lshrrev_b32 v9, 3, v0
    v_and_b32 v10, 7, v0
    s_lshl_b32 s46, s35, 6
    v_add_u32 v11, s46, v9
    v_lshlrev_b32 v11, 10, v11
    v_lshl_add_u32 v11, v10, 4, v11
    s_lshl_b32 s47, s36, 7
    v_add_u32 v11, s47, v11
    s_mov_b32 s51, 32768
    buffer_load_dwordx4 v[228:231], v11, s[16:19], 0 offen
    buffer_load_dwordx4 v[232:235], v11, s[16:19], s51 offen
    s_waitcnt vmcnt(8) lgkmcnt(0)
    ds_read_b64_tr_b16 v[148:149], v15 offset:20480
    ds_read_b64_tr_b16 v[150:151], v15 offset:21504
    ds_read_b64_tr_b16 v[152:153], v16 offset:20480
    ds_read_b64_tr_b16 v[154:155], v16 offset:21504
    v_mfma_f32_32x32x16_bf16 v[164:179], v[156:159], v[92:95], v[164:179]
    s_cmp_gt_u32 s38, 29
    s_cselect_b32 s40, s40, s52
    s_lshl_b32 s41, s40, 3
    v_mfma_f32_32x32x16_bf16 v[180:195], v[156:159], v[96:99], v[180:195]
    s_add_u32 m0, s50, 26624
    buffer_load_dwordx4 v[124:127], v12, s[8:11], s40 offen
    buffer_load_dwordx4 v13, s[12:15], s41 offen lds
    v_mfma_f32_32x32x16_bf16 v[196:211], v[160:163], v[92:95], v[196:211]
    buffer_load_dwordx4 v[128:131], v12, s[8:11], s40 offen offset:1024
    buffer_load_dwordx4 v14, s[12:15], s41 offen offset:1024 lds
    s_add_u32 s40, s40, 2048
    v_mfma_f32_32x32x16_bf16 v[212:227], v[160:163], v[96:99], v[212:227]
    s_cmp_eq_u32 s40, s52
    s_cselect_b32 s40, 0, s40
    s_lshl_b32 s41, s40, 3
    s_waitcnt vmcnt(8) lgkmcnt(0)
    ds_read_b64_tr_b16 v[156:157], v15 offset:22528
    ds_read_b64_tr_b16 v[158:159], v15 offset:23552
    ds_read_b64_tr_b16 v[160:161], v16 offset:22528
    ds_read_b64_tr_b16 v[162:163], v16 offset:23552
    v_mfma_f32_32x32x16_bf16 v[164:179], v[148:151], v[100:103], v[164:179]
    v_mfma_f32_32x32x16_bf16 v[180:195], v[148:151], v[104:107], v[180:195]
    v_mfma_f32_32x32x16_bf16 v[196:211], v[152:155], v[100:103], v[196:211]
    v_mfma_f32_32x32x16_bf16 v[212:227], v[152:155], v[104:107], v[212:227]
    s_waitcnt vmcnt(4) lgkmcnt(0)
    ds_read_b64_tr_b16 v[148:149], v15 offset:24576
    ds_read_b64_tr_b16 v[150:151], v15 offset:25600
    ds_read_b64_tr_b16 v[152:153], v16 offset:24576
    ds_read_b64_tr_b16 v[154:155], v16 offset:25600
    v_mfma_f32_32x32x16_bf16 v[164:179], v[156:159], v[108:111], v[164:179]
    v_mfma_f32_32x32x16_bf16 v[180:195], v[156:159], v[112:115], v[180:195]
    v_mfma_f32_32x32x16_bf16 v[196:211], v[160:163], v[108:111], v[196:211]
    v_mfma_f32_32x32x16_bf16 v[212:227], v[160:163], v[112:115], v[212:227]
    s_waitcnt vmcnt(0) lgkmcnt(0)
    ds_read_b64_tr_b16 v[156:157], v15 offset:26624
    ds_read_b64_tr_b16 v[158:159], v15 offset:27648
    ds_read_b64_tr_b16 v[160:161], v16 offset:26624
    ds_read_b64_tr_b16 v[162:163], v16 offset:27648
    v_mfma_f32_32x32x16_bf16 v[164:179], v[148:151], v[116:119], v[164:179]
    v_mfma_f32_32x32x16_bf16 v[180:195], v[148:151], v[120:123], v[180:195]
    v_mfma_f32_32x32x16_bf16 v[196:211], v[152:155], v[116:119], v[196:211]
    v_mfma_f32_32x32x16_bf16 v[212:227], v[152:155], v[120:123], v[212:227]
    s_cmp_le_u32 s38, 29
    s_cbranch_scc1 K2_TAIL
    s_waitcnt vmcnt(0) lgkmcnt(0)
    v_mfma_f32_32x32x16_bf16 v[164:179], v[156:159], v[124:127], v[164:179]
    v_mfma_f32_32x32x16_bf16 v[180:195], v[156:159], v[128:131], v[180:195]
    v_mfma_f32_32x32x16_bf16 v[196:211], v[160:163], v[124:127], v[196:211]
    v_mfma_f32_32x32x16_bf16 v[212:227], v[160:163], v[128:131], v[212:227]
K2_TAIL:
    s_waitcnt vmcnt(0) lgkmcnt(0)
    v_mul_u32_u24 v4, 272, v2
    v_lshl_add_u32 v4, v3, 4, v4
    s_mul_i32 s46, s34, 32768
    v_add_u32 v4, s46, v4
    s_nop 7
    s_nop 7
    ds_write_b128 v4, v[164:167] offset:0
    ds_write_b128 v4, v[168:171] offset:32
    ds_write_b128 v4, v[172:175] offset:64
    ds_write_b128 v4, v[176:179] offset:96
    ds_write_b128 v4, v[180:183] offset:8704
    ds_write_b128 v4, v[184:187] offset:8736
    ds_write_b128 v4, v[188:191] offset:8768
    ds_write_b128 v4, v[192:195] offset:8800
    ds_write_b128 v4, v[196:199] offset:128
    ds_write_b128 v4, v[200:203] offset:160
    ds_write_b128 v4, v[204:207] offset:192
    ds_write_b128 v4, v[208:211] offset:224
    ds_write_b128 v4, v[212:215] offset:8832
    ds_write_b128 v4, v[216:219] offset:8864
    ds_write_b128 v4, v[220:223] offset:8896
    ds_write_b128 v4, v[224:227] offset:8928
    v_mul_u32_u24 v5, 272, v9
    v_lshl_add_u32 v5, v10, 5, v5
    v_add_u32 v6, 65536, v5
    s_waitcnt vmcnt(0) lgkmcnt(0)
    s_barrier
    ds_read_b128 v[20:23], v5 offset:0
    ds_read_b128 v[24:27], v5 offset:16
    ds_read_b128 v[28:31], v5 offset:32768
    ds_read_b128 v[32:35], v5 offset:32784
    ds_read_b128 v[36:39], v6 offset:0
    ds_read_b128 v[40:43], v6 offset:16
    ds_read_b128 v[44:47], v6 offset:32768
    ds_read_b128 v[48:51], v6 offset:32784
    s_waitcnt lgkmcnt(4)
    ds_read_b128 v[52:55], v5 offset:8704
    ds_read_b128 v[56:59], v5 offset:8720
    ds_read_b128 v[60:63], v5 offset:41472
    ds_read_b128 v[64:67], v5 offset:41488
    ds_read_b128 v[68:71], v6 offset:8704
    ds_read_b128 v[72:75], v6 offset:8720
    ds_read_b128 v[76:79], v6 offset:41472
    ds_read_b128 v[80:83], v6 offset:41488
    s_waitcnt lgkmcnt(8)
    v_add_f32 v20, v20, v28
    v_add_f32 v21, v21, v29
    v_add_f32 v22, v22, v30
    v_add_f32 v23, v23, v31
    v_add_f32 v24, v24, v32
    v_add_f32 v25, v25, v33
    v_add_f32 v26, v26, v34
    v_add_f32 v27, v27, v35
    v_add_f32 v36, v36, v44
    v_add_f32 v37, v37, v45
    v_add_f32 v38, v38, v46
    v_add_f32 v39, v39, v47
    v_add_f32 v40, v40, v48
    v_add_f32 v41, v41, v49
    v_add_f32 v42, v42, v50
    v_add_f32 v43, v43, v51
    v_lshlrev_b32 v28, 16, v228
    v_and_b32 v29, 0xffff0000, v228
    v_lshlrev_b32 v30, 16, v229
    v_and_b32 v31, 0xffff0000, v229
    v_lshlrev_b32 v32, 16, v230
    v_and_b32 v33, 0xffff0000, v230
    v_lshlrev_b32 v34, 16, v231
    v_and_b32 v35, 0xffff0000, v231
    v_add_f32 v20, v20, v36
    v_add_f32 v21, v21, v37
    v_add_f32 v22, v22, v38
    v_add_f32 v23, v23, v39
    v_add_f32 v24, v24, v40
    v_add_f32 v25, v25, v41
    v_add_f32 v26, v26, v42
    v_add_f32 v27, v27, v43
    v_add_f32 v20, v20, v28
    v_add_f32 v21, v21, v29
    v_add_f32 v22, v22, v30
    v_add_f32 v23, v23, v31
    v_add_f32 v24, v24, v32
    v_add_f32 v25, v25, v33
    v_add_f32 v26, v26, v34
    v_add_f32 v27, v27, v35
    v_cvt_pk_bf16_f32 v36, v20, v21
    v_cvt_pk_bf16_f32 v37, v22, v23
    v_cvt_pk_bf16_f32 v38, v24, v25
    v_cvt_pk_bf16_f32 v39, v26, v27
    buffer_store_dwordx4 v[36:39], v11, s[20:23], 0 offen
    s_waitcnt lgkmcnt(0)
    v_add_f32 v52, v52, v60
    v_add_f32 v53, v53, v61
    v_add_f32 v54, v54, v62
    v_add_f32 v55, v55, v63
    v_add_f32 v56, v56, v64
    v_add_f32 v57, v57, v65
    v_add_f32 v58, v58, v66
    v_add_f32 v59, v59, v67
    v_add_f32 v68, v68, v76
    v_add_f32 v69, v69, v77
    v_add_f32 v70, v70, v78
    v_add_f32 v71, v71, v79
    v_add_f32 v72, v72, v80
    v_add_f32 v73, v73, v81
    v_add_f32 v74, v74, v82
    v_add_f32 v75, v75, v83
    v_lshlrev_b32 v60, 16, v232
    v_and_b32 v61, 0xffff0000, v232
    v_lshlrev_b32 v62, 16, v233
    v_and_b32 v63, 0xffff0000, v233
    v_lshlrev_b32 v64, 16, v234
    v_and_b32 v65, 0xffff0000, v234
    v_lshlrev_b32 v66, 16, v235
    v_and_b32 v67, 0xffff0000, v235
    v_add_f32 v52, v52, v68
    v_add_f32 v53, v53, v69
    v_add_f32 v54, v54, v70
    v_add_f32 v55, v55, v71
    v_add_f32 v56, v56, v72
    v_add_f32 v57, v57, v73
    v_add_f32 v58, v58, v74
    v_add_f32 v59, v59, v75
    v_add_f32 v52, v52, v60
    v_add_f32 v53, v53, v61
    v_add_f32 v54, v54, v62
    v_add_f32 v55, v55, v63
    v_add_f32 v56, v56, v64
    v_add_f32 v57, v57, v65
    v_add_f32 v58, v58, v66
    v_add_f32 v59, v59, v67
    v_cvt_pk_bf16_f32 v68, v52, v53
    v_cvt_pk_bf16_f32 v69, v54, v55
    v_cvt_pk_bf16_f32 v70, v56, v57
    v_cvt_pk_bf16_f32 v71, v58, v59
    buffer_store_dwordx4 v[68:71], v11, s[20:23], s51 offen
K2_END:
    s_endpgm
.section .rodata,"a"
.p2align 6
.amdhsa_kernel k1_kernel
  .amdhsa_next_free_vgpr 256
  .amdhsa_next_free_sgpr 102
  .amdhsa_accum_offset 256
  .amdhsa_group_segment_fixed_size 0
  .amdhsa_kernarg_size 80
  .amdhsa_user_sgpr_count 2
  .amdhsa_user_sgpr_kernarg_segment_ptr 1
  .amdhsa_system_sgpr_workgroup_id_x 1
.end_amdhsa_kernel
.p2align 6
.amdhsa_kernel k2_kernel
  .amdhsa_next_free_vgpr 236
  .amdhsa_next_free_sgpr 102
  .amdhsa_accum_offset 236
  .amdhsa_group_segment_fixed_size 0
  .amdhsa_kernarg_size 80
  .amdhsa_user_sgpr_count 2
  .amdhsa_user_sgpr_kernarg_segment_ptr 1
  .amdhsa_system_sgpr_workgroup_id_x 1
.end_amdhsa_kernel
```
